```python
import torch

def _softmax(x, axis=-1):
    return torch.softmax(x, dim=axis)

def _gelu(x):
    return torch.nn.functional.gelu(x, approximate='tanh')

def _silu(x):
    return torch.nn.functional.silu(x)

def _sigmoid(x):
    return torch.sigmoid(x)

def _layernorm(x, axis=-1, eps=1e-05):
    m = x.mean(dim=axis, keepdim=True)
    v = x.var(dim=axis, keepdim=True, unbiased=False)
    return (x - m) / torch.sqrt(v + eps)

def _scatter_add(tgt, idx, src, axis=0):
    return tgt.clone().index_add_(axis, idx, src)

def _segment_sum(src, seg, n):
    out = torch.zeros((n,) + src.shape[1:], dtype=src.dtype)
    return out.index_add_(0, seg, src)

def _pad(x, pw):
    flat = tuple((v for pair in reversed(pw) for v in pair))
    return torch.nn.functional.pad(x, flat)
kernel_name = 'interleave_layers__mha_block__mixer_gmlp__prompt'

def setup_inputs():

    _w = lambda a: (lambda t: t.to(torch.bfloat16) if t.is_floating_point() else t)(torch.as_tensor(a))

    def _A_setup():
        B, S, D, H = (1, 2048, 448, 16)
        return {'x': _w((lambda *s: torch.randn(*s, dtype=torch.bfloat16) * 0.05)(B, S, D)), 'wqkv': _w((lambda *s: torch.randn(*s, dtype=torch.bfloat16) * 0.05)(D, 3 * D)), 'wo': _w((lambda *s: torch.randn(*s, dtype=torch.bfloat16) * 0.05)(D, D))}
    _A_in = _A_setup()

    def _B_setup():
        B, S, D, F = (1, 2048, 448, 1792)
        Fh = F // 2
        return {'x': _w((lambda *s: torch.randn(*s, dtype=torch.bfloat16) * 0.05)(B, S, D)), 'w_in': _w((lambda *s: torch.randn(*s, dtype=torch.bfloat16) * 0.2)(D, 2 * Fh)), 'w_sp': _w(0.01 * (lambda *s: torch.randn(*s, dtype=torch.bfloat16) * 0.2)(S, S)), 'b_sp': _w(1.0 + 0.01 * (lambda *s: torch.randn(*s, dtype=torch.bfloat16) * 0.05)(S)), 'w_out': _w((lambda *s: torch.randn(*s, dtype=torch.bfloat16) * 0.05)(Fh, D))}
    _B_in = _B_setup()
    return {'A_x': _A_in['x'], 'A_wqkv': _A_in['wqkv'], 'A_wo': _A_in['wo'], 'B_x': _B_in['x'], 'B_w_in': _B_in['w_in'], 'B_w_sp': _B_in['w_sp'], 'B_b_sp': _B_in['b_sp'], 'B_w_out': _B_in['w_out']}

def reference(A_x, A_wqkv, A_wo, B_x, B_w_in, B_w_sp, B_b_sp, B_w_out):

    def _A_ref(x, wqkv, wo):
        B, S, D = x.shape
        H = 16
        Dh = D // H
        qkv = (lambda x, *d: x.permute(*d))((x @ wqkv).reshape(B, S, 3, H, Dh), 2, 0, 3, 1, 4)
        q, k, v = (qkv[0], qkv[1], qkv[2])
        scores = torch.einsum('bhqd,bhkd->bhqk', q, k) * Dh ** (-0.5)
        p = _softmax(scores, axis=-1)
        o = torch.einsum('bhqk,bhkd->bhqd', p, v)
        return (lambda x, *d: x.permute(*d))(o, 0, 2, 1, 3).reshape(B, S, D) @ wo

    def _B_ref(x, w_in, w_sp, b_sp, w_out):
        B, S, D = x.shape
        F = w_in.shape[-1]
        Fh = F // 2
        z = _gelu(torch.einsum('bsd,df->bsf', x, w_in))
        z1 = z[..., :Fh].clone()
        z2 = _layernorm(z[..., Fh:], axis=-1)
        g = torch.einsum('ts,bsf->btf', w_sp, z2) + b_sp[None, :, None]
        return torch.einsum('bsf,fd->bsd', z1 * g, w_out)
    x = A_x
    x = x + _A_ref(_layernorm(x, axis=-1), A_wqkv, A_wo)
    x = x + _B_ref(_layernorm(x, axis=-1), B_w_in, B_w_sp, B_b_sp, B_w_out)
    x = x + _A_ref(_layernorm(x, axis=-1), A_wqkv, A_wo)
    x = x + _B_ref(_layernorm(x, axis=-1), B_w_in, B_w_sp, B_b_sp, B_w_out)
    return x
```

```asm
; @launch grid=(256,1,1) block=(512,1,1) lds=163840
.amdgcn_target "amdgcn-amd-amdhsa--gfx950"
.text
.globl interleave_layers__mha_block__mixer_gmlp__prompt_kernel
.p2align 8
.type interleave_layers__mha_block__mixer_gmlp__prompt_kernel,@function
interleave_layers__mha_block__mixer_gmlp__prompt_kernel:
    s_cmp_ge_u32 s2, 256
    s_cbranch_scc1 L_main_end
    s_load_dwordx4 s[20:23], s[0:1], 8
    s_load_dwordx8 s[24:31], s[0:1], 32
    s_load_dwordx2 s[32:33], s[0:1], 64
    s_load_dwordx2 s[34:35], s[0:1], 80
    s_load_dwordx2 s[100:101], s[0:1], 0
    v_lshrrev_b32 v2, 6, v0
    v_and_b32 v1, 63, v0
    v_readfirstlane_b32 s18, v2
    v_lshlrev_b32 v0, 4, v1
    s_and_b32 s3, s18, 3
    s_and_b32 s40, s2, 7
    s_lshr_b32 s41, s2, 3
    s_lshl_b32 s42, s40, 1
    s_lshr_b32 s43, s41, 4
    s_add_u32 s16, s42, s43
    s_and_b32 s17, s41, 15
    s_mov_b32 s39, 0
    s_mov_b32 s2, 0
    s_cmp_ge_u32 s17, 7
    s_cselect_b32 s37, 1, 0
    s_mul_i32 s40, s37, 7
    s_sub_u32 s38, s17, s40
    s_mov_b32 s19, 0
    s_mov_b32 s36, 40000
    s_waitcnt lgkmcnt(0)
    s_mov_b32 s8, s34
    s_mov_b32 s9, s35
    s_mov_b32 s10, 268435456
    s_mov_b32 s11, 0x20000
    s_mov_b32 s4, s22
    s_mov_b32 s5, s23
    s_mov_b32 s6, 401408
    s_mov_b32 s7, 0x20000
    s_mov_b32 s12, s26
    s_mov_b32 s13, s27
    s_mov_b32 s14, 8388608
    s_mov_b32 s15, 0x20000
    s_cmp_ge_u32 s18, 4
    s_cbranch_scc0 L_qkv_helper_3
    s_lshl_b32 s50, s16, 2
    s_add_u32 s50, s50, s3
    s_mov_b32 s4, s100
    s_mov_b32 s5, s101
    s_mov_b32 s6, 1835008
    s_mov_b32 s7, 0x20000
    s_mul_i32 s46, s50, 28672
    s_lshl_b32 s47, s3, 14
    s_add_u32 s47, s47, 86016
    v_lshrrev_b32 v4, 4, v1
    v_and_b32 v5, 15, v1
    v_add_u32 v6, 0, v4
    v_xor_b32 v6, v6, v5
    v_min_u32 v6, 13, v6
    v_mul_u32_u24 v7, 896, v4
    v_lshl_add_u32 v8, v6, 4, v7
    v_add_u32 v6, 4, v4
    v_xor_b32 v6, v6, v5
    v_min_u32 v6, 13, v6
    v_mul_u32_u24 v7, 896, v4
    v_lshl_add_u32 v9, v6, 4, v7
    v_add_u32 v6, 8, v4
    v_xor_b32 v6, v6, v5
    v_min_u32 v6, 13, v6
    v_mul_u32_u24 v7, 896, v4
    v_lshl_add_u32 v10, v6, 4, v7
    v_add_u32 v6, 12, v4
    v_xor_b32 v6, v6, v5
    v_min_u32 v6, 13, v6
    v_mul_u32_u24 v7, 896, v4
    v_lshl_add_u32 v11, v6, 4, v7
    v_and_b32 v4, 31, v1
    v_lshlrev_b32 v12, 8, v4
    v_and_b32 v4, 15, v4
    v_lshl_add_u32 v12, v4, 4, v12
    v_lshrrev_b32 v5, 5, v1
    v_lshl_add_u32 v12, v5, 3, v12
    v_add_u32 v12, s47, v12
    s_add_u32 m0, s47, 0
    s_add_u32 s42, s46, 0
    buffer_load_dwordx4 v8, s[4:7], s42 offen lds
    s_add_u32 m0, m0, 1024
    s_add_u32 s42, s46, 7168
    buffer_load_dwordx4 v9, s[4:7], s42 offen lds
    s_add_u32 m0, m0, 1024
    s_add_u32 s42, s46, 3584
    buffer_load_dwordx4 v10, s[4:7], s42 offen lds
    s_add_u32 m0, m0, 1024
    s_add_u32 s42, s46, 10752
    buffer_load_dwordx4 v11, s[4:7], s42 offen lds
    s_add_u32 m0, m0, 1024
    s_add_u32 s42, s46, 14336
    buffer_load_dwordx4 v8, s[4:7], s42 offen lds
    s_add_u32 m0, m0, 1024
    s_add_u32 s42, s46, 21504
    buffer_load_dwordx4 v9, s[4:7], s42 offen lds
    s_add_u32 m0, m0, 1024
    s_add_u32 s42, s46, 17920
    buffer_load_dwordx4 v10, s[4:7], s42 offen lds
    s_add_u32 m0, m0, 1024
    s_add_u32 s42, s46, 25088
    buffer_load_dwordx4 v11, s[4:7], s42 offen lds
    s_add_u32 m0, s47, 8192
    s_add_u32 s42, s46, 224
    buffer_load_dwordx4 v8, s[4:7], s42 offen lds
    s_add_u32 m0, m0, 1024
    s_add_u32 s42, s46, 7392
    buffer_load_dwordx4 v9, s[4:7], s42 offen lds
    s_add_u32 m0, m0, 1024
    s_add_u32 s42, s46, 3808
    buffer_load_dwordx4 v10, s[4:7], s42 offen lds
    s_add_u32 m0, m0, 1024
    s_add_u32 s42, s46, 10976
    buffer_load_dwordx4 v11, s[4:7], s42 offen lds
    s_add_u32 m0, m0, 1024
    s_add_u32 s42, s46, 14560
    buffer_load_dwordx4 v8, s[4:7], s42 offen lds
    s_add_u32 m0, m0, 1024
    s_add_u32 s42, s46, 21728
    buffer_load_dwordx4 v9, s[4:7], s42 offen lds
    s_add_u32 m0, m0, 1024
    s_add_u32 s42, s46, 18144
    buffer_load_dwordx4 v10, s[4:7], s42 offen lds
    s_add_u32 m0, m0, 1024
    s_add_u32 s42, s46, 25312
    buffer_load_dwordx4 v11, s[4:7], s42 offen lds
    v_lshrrev_b32 v2, 5, v1
    v_lshlrev_b32 v2, 2, v2
    v_bfe_u32 v3, v1, 2, 2
    v_add_u32 v2, v2, v3
    v_mul_u32_u24 v218, 64, v2
    v_bfe_u32 v3, v1, 4, 1
    v_lshlrev_b32 v3, 5, v3
    v_add_u32 v218, v218, v3
    v_and_b32 v3, 3, v1
    v_lshlrev_b32 v3, 3, v3
    v_add_u32 v218, v218, v3
    v_add_u32 v219, 57344, v218
    v_lshrrev_b32 v220, 5, v1
    v_lshlrev_b32 v220, 4, v220
    v_add_u32 v220, 161792, v220
    v_and_b32 v2, 31, v1
    v_lshrrev_b32 v3, 5, v1
    v_lshlrev_b32 v3, 2, v3
    v_sub_u32 v2, v2, v3
    v_mov_b32 v240, 0
    v_mov_b32 v3, 0x3f80
    v_cmp_eq_u32 vcc, 0, v2
    s_nop 1
    v_cndmask_b32 v240, v240, v3, vcc
    v_mov_b32 v3, 0x3f800000
    v_cmp_eq_u32 vcc, 1, v2
    s_nop 1
    v_cndmask_b32 v240, v240, v3, vcc
    v_mov_b32 v241, 0
    v_mov_b32 v3, 0x3f80
    v_cmp_eq_u32 vcc, 2, v2
    s_nop 1
    v_cndmask_b32 v241, v241, v3, vcc
    v_mov_b32 v3, 0x3f800000
    v_cmp_eq_u32 vcc, 3, v2
    s_nop 1
    v_cndmask_b32 v241, v241, v3, vcc
    v_mov_b32 v242, 0
    v_mov_b32 v3, 0x3f80
    v_cmp_eq_u32 vcc, 8, v2
    s_nop 1
    v_cndmask_b32 v242, v242, v3, vcc
    v_mov_b32 v3, 0x3f800000
    v_cmp_eq_u32 vcc, 9, v2
    s_nop 1
    v_cndmask_b32 v242, v242, v3, vcc
    v_mov_b32 v243, 0
    v_mov_b32 v3, 0x3f80
    v_cmp_eq_u32 vcc, 10, v2
    s_nop 1
    v_cndmask_b32 v243, v243, v3, vcc
    v_mov_b32 v3, 0x3f800000
    v_cmp_eq_u32 vcc, 11, v2
    s_nop 1
    v_cndmask_b32 v243, v243, v3, vcc
    v_mov_b32 v244, 0
    v_mov_b32 v3, 0x3f80
    v_cmp_eq_u32 vcc, 16, v2
    s_nop 1
    v_cndmask_b32 v244, v244, v3, vcc
    v_mov_b32 v3, 0x3f800000
    v_cmp_eq_u32 vcc, 17, v2
    s_nop 1
    v_cndmask_b32 v244, v244, v3, vcc
    v_mov_b32 v245, 0
    v_mov_b32 v3, 0x3f80
    v_cmp_eq_u32 vcc, 18, v2
    s_nop 1
    v_cndmask_b32 v245, v245, v3, vcc
    v_mov_b32 v3, 0x3f800000
    v_cmp_eq_u32 vcc, 19, v2
    s_nop 1
    v_cndmask_b32 v245, v245, v3, vcc
    v_mov_b32 v246, 0
    v_mov_b32 v3, 0x3f80
    v_cmp_eq_u32 vcc, 24, v2
    s_nop 1
    v_cndmask_b32 v246, v246, v3, vcc
    v_mov_b32 v3, 0x3f800000
    v_cmp_eq_u32 vcc, 25, v2
    s_nop 1
    v_cndmask_b32 v246, v246, v3, vcc
    v_mov_b32 v247, 0
    v_mov_b32 v3, 0x3f80
    v_cmp_eq_u32 vcc, 26, v2
    s_nop 1
    v_cndmask_b32 v247, v247, v3, vcc
    v_mov_b32 v3, 0x3f800000
    v_cmp_eq_u32 vcc, 27, v2
    s_nop 1
    v_cndmask_b32 v247, v247, v3, vcc
    v_mov_b32 v232, 0
    v_mov_b32 v233, 0
    v_mov_b32 v234, 0
    v_mov_b32 v235, 0
    s_waitcnt vmcnt(8)
    v_xor_b32 v13, 0, v12
    ds_read_b64 v[16:17], v13 offset:0
    v_xor_b32 v14, 16, v12
    ds_read_b64 v[18:19], v14 offset:0
    v_xor_b32 v13, 32, v12
    ds_read_b64 v[20:21], v13 offset:0
    v_xor_b32 v14, 48, v12
    ds_read_b64 v[22:23], v14 offset:0
    v_xor_b32 v13, 64, v12
    ds_read_b64 v[24:25], v13 offset:0
    v_xor_b32 v14, 80, v12
    ds_read_b64 v[26:27], v14 offset:0
    v_xor_b32 v13, 96, v12
    ds_read_b64 v[28:29], v13 offset:0
    v_xor_b32 v14, 112, v12
    ds_read_b64 v[30:31], v14 offset:0
    v_xor_b32 v13, 128, v12
    ds_read_b64 v[32:33], v13 offset:0
    v_xor_b32 v14, 144, v12
    ds_read_b64 v[34:35], v14 offset:0
    v_xor_b32 v13, 160, v12
    ds_read_b64 v[36:37], v13 offset:0
    v_xor_b32 v14, 176, v12
    ds_read_b64 v[38:39], v14 offset:0
    v_xor_b32 v13, 192, v12
    ds_read_b64 v[40:41], v13 offset:0
    v_xor_b32 v14, 208, v12
    ds_read_b64 v[42:43], v14 offset:0
    s_waitcnt lgkmcnt(0)
    s_add_u32 m0, s47, 0
    s_add_u32 s42, s46, 448
    buffer_load_dwordx4 v8, s[4:7], s42 offen lds
    s_add_u32 m0, m0, 1024
    s_add_u32 s42, s46, 7616
    buffer_load_dwordx4 v9, s[4:7], s42 offen lds
    s_add_u32 m0, m0, 1024
    s_add_u32 s42, s46, 4032
    buffer_load_dwordx4 v10, s[4:7], s42 offen lds
    s_add_u32 m0, m0, 1024
    s_add_u32 s42, s46, 11200
    buffer_load_dwordx4 v11, s[4:7], s42 offen lds
    s_add_u32 m0, m0, 1024
    s_add_u32 s42, s46, 14784
    buffer_load_dwordx4 v8, s[4:7], s42 offen lds
    s_add_u32 m0, m0, 1024
    s_add_u32 s42, s46, 21952
    buffer_load_dwordx4 v9, s[4:7], s42 offen lds
    s_add_u32 m0, m0, 1024
    s_add_u32 s42, s46, 18368
    buffer_load_dwordx4 v10, s[4:7], s42 offen lds
    s_add_u32 m0, m0, 1024
    s_add_u32 s42, s46, 25536
    buffer_load_dwordx4 v11, s[4:7], s42 offen lds
    v_dot2_f32_bf16 v232, v16, v16, v232
    v_dot2_f32_bf16 v233, v17, v17, v233
    v_dot2_f32_bf16 v234, v18, v18, v234
    v_dot2_f32_bf16 v235, v19, v19, v235
    v_dot2_f32_bf16 v232, v20, v20, v232
    v_dot2_f32_bf16 v233, v21, v21, v233
    v_dot2_f32_bf16 v234, v22, v22, v234
    v_dot2_f32_bf16 v235, v23, v23, v235
    v_dot2_f32_bf16 v232, v24, v24, v232
    v_dot2_f32_bf16 v233, v25, v25, v233
    v_dot2_f32_bf16 v234, v26, v26, v234
    v_dot2_f32_bf16 v235, v27, v27, v235
    v_dot2_f32_bf16 v232, v28, v28, v232
    v_dot2_f32_bf16 v233, v29, v29, v233
    v_dot2_f32_bf16 v234, v30, v30, v234
    v_dot2_f32_bf16 v235, v31, v31, v235
    v_dot2_f32_bf16 v232, v32, v32, v232
    v_dot2_f32_bf16 v233, v33, v33, v233
    v_dot2_f32_bf16 v234, v34, v34, v234
    v_dot2_f32_bf16 v235, v35, v35, v235
    v_dot2_f32_bf16 v232, v36, v36, v232
    v_dot2_f32_bf16 v233, v37, v37, v233
    v_dot2_f32_bf16 v234, v38, v38, v234
    v_dot2_f32_bf16 v235, v39, v39, v235
    v_dot2_f32_bf16 v232, v40, v40, v232
    v_dot2_f32_bf16 v233, v41, v41, v233
    v_dot2_f32_bf16 v234, v42, v42, v234
    v_dot2_f32_bf16 v235, v43, v43, v235
    s_barrier
    ds_read_b64_tr_b16 v[176:177], v218 offset:0
    ds_read_b64_tr_b16 v[178:179], v218 offset:512
    ds_read_b64_tr_b16 v[180:181], v218 offset:28672
    ds_read_b64_tr_b16 v[182:183], v218 offset:29184
    ds_read_b64_tr_b16 v[184:185], v219 offset:0
    ds_read_b64_tr_b16 v[186:187], v219 offset:512
    ds_read_b64_tr_b16 v[188:189], v218 offset:1024
    ds_read_b64_tr_b16 v[190:191], v218 offset:1536
    ds_read_b64_tr_b16 v[192:193], v218 offset:29696
    ds_read_b64_tr_b16 v[194:195], v218 offset:30208
    ds_read_b64_tr_b16 v[196:197], v219 offset:1024
    ds_read_b64_tr_b16 v[198:199], v219 offset:1536
    s_waitcnt lgkmcnt(6)
    v_mfma_f32_32x32x16_bf16 v[128:143], v[176:179], v[16:19], 0
    ds_read_b64_tr_b16 v[200:201], v218 offset:2048
    ds_read_b64_tr_b16 v[202:203], v218 offset:2560
    v_mfma_f32_32x32x16_bf16 v[144:159], v[180:183], v[16:19], 0
    ds_read_b64_tr_b16 v[204:205], v218 offset:30720
    ds_read_b64_tr_b16 v[206:207], v218 offset:31232
    v_mfma_f32_32x32x16_bf16 v[160:175], v[184:187], v[16:19], 0
    ds_read_b64_tr_b16 v[208:209], v219 offset:2048
    ds_read_b64_tr_b16 v[210:211], v219 offset:2560
    s_waitcnt lgkmcnt(6)
    v_mfma_f32_32x32x16_bf16 v[128:143], v[188:191], v[20:23], v[128:143]
    ds_read_b64_tr_b16 v[176:177], v218 offset:3072
    ds_read_b64_tr_b16 v[178:179], v218 offset:3584
    v_mfma_f32_32x32x16_bf16 v[144:159], v[192:195], v[20:23], v[144:159]
    ds_read_b64_tr_b16 v[180:181], v218 offset:31744
    ds_read_b64_tr_b16 v[182:183], v218 offset:32256
    v_mfma_f32_32x32x16_bf16 v[160:175], v[196:199], v[20:23], v[160:175]
    ds_read_b64_tr_b16 v[184:185], v219 offset:3072
    ds_read_b64_tr_b16 v[186:187], v219 offset:3584
    s_waitcnt lgkmcnt(6)
    v_mfma_f32_32x32x16_bf16 v[128:143], v[200:203], v[24:27], v[128:143]
    ds_read_b64_tr_b16 v[188:189], v218 offset:4096
    ds_read_b64_tr_b16 v[190:191], v218 offset:4608
    v_mfma_f32_32x32x16_bf16 v[144:159], v[204:207], v[24:27], v[144:159]
    ds_read_b64_tr_b16 v[192:193], v218 offset:32768
    ds_read_b64_tr_b16 v[194:195], v218 offset:33280
    v_mfma_f32_32x32x16_bf16 v[160:175], v[208:211], v[24:27], v[160:175]
    ds_read_b64_tr_b16 v[196:197], v219 offset:4096
    ds_read_b64_tr_b16 v[198:199], v219 offset:4608
    s_waitcnt lgkmcnt(6)
    v_mfma_f32_32x32x16_bf16 v[128:143], v[176:179], v[28:31], v[128:143]
    ds_read_b64_tr_b16 v[200:201], v218 offset:5120
    ds_read_b64_tr_b16 v[202:203], v218 offset:5632
    v_mfma_f32_32x32x16_bf16 v[144:159], v[180:183], v[28:31], v[144:159]
    ds_read_b64_tr_b16 v[204:205], v218 offset:33792
    ds_read_b64_tr_b16 v[206:207], v218 offset:34304
    v_mfma_f32_32x32x16_bf16 v[160:175], v[184:187], v[28:31], v[160:175]
    ds_read_b64_tr_b16 v[208:209], v219 offset:5120
    ds_read_b64_tr_b16 v[210:211], v219 offset:5632
    s_waitcnt lgkmcnt(6)
    v_mfma_f32_32x32x16_bf16 v[128:143], v[188:191], v[32:35], v[128:143]
    ds_read_b64_tr_b16 v[176:177], v218 offset:6144
    ds_read_b64_tr_b16 v[178:179], v218 offset:6656
    v_mfma_f32_32x32x16_bf16 v[144:159], v[192:195], v[32:35], v[144:159]
    ds_read_b64_tr_b16 v[180:181], v218 offset:34816
    ds_read_b64_tr_b16 v[182:183], v218 offset:35328
    v_mfma_f32_32x32x16_bf16 v[160:175], v[196:199], v[32:35], v[160:175]
    ds_read_b64_tr_b16 v[184:185], v219 offset:6144
    ds_read_b64_tr_b16 v[186:187], v219 offset:6656
    s_waitcnt lgkmcnt(6)
    v_mfma_f32_32x32x16_bf16 v[128:143], v[200:203], v[36:39], v[128:143]
    v_mfma_f32_32x32x16_bf16 v[144:159], v[204:207], v[36:39], v[144:159]
    v_mfma_f32_32x32x16_bf16 v[160:175], v[208:211], v[36:39], v[160:175]
    s_waitcnt lgkmcnt(0)
    v_mfma_f32_32x32x16_bf16 v[128:143], v[176:179], v[40:43], v[128:143]
    v_mfma_f32_32x32x16_bf16 v[144:159], v[180:183], v[40:43], v[144:159]
    v_mfma_f32_32x32x16_bf16 v[160:175], v[184:187], v[40:43], v[160:175]
    s_waitcnt vmcnt(8)
    v_xor_b32 v13, 0, v12
    ds_read_b64 v[44:45], v13 offset:8192
    v_xor_b32 v14, 16, v12
    ds_read_b64 v[46:47], v14 offset:8192
    v_xor_b32 v13, 32, v12
    ds_read_b64 v[48:49], v13 offset:8192
    v_xor_b32 v14, 48, v12
    ds_read_b64 v[50:51], v14 offset:8192
    v_xor_b32 v13, 64, v12
    ds_read_b64 v[52:53], v13 offset:8192
    v_xor_b32 v14, 80, v12
    ds_read_b64 v[54:55], v14 offset:8192
    v_xor_b32 v13, 96, v12
    ds_read_b64 v[56:57], v13 offset:8192
    v_xor_b32 v14, 112, v12
    ds_read_b64 v[58:59], v14 offset:8192
    v_xor_b32 v13, 128, v12
    ds_read_b64 v[60:61], v13 offset:8192
    v_xor_b32 v14, 144, v12
    ds_read_b64 v[62:63], v14 offset:8192
    v_xor_b32 v13, 160, v12
    ds_read_b64 v[64:65], v13 offset:8192
    v_xor_b32 v14, 176, v12
    ds_read_b64 v[66:67], v14 offset:8192
    v_xor_b32 v13, 192, v12
    ds_read_b64 v[68:69], v13 offset:8192
    v_xor_b32 v14, 208, v12
    ds_read_b64 v[70:71], v14 offset:8192
    s_waitcnt lgkmcnt(0)
    s_add_u32 m0, s47, 8192
    s_add_u32 s42, s46, 672
    buffer_load_dwordx4 v8, s[4:7], s42 offen lds
    s_add_u32 m0, m0, 1024
    s_add_u32 s42, s46, 7840
    buffer_load_dwordx4 v9, s[4:7], s42 offen lds
    s_add_u32 m0, m0, 1024
    s_add_u32 s42, s46, 4256
    buffer_load_dwordx4 v10, s[4:7], s42 offen lds
    s_add_u32 m0, m0, 1024
    s_add_u32 s42, s46, 11424
    buffer_load_dwordx4 v11, s[4:7], s42 offen lds
    s_add_u32 m0, m0, 1024
    s_add_u32 s42, s46, 15008
    buffer_load_dwordx4 v8, s[4:7], s42 offen lds
    s_add_u32 m0, m0, 1024
    s_add_u32 s42, s46, 22176
    buffer_load_dwordx4 v9, s[4:7], s42 offen lds
    s_add_u32 m0, m0, 1024
    s_add_u32 s42, s46, 18592
    buffer_load_dwordx4 v10, s[4:7], s42 offen lds
    s_add_u32 m0, m0, 1024
    s_add_u32 s42, s46, 25760
    buffer_load_dwordx4 v11, s[4:7], s42 offen lds
    v_dot2_f32_bf16 v232, v44, v44, v232
    v_dot2_f32_bf16 v233, v45, v45, v233
    v_dot2_f32_bf16 v234, v46, v46, v234
    v_dot2_f32_bf16 v235, v47, v47, v235
    v_dot2_f32_bf16 v232, v48, v48, v232
    v_dot2_f32_bf16 v233, v49, v49, v233
    v_dot2_f32_bf16 v234, v50, v50, v234
    v_dot2_f32_bf16 v235, v51, v51, v235
    v_dot2_f32_bf16 v232, v52, v52, v232
    v_dot2_f32_bf16 v233, v53, v53, v233
    v_dot2_f32_bf16 v234, v54, v54, v234
    v_dot2_f32_bf16 v235, v55, v55, v235
    v_dot2_f32_bf16 v232, v56, v56, v232
    v_dot2_f32_bf16 v233, v57, v57, v233
    v_dot2_f32_bf16 v234, v58, v58, v234
    v_dot2_f32_bf16 v235, v59, v59, v235
    v_dot2_f32_bf16 v232, v60, v60, v232
    v_dot2_f32_bf16 v233, v61, v61, v233
    v_dot2_f32_bf16 v234, v62, v62, v234
    v_dot2_f32_bf16 v235, v63, v63, v235
    v_dot2_f32_bf16 v232, v64, v64, v232
    v_dot2_f32_bf16 v233, v65, v65, v233
    v_dot2_f32_bf16 v234, v66, v66, v234
    v_dot2_f32_bf16 v235, v67, v67, v235
    v_dot2_f32_bf16 v232, v68, v68, v232
    v_dot2_f32_bf16 v233, v69, v69, v233
    v_dot2_f32_bf16 v234, v70, v70, v234
    v_dot2_f32_bf16 v235, v71, v71, v235
    ds_read_b64_tr_b16 v[176:177], v218 offset:7168
    ds_read_b64_tr_b16 v[178:179], v218 offset:7680
    ds_read_b64_tr_b16 v[180:181], v218 offset:35840
    ds_read_b64_tr_b16 v[182:183], v218 offset:36352
    ds_read_b64_tr_b16 v[184:185], v219 offset:7168
    ds_read_b64_tr_b16 v[186:187], v219 offset:7680
    ds_read_b64_tr_b16 v[188:189], v218 offset:8192
    ds_read_b64_tr_b16 v[190:191], v218 offset:8704
    ds_read_b64_tr_b16 v[192:193], v218 offset:36864
    ds_read_b64_tr_b16 v[194:195], v218 offset:37376
    ds_read_b64_tr_b16 v[196:197], v219 offset:8192
    ds_read_b64_tr_b16 v[198:199], v219 offset:8704
    s_waitcnt lgkmcnt(6)
    v_mfma_f32_32x32x16_bf16 v[128:143], v[176:179], v[44:47], v[128:143]
    ds_read_b64_tr_b16 v[200:201], v218 offset:9216
    ds_read_b64_tr_b16 v[202:203], v218 offset:9728
    v_mfma_f32_32x32x16_bf16 v[144:159], v[180:183], v[44:47], v[144:159]
    ds_read_b64_tr_b16 v[204:205], v218 offset:37888
    ds_read_b64_tr_b16 v[206:207], v218 offset:38400
    v_mfma_f32_32x32x16_bf16 v[160:175], v[184:187], v[44:47], v[160:175]
    ds_read_b64_tr_b16 v[208:209], v219 offset:9216
    ds_read_b64_tr_b16 v[210:211], v219 offset:9728
    s_waitcnt lgkmcnt(6)
    v_mfma_f32_32x32x16_bf16 v[128:143], v[188:191], v[48:51], v[128:143]
    ds_read_b64_tr_b16 v[176:177], v218 offset:10240
    ds_read_b64_tr_b16 v[178:179], v218 offset:10752
    v_mfma_f32_32x32x16_bf16 v[144:159], v[192:195], v[48:51], v[144:159]
    ds_read_b64_tr_b16 v[180:181], v218 offset:38912
    ds_read_b64_tr_b16 v[182:183], v218 offset:39424
    v_mfma_f32_32x32x16_bf16 v[160:175], v[196:199], v[48:51], v[160:175]
    ds_read_b64_tr_b16 v[184:185], v219 offset:10240
    ds_read_b64_tr_b16 v[186:187], v219 offset:10752
    s_waitcnt lgkmcnt(6)
    v_mfma_f32_32x32x16_bf16 v[128:143], v[200:203], v[52:55], v[128:143]
    ds_read_b64_tr_b16 v[188:189], v218 offset:11264
    ds_read_b64_tr_b16 v[190:191], v218 offset:11776
    v_mfma_f32_32x32x16_bf16 v[144:159], v[204:207], v[52:55], v[144:159]
    ds_read_b64_tr_b16 v[192:193], v218 offset:39936
    ds_read_b64_tr_b16 v[194:195], v218 offset:40448
    v_mfma_f32_32x32x16_bf16 v[160:175], v[208:211], v[52:55], v[160:175]
    ds_read_b64_tr_b16 v[196:197], v219 offset:11264
    ds_read_b64_tr_b16 v[198:199], v219 offset:11776
    s_waitcnt lgkmcnt(6)
    v_mfma_f32_32x32x16_bf16 v[128:143], v[176:179], v[56:59], v[128:143]
    ds_read_b64_tr_b16 v[200:201], v218 offset:12288
    ds_read_b64_tr_b16 v[202:203], v218 offset:12800
    v_mfma_f32_32x32x16_bf16 v[144:159], v[180:183], v[56:59], v[144:159]
    ds_read_b64_tr_b16 v[204:205], v218 offset:40960
    ds_read_b64_tr_b16 v[206:207], v218 offset:41472
    v_mfma_f32_32x32x16_bf16 v[160:175], v[184:187], v[56:59], v[160:175]
    ds_read_b64_tr_b16 v[208:209], v219 offset:12288
    ds_read_b64_tr_b16 v[210:211], v219 offset:12800
    s_waitcnt lgkmcnt(6)
    v_mfma_f32_32x32x16_bf16 v[128:143], v[188:191], v[60:63], v[128:143]
    ds_read_b64_tr_b16 v[176:177], v218 offset:13312
    ds_read_b64_tr_b16 v[178:179], v218 offset:13824
    v_mfma_f32_32x32x16_bf16 v[144:159], v[192:195], v[60:63], v[144:159]
    ds_read_b64_tr_b16 v[180:181], v218 offset:41984
    ds_read_b64_tr_b16 v[182:183], v218 offset:42496
    v_mfma_f32_32x32x16_bf16 v[160:175], v[196:199], v[60:63], v[160:175]
    ds_read_b64_tr_b16 v[184:185], v219 offset:13312
    ds_read_b64_tr_b16 v[186:187], v219 offset:13824
    s_waitcnt lgkmcnt(6)
    v_mfma_f32_32x32x16_bf16 v[128:143], v[200:203], v[64:67], v[128:143]
    v_mfma_f32_32x32x16_bf16 v[144:159], v[204:207], v[64:67], v[144:159]
    v_mfma_f32_32x32x16_bf16 v[160:175], v[208:211], v[64:67], v[160:175]
    s_waitcnt lgkmcnt(0)
    v_mfma_f32_32x32x16_bf16 v[128:143], v[176:179], v[68:71], v[128:143]
    v_mfma_f32_32x32x16_bf16 v[144:159], v[180:183], v[68:71], v[144:159]
    v_mfma_f32_32x32x16_bf16 v[160:175], v[184:187], v[68:71], v[160:175]
    s_waitcnt vmcnt(8)
    v_xor_b32 v13, 0, v12
    ds_read_b64 v[72:73], v13 offset:0
    v_xor_b32 v14, 16, v12
    ds_read_b64 v[74:75], v14 offset:0
    v_xor_b32 v13, 32, v12
    ds_read_b64 v[76:77], v13 offset:0
    v_xor_b32 v14, 48, v12
    ds_read_b64 v[78:79], v14 offset:0
    v_xor_b32 v13, 64, v12
    ds_read_b64 v[80:81], v13 offset:0
    v_xor_b32 v14, 80, v12
    ds_read_b64 v[82:83], v14 offset:0
    v_xor_b32 v13, 96, v12
    ds_read_b64 v[84:85], v13 offset:0
    v_xor_b32 v14, 112, v12
    ds_read_b64 v[86:87], v14 offset:0
    v_xor_b32 v13, 128, v12
    ds_read_b64 v[88:89], v13 offset:0
    v_xor_b32 v14, 144, v12
    ds_read_b64 v[90:91], v14 offset:0
    v_xor_b32 v13, 160, v12
    ds_read_b64 v[92:93], v13 offset:0
    v_xor_b32 v14, 176, v12
    ds_read_b64 v[94:95], v14 offset:0
    v_xor_b32 v13, 192, v12
    ds_read_b64 v[96:97], v13 offset:0
    v_xor_b32 v14, 208, v12
    ds_read_b64 v[98:99], v14 offset:0
    s_waitcnt lgkmcnt(0)
    v_dot2_f32_bf16 v232, v72, v72, v232
    v_dot2_f32_bf16 v233, v73, v73, v233
    v_dot2_f32_bf16 v234, v74, v74, v234
    v_dot2_f32_bf16 v235, v75, v75, v235
    v_dot2_f32_bf16 v232, v76, v76, v232
    v_dot2_f32_bf16 v233, v77, v77, v233
    v_dot2_f32_bf16 v234, v78, v78, v234
    v_dot2_f32_bf16 v235, v79, v79, v235
    v_dot2_f32_bf16 v232, v80, v80, v232
    v_dot2_f32_bf16 v233, v81, v81, v233
    v_dot2_f32_bf16 v234, v82, v82, v234
    v_dot2_f32_bf16 v235, v83, v83, v235
    v_dot2_f32_bf16 v232, v84, v84, v232
    v_dot2_f32_bf16 v233, v85, v85, v233
    v_dot2_f32_bf16 v234, v86, v86, v234
    v_dot2_f32_bf16 v235, v87, v87, v235
    v_dot2_f32_bf16 v232, v88, v88, v232
    v_dot2_f32_bf16 v233, v89, v89, v233
    v_dot2_f32_bf16 v234, v90, v90, v234
    v_dot2_f32_bf16 v235, v91, v91, v235
    v_dot2_f32_bf16 v232, v92, v92, v232
    v_dot2_f32_bf16 v233, v93, v93, v233
    v_dot2_f32_bf16 v234, v94, v94, v234
    v_dot2_f32_bf16 v235, v95, v95, v235
    v_dot2_f32_bf16 v232, v96, v96, v232
    v_dot2_f32_bf16 v233, v97, v97, v233
    v_dot2_f32_bf16 v234, v98, v98, v234
    v_dot2_f32_bf16 v235, v99, v99, v235
    ds_read_b64_tr_b16 v[176:177], v218 offset:14336
    ds_read_b64_tr_b16 v[178:179], v218 offset:14848
    ds_read_b64_tr_b16 v[180:181], v218 offset:43008
    ds_read_b64_tr_b16 v[182:183], v218 offset:43520
    ds_read_b64_tr_b16 v[184:185], v219 offset:14336
    ds_read_b64_tr_b16 v[186:187], v219 offset:14848
    ds_read_b64_tr_b16 v[188:189], v218 offset:15360
    ds_read_b64_tr_b16 v[190:191], v218 offset:15872
    ds_read_b64_tr_b16 v[192:193], v218 offset:44032
    ds_read_b64_tr_b16 v[194:195], v218 offset:44544
    ds_read_b64_tr_b16 v[196:197], v219 offset:15360
    ds_read_b64_tr_b16 v[198:199], v219 offset:15872
    s_waitcnt lgkmcnt(6)
    v_mfma_f32_32x32x16_bf16 v[128:143], v[176:179], v[72:75], v[128:143]
    ds_read_b64_tr_b16 v[200:201], v218 offset:16384
    ds_read_b64_tr_b16 v[202:203], v218 offset:16896
    v_mfma_f32_32x32x16_bf16 v[144:159], v[180:183], v[72:75], v[144:159]
    ds_read_b64_tr_b16 v[204:205], v218 offset:45056
    ds_read_b64_tr_b16 v[206:207], v218 offset:45568
    v_mfma_f32_32x32x16_bf16 v[160:175], v[184:187], v[72:75], v[160:175]
    ds_read_b64_tr_b16 v[208:209], v219 offset:16384
    ds_read_b64_tr_b16 v[210:211], v219 offset:16896
    s_waitcnt lgkmcnt(6)
    v_mfma_f32_32x32x16_bf16 v[128:143], v[188:191], v[76:79], v[128:143]
    ds_read_b64_tr_b16 v[176:177], v218 offset:17408
    ds_read_b64_tr_b16 v[178:179], v218 offset:17920
    v_mfma_f32_32x32x16_bf16 v[144:159], v[192:195], v[76:79], v[144:159]
    ds_read_b64_tr_b16 v[180:181], v218 offset:46080
    ds_read_b64_tr_b16 v[182:183], v218 offset:46592
    v_mfma_f32_32x32x16_bf16 v[160:175], v[196:199], v[76:79], v[160:175]
    ds_read_b64_tr_b16 v[184:185], v219 offset:17408
    ds_read_b64_tr_b16 v[186:187], v219 offset:17920
    s_waitcnt lgkmcnt(6)
    v_mfma_f32_32x32x16_bf16 v[128:143], v[200:203], v[80:83], v[128:143]
    ds_read_b64_tr_b16 v[188:189], v218 offset:18432
    ds_read_b64_tr_b16 v[190:191], v218 offset:18944
    v_mfma_f32_32x32x16_bf16 v[144:159], v[204:207], v[80:83], v[144:159]
    ds_read_b64_tr_b16 v[192:193], v218 offset:47104
    ds_read_b64_tr_b16 v[194:195], v218 offset:47616
    v_mfma_f32_32x32x16_bf16 v[160:175], v[208:211], v[80:83], v[160:175]
    ds_read_b64_tr_b16 v[196:197], v219 offset:18432
    ds_read_b64_tr_b16 v[198:199], v219 offset:18944
    s_waitcnt lgkmcnt(6)
    v_mfma_f32_32x32x16_bf16 v[128:143], v[176:179], v[84:87], v[128:143]
    ds_read_b64_tr_b16 v[200:201], v218 offset:19456
    ds_read_b64_tr_b16 v[202:203], v218 offset:19968
    v_mfma_f32_32x32x16_bf16 v[144:159], v[180:183], v[84:87], v[144:159]
    ds_read_b64_tr_b16 v[204:205], v218 offset:48128
    ds_read_b64_tr_b16 v[206:207], v218 offset:48640
    v_mfma_f32_32x32x16_bf16 v[160:175], v[184:187], v[84:87], v[160:175]
    ds_read_b64_tr_b16 v[208:209], v219 offset:19456
    ds_read_b64_tr_b16 v[210:211], v219 offset:19968
    s_waitcnt lgkmcnt(6)
    v_mfma_f32_32x32x16_bf16 v[128:143], v[188:191], v[88:91], v[128:143]
    ds_read_b64_tr_b16 v[176:177], v218 offset:20480
    ds_read_b64_tr_b16 v[178:179], v218 offset:20992
    v_mfma_f32_32x32x16_bf16 v[144:159], v[192:195], v[88:91], v[144:159]
    ds_read_b64_tr_b16 v[180:181], v218 offset:49152
    ds_read_b64_tr_b16 v[182:183], v218 offset:49664
    v_mfma_f32_32x32x16_bf16 v[160:175], v[196:199], v[88:91], v[160:175]
    ds_read_b64_tr_b16 v[184:185], v219 offset:20480
    ds_read_b64_tr_b16 v[186:187], v219 offset:20992
    s_waitcnt lgkmcnt(6)
    v_mfma_f32_32x32x16_bf16 v[128:143], v[200:203], v[92:95], v[128:143]
    v_mfma_f32_32x32x16_bf16 v[144:159], v[204:207], v[92:95], v[144:159]
    v_mfma_f32_32x32x16_bf16 v[160:175], v[208:211], v[92:95], v[160:175]
    s_waitcnt lgkmcnt(0)
    v_mfma_f32_32x32x16_bf16 v[128:143], v[176:179], v[96:99], v[128:143]
    v_mfma_f32_32x32x16_bf16 v[144:159], v[180:183], v[96:99], v[144:159]
    v_mfma_f32_32x32x16_bf16 v[160:175], v[184:187], v[96:99], v[160:175]
    s_waitcnt vmcnt(0)
    v_xor_b32 v13, 0, v12
    ds_read_b64 v[100:101], v13 offset:8192
    v_xor_b32 v14, 16, v12
    ds_read_b64 v[102:103], v14 offset:8192
    v_xor_b32 v13, 32, v12
    ds_read_b64 v[104:105], v13 offset:8192
    v_xor_b32 v14, 48, v12
    ds_read_b64 v[106:107], v14 offset:8192
    v_xor_b32 v13, 64, v12
    ds_read_b64 v[108:109], v13 offset:8192
    v_xor_b32 v14, 80, v12
    ds_read_b64 v[110:111], v14 offset:8192
    v_xor_b32 v13, 96, v12
    ds_read_b64 v[112:113], v13 offset:8192
    v_xor_b32 v14, 112, v12
    ds_read_b64 v[114:115], v14 offset:8192
    v_xor_b32 v13, 128, v12
    ds_read_b64 v[116:117], v13 offset:8192
    v_xor_b32 v14, 144, v12
    ds_read_b64 v[118:119], v14 offset:8192
    v_xor_b32 v13, 160, v12
    ds_read_b64 v[120:121], v13 offset:8192
    v_xor_b32 v14, 176, v12
    ds_read_b64 v[122:123], v14 offset:8192
    v_xor_b32 v13, 192, v12
    ds_read_b64 v[124:125], v13 offset:8192
    v_xor_b32 v14, 208, v12
    ds_read_b64 v[126:127], v14 offset:8192
    s_waitcnt lgkmcnt(0)
    v_dot2_f32_bf16 v232, v100, v100, v232
    v_dot2_f32_bf16 v233, v101, v101, v233
    v_dot2_f32_bf16 v234, v102, v102, v234
    v_dot2_f32_bf16 v235, v103, v103, v235
    v_dot2_f32_bf16 v232, v104, v104, v232
    v_dot2_f32_bf16 v233, v105, v105, v233
    v_dot2_f32_bf16 v234, v106, v106, v234
    v_dot2_f32_bf16 v235, v107, v107, v235
    v_dot2_f32_bf16 v232, v108, v108, v232
    v_dot2_f32_bf16 v233, v109, v109, v233
    v_dot2_f32_bf16 v234, v110, v110, v234
    v_dot2_f32_bf16 v235, v111, v111, v235
    v_dot2_f32_bf16 v232, v112, v112, v232
    v_dot2_f32_bf16 v233, v113, v113, v233
    v_dot2_f32_bf16 v234, v114, v114, v234
    v_dot2_f32_bf16 v235, v115, v115, v235
    v_dot2_f32_bf16 v232, v116, v116, v232
    v_dot2_f32_bf16 v233, v117, v117, v233
    v_dot2_f32_bf16 v234, v118, v118, v234
    v_dot2_f32_bf16 v235, v119, v119, v235
    v_dot2_f32_bf16 v232, v120, v120, v232
    v_dot2_f32_bf16 v233, v121, v121, v233
    v_dot2_f32_bf16 v234, v122, v122, v234
    v_dot2_f32_bf16 v235, v123, v123, v235
    v_dot2_f32_bf16 v232, v124, v124, v232
    v_dot2_f32_bf16 v233, v125, v125, v233
    v_dot2_f32_bf16 v234, v126, v126, v234
    v_dot2_f32_bf16 v235, v127, v127, v235
    ds_read_b64_tr_b16 v[176:177], v218 offset:21504
    ds_read_b64_tr_b16 v[178:179], v218 offset:22016
    ds_read_b64_tr_b16 v[180:181], v218 offset:50176
    ds_read_b64_tr_b16 v[182:183], v218 offset:50688
    ds_read_b64_tr_b16 v[184:185], v219 offset:21504
    ds_read_b64_tr_b16 v[186:187], v219 offset:22016
    ds_read_b64_tr_b16 v[188:189], v218 offset:22528
    ds_read_b64_tr_b16 v[190:191], v218 offset:23040
    ds_read_b64_tr_b16 v[192:193], v218 offset:51200
    ds_read_b64_tr_b16 v[194:195], v218 offset:51712
    ds_read_b64_tr_b16 v[196:197], v219 offset:22528
    ds_read_b64_tr_b16 v[198:199], v219 offset:23040
    s_waitcnt lgkmcnt(6)
    v_mfma_f32_32x32x16_bf16 v[128:143], v[176:179], v[100:103], v[128:143]
    ds_read_b64_tr_b16 v[200:201], v218 offset:23552
    ds_read_b64_tr_b16 v[202:203], v218 offset:24064
    v_mfma_f32_32x32x16_bf16 v[144:159], v[180:183], v[100:103], v[144:159]
    ds_read_b64_tr_b16 v[204:205], v218 offset:52224
    ds_read_b64_tr_b16 v[206:207], v218 offset:52736
    v_mfma_f32_32x32x16_bf16 v[160:175], v[184:187], v[100:103], v[160:175]
    ds_read_b64_tr_b16 v[208:209], v219 offset:23552
    ds_read_b64_tr_b16 v[210:211], v219 offset:24064
    s_waitcnt lgkmcnt(6)
    v_mfma_f32_32x32x16_bf16 v[128:143], v[188:191], v[104:107], v[128:143]
    ds_read_b64_tr_b16 v[176:177], v218 offset:24576
    ds_read_b64_tr_b16 v[178:179], v218 offset:25088
    v_mfma_f32_32x32x16_bf16 v[144:159], v[192:195], v[104:107], v[144:159]
    ds_read_b64_tr_b16 v[180:181], v218 offset:53248
    ds_read_b64_tr_b16 v[182:183], v218 offset:53760
    v_mfma_f32_32x32x16_bf16 v[160:175], v[196:199], v[104:107], v[160:175]
    ds_read_b64_tr_b16 v[184:185], v219 offset:24576
    ds_read_b64_tr_b16 v[186:187], v219 offset:25088
    s_waitcnt lgkmcnt(6)
    v_mfma_f32_32x32x16_bf16 v[128:143], v[200:203], v[108:111], v[128:143]
    ds_read_b64_tr_b16 v[188:189], v218 offset:25600
    ds_read_b64_tr_b16 v[190:191], v218 offset:26112
    v_mfma_f32_32x32x16_bf16 v[144:159], v[204:207], v[108:111], v[144:159]
    ds_read_b64_tr_b16 v[192:193], v218 offset:54272
    ds_read_b64_tr_b16 v[194:195], v218 offset:54784
    v_mfma_f32_32x32x16_bf16 v[160:175], v[208:211], v[108:111], v[160:175]
    ds_read_b64_tr_b16 v[196:197], v219 offset:25600
    ds_read_b64_tr_b16 v[198:199], v219 offset:26112
    s_waitcnt lgkmcnt(6)
    v_mfma_f32_32x32x16_bf16 v[128:143], v[176:179], v[112:115], v[128:143]
    ds_read_b64_tr_b16 v[200:201], v218 offset:26624
    ds_read_b64_tr_b16 v[202:203], v218 offset:27136
    v_mfma_f32_32x32x16_bf16 v[144:159], v[180:183], v[112:115], v[144:159]
    ds_read_b64_tr_b16 v[204:205], v218 offset:55296
    ds_read_b64_tr_b16 v[206:207], v218 offset:55808
    v_mfma_f32_32x32x16_bf16 v[160:175], v[184:187], v[112:115], v[160:175]
    ds_read_b64_tr_b16 v[208:209], v219 offset:26624
    ds_read_b64_tr_b16 v[210:211], v219 offset:27136
    s_waitcnt lgkmcnt(6)
    v_mfma_f32_32x32x16_bf16 v[128:143], v[188:191], v[116:119], v[128:143]
    ds_read_b64_tr_b16 v[176:177], v218 offset:27648
    ds_read_b64_tr_b16 v[178:179], v218 offset:28160
    v_mfma_f32_32x32x16_bf16 v[144:159], v[192:195], v[116:119], v[144:159]
    ds_read_b64_tr_b16 v[180:181], v218 offset:56320
    ds_read_b64_tr_b16 v[182:183], v218 offset:56832
    v_mfma_f32_32x32x16_bf16 v[160:175], v[196:199], v[116:119], v[160:175]
    ds_read_b64_tr_b16 v[184:185], v219 offset:27648
    ds_read_b64_tr_b16 v[186:187], v219 offset:28160
    s_waitcnt lgkmcnt(6)
    v_mfma_f32_32x32x16_bf16 v[128:143], v[200:203], v[120:123], v[128:143]
    v_mfma_f32_32x32x16_bf16 v[144:159], v[204:207], v[120:123], v[144:159]
    v_mfma_f32_32x32x16_bf16 v[160:175], v[208:211], v[120:123], v[160:175]
    s_waitcnt lgkmcnt(0)
    v_mfma_f32_32x32x16_bf16 v[128:143], v[176:179], v[124:127], v[128:143]
    v_mfma_f32_32x32x16_bf16 v[144:159], v[180:183], v[124:127], v[144:159]
    v_mfma_f32_32x32x16_bf16 v[160:175], v[184:187], v[124:127], v[160:175]
    v_add_f32 v232, v232, v233
    v_add_f32 v234, v234, v235
    v_add_f32 v232, v232, v234
    v_mov_b32 v216, v232
    s_nop 1
    v_permlane32_swap_b32 v232, v216
    s_nop 1
    v_add_f32 v232, v232, v216
    s_nop 3
    v_mov_b32 v228, v140
    v_mov_b32 v229, v140
    s_nop 1
    v_permlane32_swap_b32 v228, v229
    s_nop 0
    v_mul_f32 v229, 0x3b124925, v229
    v_mul_f32 v232, 0x3b124925, v232
    v_fma_f32 v232, -v229, v229, v232
    v_max_f32 v232, 0, v232
    v_add_f32 v232, 0x3727c5ac, v232
    v_rsq_f32 v212, v232
    s_nop 0
    v_mul_f32 v214, v229, v212
    s_barrier
    ds_read_b128 v[16:19], v220 offset:256
    ds_read_b128 v[20:23], v220 offset:288
    ds_read_b128 v[24:27], v220 offset:320
    ds_read_b128 v[28:31], v220 offset:352
    ds_read_b128 v[32:35], v220 offset:128
    ds_read_b128 v[36:39], v220 offset:160
    ds_read_b128 v[40:43], v220 offset:192
    ds_read_b128 v[44:47], v220 offset:224
    ds_read_b128 v[48:51], v220 offset:0
    ds_read_b128 v[52:55], v220 offset:32
    ds_read_b128 v[56:59], v220 offset:64
    ds_read_b128 v[60:63], v220 offset:96
    s_lshl_b32 s40, s17, 6
    s_add_u32 s40, s40, s50
    s_lshl_b32 s40, s40, 11
    s_mul_i32 s41, s19, 2097152
    s_add_u32 s41, s41, 9437184
    s_add_u32 s41, s41, s40
    s_mul_i32 s42, s19, 2097152
    s_add_u32 s42, s42, 13631488
    s_add_u32 s42, s42, s40
    s_waitcnt lgkmcnt(8)
    v_pk_mul_f32 v[16:17], v[16:17], v[214:215] op_sel_hi:[1,0]
    v_pk_mul_f32 v[18:19], v[18:19], v[214:215] op_sel_hi:[1,0]
    v_pk_mul_f32 v[20:21], v[20:21], v[214:215] op_sel_hi:[1,0]
    v_pk_mul_f32 v[22:23], v[22:23], v[214:215] op_sel_hi:[1,0]
    v_pk_mul_f32 v[24:25], v[24:25], v[214:215] op_sel_hi:[1,0]
    v_pk_mul_f32 v[26:27], v[26:27], v[214:215] op_sel_hi:[1,0]
    v_pk_mul_f32 v[28:29], v[28:29], v[214:215] op_sel_hi:[1,0]
    v_pk_mul_f32 v[30:31], v[30:31], v[214:215] op_sel_hi:[1,0]
    v_pk_fma_f32 v[160:161], v[160:161], v[212:213], v[16:17] op_sel_hi:[1,0,1] neg_lo:[0,0,1] neg_hi:[0,0,1]
    v_pk_fma_f32 v[162:163], v[162:163], v[212:213], v[18:19] op_sel_hi:[1,0,1] neg_lo:[0,0,1] neg_hi:[0,0,1]
    v_pk_fma_f32 v[164:165], v[164:165], v[212:213], v[20:21] op_sel_hi:[1,0,1] neg_lo:[0,0,1] neg_hi:[0,0,1]
    v_pk_fma_f32 v[166:167], v[166:167], v[212:213], v[22:23] op_sel_hi:[1,0,1] neg_lo:[0,0,1] neg_hi:[0,0,1]
    v_pk_fma_f32 v[168:169], v[168:169], v[212:213], v[24:25] op_sel_hi:[1,0,1] neg_lo:[0,0,1] neg_hi:[0,0,1]
    v_pk_fma_f32 v[170:171], v[170:171], v[212:213], v[26:27] op_sel_hi:[1,0,1] neg_lo:[0,0,1] neg_hi:[0,0,1]
    v_pk_fma_f32 v[172:173], v[172:173], v[212:213], v[28:29] op_sel_hi:[1,0,1] neg_lo:[0,0,1] neg_hi:[0,0,1]
    v_pk_fma_f32 v[174:175], v[174:175], v[212:213], v[30:31] op_sel_hi:[1,0,1] neg_lo:[0,0,1] neg_hi:[0,0,1]
    s_mov_b32 exec_lo, 0
    v_mov_b32 v172, 1.0
    v_mov_b32 v173, 0
    v_mov_b32 v174, 0
    v_mov_b32 v175, 0
    s_mov_b64 exec, -1
    v_cvt_pk_bf16_f32 v184, v160, v161
    v_cvt_pk_bf16_f32 v185, v162, v163
    v_cvt_pk_bf16_f32 v186, v164, v165
    v_cvt_pk_bf16_f32 v187, v166, v167
    v_cvt_pk_bf16_f32 v188, v168, v169
    v_cvt_pk_bf16_f32 v189, v170, v171
    v_cvt_pk_bf16_f32 v190, v172, v173
    v_cvt_pk_bf16_f32 v191, v174, v175
    s_nop 1
    v_mfma_f32_32x32x16_bf16 v[160:175], v[184:187], v[240:243], 0
    v_mfma_f32_32x32x16_bf16 v[160:175], v[188:191], v[244:247], v[160:175]
    s_waitcnt lgkmcnt(0)
    v_pk_mul_f32 v[32:33], v[32:33], v[214:215] op_sel_hi:[1,0]
    v_pk_mul_f32 v[34:35], v[34:35], v[214:215] op_sel_hi:[1,0]
    v_pk_mul_f32 v[36:37], v[36:37], v[214:215] op_sel_hi:[1,0]
    v_pk_mul_f32 v[38:39], v[38:39], v[214:215] op_sel_hi:[1,0]
    v_pk_mul_f32 v[40:41], v[40:41], v[214:215] op_sel_hi:[1,0]
    v_pk_mul_f32 v[42:43], v[42:43], v[214:215] op_sel_hi:[1,0]
    v_pk_mul_f32 v[44:45], v[44:45], v[214:215] op_sel_hi:[1,0]
    v_pk_mul_f32 v[46:47], v[46:47], v[214:215] op_sel_hi:[1,0]
    v_pk_fma_f32 v[144:145], v[144:145], v[212:213], v[32:33] op_sel_hi:[1,0,1] neg_lo:[0,0,1] neg_hi:[0,0,1]
    v_pk_fma_f32 v[146:147], v[146:147], v[212:213], v[34:35] op_sel_hi:[1,0,1] neg_lo:[0,0,1] neg_hi:[0,0,1]
    v_pk_fma_f32 v[148:149], v[148:149], v[212:213], v[36:37] op_sel_hi:[1,0,1] neg_lo:[0,0,1] neg_hi:[0,0,1]
    v_pk_fma_f32 v[150:151], v[150:151], v[212:213], v[38:39] op_sel_hi:[1,0,1] neg_lo:[0,0,1] neg_hi:[0,0,1]
    v_pk_fma_f32 v[152:153], v[152:153], v[212:213], v[40:41] op_sel_hi:[1,0,1] neg_lo:[0,0,1] neg_hi:[0,0,1]
    v_pk_fma_f32 v[154:155], v[154:155], v[212:213], v[42:43] op_sel_hi:[1,0,1] neg_lo:[0,0,1] neg_hi:[0,0,1]
    v_pk_fma_f32 v[156:157], v[156:157], v[212:213], v[44:45] op_sel_hi:[1,0,1] neg_lo:[0,0,1] neg_hi:[0,0,1]
    v_pk_fma_f32 v[158:159], v[158:159], v[212:213], v[46:47] op_sel_hi:[1,0,1] neg_lo:[0,0,1] neg_hi:[0,0,1]
    s_mov_b32 exec_lo, 0
    v_mov_b32 v156, 0
    v_mov_b32 v157, 0
    v_mov_b32 v158, 0
    v_mov_b32 v159, 0
    s_mov_b64 exec, -1
    v_cvt_pk_bf16_f32 v192, v144, v145
    v_cvt_pk_bf16_f32 v193, v146, v147
    v_cvt_pk_bf16_f32 v194, v148, v149
    v_cvt_pk_bf16_f32 v195, v150, v151
    v_cvt_pk_bf16_f32 v196, v152, v153
    v_cvt_pk_bf16_f32 v197, v154, v155
    v_cvt_pk_bf16_f32 v198, v156, v157
    v_cvt_pk_bf16_f32 v199, v158, v159
    buffer_store_dwordx4 v[192:195], v0, s[8:11], s41 offen offset:0 sc1
    buffer_store_dwordx4 v[196:199], v0, s[8:11], s41 offen offset:1024 sc1
    v_cvt_pk_bf16_f32 v184, v160, v161
    v_cvt_pk_bf16_f32 v185, v162, v163
    v_cvt_pk_bf16_f32 v186, v164, v165
    v_cvt_pk_bf16_f32 v187, v166, v167
    v_cvt_pk_bf16_f32 v188, v168, v169
    v_cvt_pk_bf16_f32 v189, v170, v171
    v_cvt_pk_bf16_f32 v190, v172, v173
    v_cvt_pk_bf16_f32 v191, v174, v175
    buffer_store_dwordx4 v[184:187], v0, s[8:11], s42 offen offset:0 sc1
    buffer_store_dwordx4 v[188:191], v0, s[8:11], s42 offen offset:1024 sc1
    v_mul_f32 v214, 0x3e8b97f6, v214
    v_mul_f32 v212, 0x3e8b97f6, v212
    v_pk_mul_f32 v[48:49], v[48:49], v[214:215] op_sel_hi:[1,0]
    v_pk_mul_f32 v[50:51], v[50:51], v[214:215] op_sel_hi:[1,0]
    v_pk_mul_f32 v[52:53], v[52:53], v[214:215] op_sel_hi:[1,0]
    v_pk_mul_f32 v[54:55], v[54:55], v[214:215] op_sel_hi:[1,0]
    v_pk_mul_f32 v[56:57], v[56:57], v[214:215] op_sel_hi:[1,0]
    v_pk_mul_f32 v[58:59], v[58:59], v[214:215] op_sel_hi:[1,0]
    v_pk_mul_f32 v[60:61], v[60:61], v[214:215] op_sel_hi:[1,0]
    v_pk_mul_f32 v[62:63], v[62:63], v[214:215] op_sel_hi:[1,0]
    v_pk_fma_f32 v[128:129], v[128:129], v[212:213], v[48:49] op_sel_hi:[1,0,1] neg_lo:[0,0,1] neg_hi:[0,0,1]
    v_pk_fma_f32 v[130:131], v[130:131], v[212:213], v[50:51] op_sel_hi:[1,0,1] neg_lo:[0,0,1] neg_hi:[0,0,1]
    v_pk_fma_f32 v[132:133], v[132:133], v[212:213], v[52:53] op_sel_hi:[1,0,1] neg_lo:[0,0,1] neg_hi:[0,0,1]
    v_pk_fma_f32 v[134:135], v[134:135], v[212:213], v[54:55] op_sel_hi:[1,0,1] neg_lo:[0,0,1] neg_hi:[0,0,1]
    v_pk_fma_f32 v[136:137], v[136:137], v[212:213], v[56:57] op_sel_hi:[1,0,1] neg_lo:[0,0,1] neg_hi:[0,0,1]
    v_pk_fma_f32 v[138:139], v[138:139], v[212:213], v[58:59] op_sel_hi:[1,0,1] neg_lo:[0,0,1] neg_hi:[0,0,1]
    v_pk_fma_f32 v[140:141], v[140:141], v[212:213], v[60:61] op_sel_hi:[1,0,1] neg_lo:[0,0,1] neg_hi:[0,0,1]
    v_pk_fma_f32 v[142:143], v[142:143], v[212:213], v[62:63] op_sel_hi:[1,0,1] neg_lo:[0,0,1] neg_hi:[0,0,1]
    s_mov_b32 exec_lo, 0
    v_mov_b32 v140, 0
    v_mov_b32 v141, 0
    v_mov_b32 v142, 0
    v_mov_b32 v143, 0
    s_mov_b64 exec, -1
    v_cvt_pk_bf16_f32 v144, v128, v129
    v_cvt_pk_bf16_f32 v145, v130, v131
    v_cvt_pk_bf16_f32 v146, v132, v133
    v_cvt_pk_bf16_f32 v147, v134, v135
    v_cvt_pk_bf16_f32 v148, v136, v137
    v_cvt_pk_bf16_f32 v149, v138, v139
    v_cvt_pk_bf16_f32 v150, v140, v141
    v_cvt_pk_bf16_f32 v151, v142, v143
    s_lshl_b32 s41, s3, 11
    s_add_u32 s41, s41, 145408
    v_add_u32 v2, s41, v0
    ds_write_b128 v2, v[144:147]
    ds_write_b128 v2, v[148:151] offset:1024
    s_mul_i32 s57, s19, 32768
    s_add_u32 s57, s57, 0
    s_lshl_b32 s58, s16, 11
    s_add_u32 s57, s57, s58
    s_lshl_b32 s58, s17, 7
    s_add_u32 s57, s57, s58
    s_lshl_b32 s58, s19, 2
    s_add_u32 s58, s58, 162880
    v_mov_b32 v4, 1
    v_mov_b32 v5, s58
    s_waitcnt vmcnt(0)
    s_mov_b64 exec, 1
    ds_add_rtn_u32 v6, v5, v4
    v_mov_b32 v7, 0
    s_waitcnt lgkmcnt(0)
    v_readfirstlane_b32 s58, v6
    s_nop 0
    s_cmp_eq_u32 s58, 3
    s_cbranch_scc0 L_nosig_5
    buffer_store_dword v4, v7, s[8:11], s57 offen sc1
L_nosig_5:
    s_mov_b64 exec, -1
    s_load_dwordx2 s[52:53], s[0:1], 72
    v_lshlrev_b32 v6, 2, v1
    s_waitcnt lgkmcnt(0)
    s_mov_b32 s12, s52
    s_mov_b32 s13, s53
    s_mov_b32 s14, 256
    s_mov_b32 s15, 0x20000
    s_mov_b32 s59, s36
L_dbg_6:
    buffer_load_dword v7, v6, s[12:15], 0 offen sc1
    s_waitcnt vmcnt(0)
    v_subrev_u32 v8, 0x01010101, v7
    v_not_b32 v9, v7
    v_and_b32 v8, v8, v9
    v_and_b32 v8, 0x80808080, v8
    v_cmp_ne_u32 vcc, 0, v8
    s_cbranch_vccz L_dbgd_7
    s_sub_u32 s59, s59, 1
    s_cmp_lg_u32 s59, 0
    s_cbranch_scc1 L_dbg_6
    s_mov_b32 s36, 1
L_dbgd_7:
    s_getreg_b32 s55, hwreg(HW_REG_XCC_ID, 0, 4)
    s_add_u32 s55, s55, 1
    s_mul_i32 s55, s55, 0x01010101
    v_cmp_ne_u32 vcc, s55, v7
    s_lshl_b32 s54, s16, 2
    s_nop 0
    s_lshr_b64 vcc, vcc, s54
    s_and_b32 vcc_lo, vcc_lo, 15
    s_cmp_eq_u32 vcc_lo, 0
    s_cselect_b32 s39, 1, 0
    s_waitcnt lgkmcnt(0)
    s_branch L_qkv_join_4
L_qkv_helper_3:
    v_mov_b32 v4, 0
    v_lshlrev_b32 v3, 2, v1
    v_add_u32 v3, 162816, v3
    ds_write_b32 v3, v4
    s_cmp_eq_u32 s18, 0
    s_cbranch_scc0 L_init_w0_8
    v_mov_b32 v5, 0
    v_mov_b32 v6, 0
    v_mov_b32 v7, 0
    s_lshl_b32 s40, s16, 4
    s_add_u32 s40, s40, s17
    s_lshl_b32 s40, s40, 7
    v_lshlrev_b32 v3, 15, v1
    s_mov_b64 exec, 0x3fff
    buffer_store_dwordx4 v[4:7], v3, s[8:11], s40 offen sc1
    s_mov_b64 exec, -1
    s_cmp_lt_u32 s17, 14
    s_cbranch_scc0 L_init_w0_8
    s_mul_i32 s40, s16, 14
    s_add_u32 s40, s40, s17
    s_lshl_b32 s40, s40, 10
    s_add_u32 s40, s40, 38797312
    buffer_store_dwordx4 v[4:7], v0, s[8:11], s40 offen sc1
    s_add_u32 s40, s40, 0x40000
    buffer_store_dwordx4 v[4:7], v0, s[8:11], s40 offen sc1
L_init_w0_8:
    s_mov_b32 s4, s20
    s_mov_b32 s5, s21
    s_mov_b32 s6, 1204224
    s_mov_b32 s7, 0x20000
    v_lshrrev_b32 v3, 2, v1
    v_mul_u32_u24 v2, 2688, v3
    v_and_b32 v3, 3, v1
    v_lshlrev_b32 v3, 4, v3
    v_add_u32 v2, v2, v3
    s_mov_b32 s41, s3
    s_mul_i32 s42, s17, 56
    s_mul_i32 s40, s41, 43008
    s_add_u32 s42, s42, s40
    s_lshl_b32 s41, s41, 10
    s_mov_b32 m0, s41
    s_add_u32 s40, s42, 0
    buffer_load_dwordx4 v2, s[4:7], s40 offen lds
    s_add_u32 m0, m0, 4096
    s_add_u32 s40, s42, 172032
    buffer_load_dwordx4 v2, s[4:7], s40 offen lds
    s_add_u32 m0, m0, 4096
    s_add_u32 s40, s42, 344064
    buffer_load_dwordx4 v2, s[4:7], s40 offen lds
    s_add_u32 m0, m0, 4096
    s_add_u32 s40, s42, 516096
    buffer_load_dwordx4 v2, s[4:7], s40 offen lds
    s_add_u32 m0, m0, 4096
    s_add_u32 s40, s42, 688128
    buffer_load_dwordx4 v2, s[4:7], s40 offen lds
    s_add_u32 m0, m0, 4096
    s_add_u32 s40, s42, 860160
    buffer_load_dwordx4 v2, s[4:7], s40 offen lds
    s_add_u32 m0, m0, 4096
    s_add_u32 s40, s42, 1032192
    buffer_load_dwordx4 v2, s[4:7], s40 offen lds
    s_add_u32 m0, m0, 4096
    s_add_u32 s40, s42, 896
    buffer_load_dwordx4 v2, s[4:7], s40 offen lds
    s_add_u32 m0, m0, 4096
    s_add_u32 s40, s42, 172928
    buffer_load_dwordx4 v2, s[4:7], s40 offen lds
    s_add_u32 m0, m0, 4096
    s_add_u32 s40, s42, 344960
    buffer_load_dwordx4 v2, s[4:7], s40 offen lds
    s_add_u32 m0, m0, 4096
    s_add_u32 s40, s42, 516992
    buffer_load_dwordx4 v2, s[4:7], s40 offen lds
    s_add_u32 m0, m0, 4096
    s_add_u32 s40, s42, 689024
    buffer_load_dwordx4 v2, s[4:7], s40 offen lds
    s_add_u32 m0, m0, 4096
    s_add_u32 s40, s42, 861056
    buffer_load_dwordx4 v2, s[4:7], s40 offen lds
    s_add_u32 m0, m0, 4096
    s_add_u32 s40, s42, 1033088
    buffer_load_dwordx4 v2, s[4:7], s40 offen lds
    s_add_u32 m0, m0, 4096
    s_add_u32 s40, s42, 1792
    buffer_load_dwordx4 v2, s[4:7], s40 offen lds
    s_add_u32 m0, m0, 4096
    s_add_u32 s40, s42, 173824
    buffer_load_dwordx4 v2, s[4:7], s40 offen lds
    s_add_u32 m0, m0, 4096
    s_add_u32 s40, s42, 345856
    buffer_load_dwordx4 v2, s[4:7], s40 offen lds
    s_add_u32 m0, m0, 4096
    s_add_u32 s40, s42, 517888
    buffer_load_dwordx4 v2, s[4:7], s40 offen lds
    s_add_u32 m0, m0, 4096
    s_add_u32 s40, s42, 689920
    buffer_load_dwordx4 v2, s[4:7], s40 offen lds
    s_add_u32 m0, m0, 4096
    s_add_u32 s40, s42, 861952
    buffer_load_dwordx4 v2, s[4:7], s40 offen lds
    s_add_u32 m0, m0, 4096
    s_add_u32 s40, s42, 1033984
    buffer_load_dwordx4 v2, s[4:7], s40 offen lds
    s_cmp_eq_u32 s18, 0
    s_cbranch_scc0 L_pub_w0_9
    s_load_dwordx2 s[52:53], s[0:1], 72
    s_getreg_b32 s40, hwreg(HW_REG_XCC_ID, 0, 4)
    s_add_u32 s40, s40, 1
    v_mov_b32 v4, s40
    s_lshl_b32 s41, s16, 4
    s_add_u32 s41, s41, s17
    v_mov_b32 v3, s41
    s_waitcnt vmcnt(21) lgkmcnt(0)
    s_mov_b32 s12, s52
    s_mov_b32 s13, s53
    s_mov_b32 s14, 256
    s_mov_b32 s15, 0x20000
    s_mov_b64 exec, 1
    buffer_store_byte v4, v3, s[12:15], 0 offen sc1
    s_mov_b64 exec, -1
L_pub_w0_9:
    s_waitcnt vmcnt(0)
    v_lshrrev_b32 v4, 4, v1
    v_lshlrev_b32 v4, 2, v4
    v_add_u32 v4, s3, v4
    v_lshlrev_b32 v4, 4, v4
    v_and_b32 v5, 15, v1
    v_add_u32 v4, v4, v5
    v_lshlrev_b32 v4, 6, v4
    v_add_u32 v4, 56, v4
    v_mov_b32 v5, 0x3f80
    ds_write_b16 v4, v5
    s_mov_b32 exec_hi, 0xffff
    ds_write_b16 v4, v5 offset:16384
    s_mov_b64 exec, -1
    s_waitcnt vmcnt(0) lgkmcnt(0)
    s_barrier
    s_cmp_eq_u32 s3, 3
    s_cbranch_scc1 L_qkv_nocs2_10
    v_lshrrev_b32 v2, 5, v1
    v_lshlrev_b32 v2, 2, v2
    v_bfe_u32 v3, v1, 2, 2
    v_add_u32 v2, v2, v3
    v_mul_u32_u24 v12, 64, v2
    v_bfe_u32 v3, v1, 4, 1
    v_lshlrev_b32 v3, 5, v3
    v_add_u32 v12, v12, v3
    v_and_b32 v3, 3, v1
    v_lshlrev_b32 v3, 3, v3
    v_add_u32 v12, v12, v3
    s_mul_i32 s41, s3, 28672
    v_add_u32 v12, s41, v12
    s_lshl_b32 s42, s3, 7
    s_add_u32 s42, s42, 161792
    v_mov_b32 v32, 0x3f803f80
    v_mov_b32 v33, 0x3f803f80
    v_mov_b32 v34, 0x3f803f80
    v_mov_b32 v35, 0x3f803f80
    ds_read_b64_tr_b16 v[36:37], v12 offset:0
    ds_read_b64_tr_b16 v[38:39], v12 offset:512
    ds_read_b64_tr_b16 v[40:41], v12 offset:1024
    ds_read_b64_tr_b16 v[42:43], v12 offset:1536
    ds_read_b64_tr_b16 v[44:45], v12 offset:2048
    ds_read_b64_tr_b16 v[46:47], v12 offset:2560
    s_waitcnt lgkmcnt(4)
    v_mfma_f32_32x32x16_bf16 v[16:31], v[36:39], v[32:35], 0
    ds_read_b64_tr_b16 v[36:37], v12 offset:3072
    ds_read_b64_tr_b16 v[38:39], v12 offset:3584
    s_waitcnt lgkmcnt(4)
    v_mfma_f32_32x32x16_bf16 v[16:31], v[40:43], v[32:35], v[16:31]
    ds_read_b64_tr_b16 v[40:41], v12 offset:4096
    ds_read_b64_tr_b16 v[42:43], v12 offset:4608
    s_waitcnt lgkmcnt(4)
    v_mfma_f32_32x32x16_bf16 v[16:31], v[44:47], v[32:35], v[16:31]
    ds_read_b64_tr_b16 v[44:45], v12 offset:5120
    ds_read_b64_tr_b16 v[46:47], v12 offset:5632
    s_waitcnt lgkmcnt(4)
    v_mfma_f32_32x32x16_bf16 v[16:31], v[36:39], v[32:35], v[16:31]
    ds_read_b64_tr_b16 v[36:37], v12 offset:6144
    ds_read_b64_tr_b16 v[38:39], v12 offset:6656
    s_waitcnt lgkmcnt(4)
    v_mfma_f32_32x32x16_bf16 v[16:31], v[40:43], v[32:35], v[16:31]
    ds_read_b64_tr_b16 v[40:41], v12 offset:7168
    ds_read_b64_tr_b16 v[42:43], v12 offset:7680
    s_waitcnt lgkmcnt(4)
    v_mfma_f32_32x32x16_bf16 v[16:31], v[44:47], v[32:35], v[16:31]
    ds_read_b64_tr_b16 v[44:45], v12 offset:8192
    ds_read_b64_tr_b16 v[46:47], v12 offset:8704
    s_waitcnt lgkmcnt(4)
    v_mfma_f32_32x32x16_bf16 v[16:31], v[36:39], v[32:35], v[16:31]
    ds_read_b64_tr_b16 v[36:37], v12 offset:9216
    ds_read_b64_tr_b16 v[38:39], v12 offset:9728
    s_waitcnt lgkmcnt(4)
    v_mfma_f32_32x32x16_bf16 v[16:31], v[40:43], v[32:35], v[16:31]
    ds_read_b64_tr_b16 v[40:41], v12 offset:10240
    ds_read_b64_tr_b16 v[42:43], v12 offset:10752
    s_waitcnt lgkmcnt(4)
    v_mfma_f32_32x32x16_bf16 v[16:31], v[44:47], v[32:35], v[16:31]
    ds_read_b64_tr_b16 v[44:45], v12 offset:11264
    ds_read_b64_tr_b16 v[46:47], v12 offset:11776
    s_waitcnt lgkmcnt(4)
    v_mfma_f32_32x32x16_bf16 v[16:31], v[36:39], v[32:35], v[16:31]
    ds_read_b64_tr_b16 v[36:37], v12 offset:12288
    ds_read_b64_tr_b16 v[38:39], v12 offset:12800
    s_waitcnt lgkmcnt(4)
    v_mfma_f32_32x32x16_bf16 v[16:31], v[40:43], v[32:35], v[16:31]
    ds_read_b64_tr_b16 v[40:41], v12 offset:13312
    ds_read_b64_tr_b16 v[42:43], v12 offset:13824
    s_waitcnt lgkmcnt(4)
    v_mfma_f32_32x32x16_bf16 v[16:31], v[44:47], v[32:35], v[16:31]
    ds_read_b64_tr_b16 v[44:45], v12 offset:14336
    ds_read_b64_tr_b16 v[46:47], v12 offset:14848
    s_waitcnt lgkmcnt(4)
    v_mfma_f32_32x32x16_bf16 v[16:31], v[36:39], v[32:35], v[16:31]
    ds_read_b64_tr_b16 v[36:37], v12 offset:15360
    ds_read_b64_tr_b16 v[38:39], v12 offset:15872
    s_waitcnt lgkmcnt(4)
    v_mfma_f32_32x32x16_bf16 v[16:31], v[40:43], v[32:35], v[16:31]
    ds_read_b64_tr_b16 v[40:41], v12 offset:16384
    ds_read_b64_tr_b16 v[42:43], v12 offset:16896
    s_waitcnt lgkmcnt(4)
    v_mfma_f32_32x32x16_bf16 v[16:31], v[44:47], v[32:35], v[16:31]
    ds_read_b64_tr_b16 v[44:45], v12 offset:17408
    ds_read_b64_tr_b16 v[46:47], v12 offset:17920
    s_waitcnt lgkmcnt(4)
    v_mfma_f32_32x32x16_bf16 v[16:31], v[36:39], v[32:35], v[16:31]
    ds_read_b64_tr_b16 v[36:37], v12 offset:18432
    ds_read_b64_tr_b16 v[38:39], v12 offset:18944
    s_waitcnt lgkmcnt(4)
    v_mfma_f32_32x32x16_bf16 v[16:31], v[40:43], v[32:35], v[16:31]
    ds_read_b64_tr_b16 v[40:41], v12 offset:19456
    ds_read_b64_tr_b16 v[42:43], v12 offset:19968
    s_waitcnt lgkmcnt(4)
    v_mfma_f32_32x32x16_bf16 v[16:31], v[44:47], v[32:35], v[16:31]
    ds_read_b64_tr_b16 v[44:45], v12 offset:20480
    ds_read_b64_tr_b16 v[46:47], v12 offset:20992
    s_waitcnt lgkmcnt(4)
    v_mfma_f32_32x32x16_bf16 v[16:31], v[36:39], v[32:35], v[16:31]
    ds_read_b64_tr_b16 v[36:37], v12 offset:21504
    ds_read_b64_tr_b16 v[38:39], v12 offset:22016
    s_waitcnt lgkmcnt(4)
    v_mfma_f32_32x32x16_bf16 v[16:31], v[40:43], v[32:35], v[16:31]
    ds_read_b64_tr_b16 v[40:41], v12 offset:22528
    ds_read_b64_tr_b16 v[42:43], v12 offset:23040
    s_waitcnt lgkmcnt(4)
    v_mfma_f32_32x32x16_bf16 v[16:31], v[44:47], v[32:35], v[16:31]
    ds_read_b64_tr_b16 v[44:45], v12 offset:23552
    ds_read_b64_tr_b16 v[46:47], v12 offset:24064
    s_waitcnt lgkmcnt(4)
    v_mfma_f32_32x32x16_bf16 v[16:31], v[36:39], v[32:35], v[16:31]
    ds_read_b64_tr_b16 v[36:37], v12 offset:24576
    ds_read_b64_tr_b16 v[38:39], v12 offset:25088
    s_waitcnt lgkmcnt(4)
    v_mfma_f32_32x32x16_bf16 v[16:31], v[40:43], v[32:35], v[16:31]
    ds_read_b64_tr_b16 v[40:41], v12 offset:25600
    ds_read_b64_tr_b16 v[42:43], v12 offset:26112
    s_waitcnt lgkmcnt(4)
    v_mfma_f32_32x32x16_bf16 v[16:31], v[44:47], v[32:35], v[16:31]
    ds_read_b64_tr_b16 v[44:45], v12 offset:26624
    ds_read_b64_tr_b16 v[46:47], v12 offset:27136
    s_waitcnt lgkmcnt(4)
    v_mfma_f32_32x32x16_bf16 v[16:31], v[36:39], v[32:35], v[16:31]
    ds_read_b64_tr_b16 v[36:37], v12 offset:27648
    ds_read_b64_tr_b16 v[38:39], v12 offset:28160
    s_waitcnt lgkmcnt(4)
    v_mfma_f32_32x32x16_bf16 v[16:31], v[40:43], v[32:35], v[16:31]
    s_waitcnt lgkmcnt(2)
    v_mfma_f32_32x32x16_bf16 v[16:31], v[44:47], v[32:35], v[16:31]
    s_waitcnt lgkmcnt(0)
    v_mfma_f32_32x32x16_bf16 v[16:31], v[36:39], v[32:35], v[16:31]
    v_lshrrev_b32 v11, 5, v1
    v_lshlrev_b32 v11, 4, v11
    v_add_u32 v11, s42, v11
    s_mov_b32 exec_lo, 1
    s_mov_b32 exec_hi, 1
    s_nop 7
    ds_write_b128 v11, v[16:19] offset:0
    ds_write_b128 v11, v[20:23] offset:32
    ds_write_b128 v11, v[24:27] offset:64
    ds_write_b128 v11, v[28:31] offset:96
    s_mov_b64 exec, -1
    s_waitcnt lgkmcnt(0)
L_qkv_nocs2_10:
    s_barrier
    s_lshl_b32 s40, s3, 10
    v_add_u32 v2, s40, v0
    v_add_u32 v3, 0x10000, v2
    ds_read_b128 v[172:175], v2 offset:0
    ds_read_b128 v[176:179], v2 offset:4096
    ds_read_b128 v[180:183], v2 offset:8192
    ds_read_b128 v[184:187], v2 offset:12288
    ds_read_b128 v[188:191], v2 offset:16384
    ds_read_b128 v[192:195], v2 offset:20480
    ds_read_b128 v[196:199], v2 offset:24576
    ds_read_b128 v[200:203], v2 offset:28672
    ds_read_b128 v[204:207], v2 offset:32768
    ds_read_b128 v[208:211], v2 offset:36864
    ds_read_b128 v[212:215], v2 offset:40960
    ds_read_b128 v[216:219], v2 offset:45056
    s_waitcnt lgkmcnt(0)
    ds_read_b128 v[220:223], v2 offset:49152
    ds_read_b128 v[224:227], v2 offset:53248
    ds_read_b128 v[228:231], v2 offset:57344
    ds_read_b128 v[232:235], v2 offset:61440
    ds_read_b128 v[236:239], v3 offset:0
    ds_read_b128 v[240:243], v3 offset:4096
    ds_read_b128 v[244:247], v3 offset:8192
    ds_read_b128 v[248:251], v3 offset:12288
    ds_read_b128 v[252:255], v3 offset:16384
    s_load_dwordx2 s[52:53], s[0:1], 72
    v_lshlrev_b32 v6, 2, v1
    s_waitcnt lgkmcnt(0)
    s_mov_b32 s12, s52
    s_mov_b32 s13, s53
    s_mov_b32 s14, 256
    s_mov_b32 s15, 0x20000
    s_mov_b32 s59, s36
L_dbg_11:
    buffer_load_dword v7, v6, s[12:15], 0 offen sc1
    s_waitcnt vmcnt(0)
    v_subrev_u32 v8, 0x01010101, v7
    v_not_b32 v9, v7
    v_and_b32 v8, v8, v9
    v_and_b32 v8, 0x80808080, v8
    v_cmp_ne_u32 vcc, 0, v8
    s_cbranch_vccz L_dbgd_12
    s_sub_u32 s59, s59, 1
    s_cmp_lg_u32 s59, 0
    s_cbranch_scc1 L_dbg_11
    s_mov_b32 s36, 1
L_dbgd_12:
    s_getreg_b32 s55, hwreg(HW_REG_XCC_ID, 0, 4)
    s_add_u32 s55, s55, 1
    s_mul_i32 s55, s55, 0x01010101
    v_cmp_ne_u32 vcc, s55, v7
    s_lshl_b32 s54, s16, 2
    s_nop 0
    s_lshr_b64 vcc, vcc, s54
    s_and_b32 vcc_lo, vcc_lo, 15
    s_cmp_eq_u32 vcc_lo, 0
    s_cselect_b32 s39, 1, 0
    s_waitcnt lgkmcnt(0)
L_qkv_join_4:
L_att_1:
    s_mov_b32 s48, s3
    s_lshr_b32 s49, s18, 2
    v_mov_b32 v24, 0
    v_mov_b32 v25, 0
    v_mov_b32 v26, 0
    v_mov_b32 v27, 0
    v_mov_b32 v28, 0
    v_mov_b32 v29, 0
    v_mov_b32 v30, 0
    v_mov_b32 v31, 0
    v_mov_b32 v32, 0
    v_mov_b32 v33, 0
    v_mov_b32 v34, 0
    v_mov_b32 v35, 0
    v_mov_b32 v36, 0
    v_mov_b32 v37, 0
    v_mov_b32 v38, 0
    v_mov_b32 v39, 0
    s_lshl_b32 s45, s49, 13
    v_add_u32 v2, s45, v0
    s_lshl_b32 s45, s48, 11
    s_add_u32 s45, s45, 145408
    v_add_u32 v4, s45, v0
    s_cmp_eq_u32 s49, 0
    s_cbranch_scc0 L_att_role1_13
    s_mov_b32 s4, s22
    s_mov_b32 s5, s23
    s_mov_b32 s6, 401408
    s_mov_b32 s7, 0x20000
    s_mov_b32 s12, s24
    s_mov_b32 s13, s25
    s_mov_b32 s14, 1605632
    s_mov_b32 s15, 0x20000
    v_lshrrev_b32 v5, 3, v1
    v_mul_u32_u24 v8, 896, v5
    v_bfe_u32 v5, v1, 4, 1
    v_lshlrev_b32 v5, 2, v5
    v_and_b32 v6, 7, v1
    v_xor_b32 v5, v5, v6
    v_lshlrev_b32 v5, 4, v5
    v_add_u32 v8, v8, v5
    v_lshrrev_b32 v5, 3, v1
    v_mul_u32_u24 v9, 3584, v5
    v_bfe_u32 v5, v1, 4, 1
    v_lshlrev_b32 v5, 2, v5
    v_and_b32 v6, 7, v1
    v_xor_b32 v5, v5, v6
    v_lshlrev_b32 v5, 4, v5
    v_add_u32 v9, v9, v5
    s_mul_i32 s46, s48, 7168
    s_min_u32 s47, s38, 6
    s_lshl_b32 s47, s47, 7
    s_add_u32 s46, s46, s47
    s_lshl_b32 s47, s48, 10
    s_mul_i32 s51, s48, 28672
    s_min_u32 s45, s17, 13
    s_lshl_b32 s45, s45, 7
    s_add_u32 s51, s51, s45
    s_lshl_b32 s45, s17, 6
    s_lshr_b32 s44, s48, 1
    s_add_u32 s45, s45, s44
    s_lshl_b32 s45, s45, 11
    s_mul_i32 s40, s19, 2097152
    s_add_u32 s40, s40, 9437184
    s_add_u32 s40, s40, s45
    s_and_b32 s45, s48, 1
    s_mul_i32 s42, s45, 4194304
    s_add_u32 s40, s40, s42
    s_lshl_b32 s41, s44, 12
    s_lshl_b32 s45, s45, 11
    s_add_u32 s41, s41, s45
    s_cmp_eq_u32 s18, 0
    s_cbranch_scc0 L_nopoll_15
    s_mul_i32 s54, s19, 32768
    s_add_u32 s54, s54, 0
    s_lshl_b32 s55, s17, 7
    s_add_u32 s54, s54, s55
    v_and_b32 v5, 15, v1
    v_lshlrev_b32 v5, 11, v5
    s_mov_b32 s59, s36
L_poll_16:
    buffer_load_dword v10, v5, s[8:11], s54 offen sc1
    s_waitcnt vmcnt(0)
    v_cmp_eq_u32 vcc, 0, v10
    s_cbranch_vccz L_polld_17
    s_sub_u32 s59, s59, 1
    s_cmp_lg_u32 s59, 0
    s_cbranch_scc1 L_poll_16
    s_mov_b32 s36, 1
L_polld_17:
L_nopoll_15:
    s_barrier
    v_add_u32 v3, 0x10000, v2
    s_setprio 1
    s_add_u32 m0, s41, 0
    s_add_u32 s43, s40, 0
    buffer_load_dwordx4 v0, s[8:11], s43 offen offset:0 sc1 lds
    buffer_load_dwordx4 v0, s[8:11], s43 offen offset:1024 sc1 lds
    s_add_u32 m0, s41, 8192
    s_add_u32 s43, s40, 65536
    buffer_load_dwordx4 v0, s[8:11], s43 offen offset:0 sc1 lds
    buffer_load_dwordx4 v0, s[8:11], s43 offen offset:1024 sc1 lds
    s_add_u32 m0, s41, 16384
    s_add_u32 s43, s40, 4096
    buffer_load_dwordx4 v0, s[8:11], s43 offen offset:0 sc1 lds
    buffer_load_dwordx4 v0, s[8:11], s43 offen offset:1024 sc1 lds
    s_add_u32 m0, s41, 24576
    s_add_u32 s43, s40, 69632
    buffer_load_dwordx4 v0, s[8:11], s43 offen offset:0 sc1 lds
    buffer_load_dwordx4 v0, s[8:11], s43 offen offset:1024 sc1 lds
    s_waitcnt vmcnt(4)
    s_barrier
    s_add_u32 m0, s41, 32768
    s_add_u32 s43, s40, 8192
    buffer_load_dwordx4 v0, s[8:11], s43 offen offset:0 sc1 lds
    buffer_load_dwordx4 v0, s[8:11], s43 offen offset:1024 sc1 lds
    s_add_u32 m0, s41, 40960
    s_add_u32 s43, s40, 73728
    buffer_load_dwordx4 v0, s[8:11], s43 offen offset:0 sc1 lds
    buffer_load_dwordx4 v0, s[8:11], s43 offen offset:1024 sc1 lds
    s_add_u32 m0, s41, 49152
    s_add_u32 s43, s40, 12288
    buffer_load_dwordx4 v0, s[8:11], s43 offen offset:0 sc1 lds
    buffer_load_dwordx4 v0, s[8:11], s43 offen offset:1024 sc1 lds
    s_add_u32 m0, s41, 57344
    s_add_u32 s43, s40, 77824
    buffer_load_dwordx4 v0, s[8:11], s43 offen offset:0 sc1 lds
    buffer_load_dwordx4 v0, s[8:11], s43 offen offset:1024 sc1 lds
    ds_read_b128 v[16:19], v4
    ds_read_b128 v[20:23], v4 offset:1024
    ds_read_b128 v[80:83], v2 offset:0
    ds_read_b128 v[84:87], v2 offset:1024
    ds_read_b128 v[88:91], v2 offset:4096
    ds_read_b128 v[92:95], v2 offset:5120
    ds_read_b128 v[104:107], v2 offset:3072
    ds_read_b128 v[96:99], v2 offset:2048
    s_waitcnt lgkmcnt(4)
    v_mfma_f32_32x32x16_bf16 v[40:55], v[80:83], v[16:19], 0
    v_mfma_f32_32x32x16_bf16 v[40:55], v[84:87], v[20:23], v[40:55]
    s_nop 9
    s_waitcnt vmcnt(8)
    s_barrier
    s_waitcnt lgkmcnt(0)
    ds_read_b128 v[80:83], v2 offset:16384
    v_mfma_f32_32x32x16_bf16 v[56:71], v[88:91], v[16:19], 0
    v_exp_f32 v40, v40
    v_exp_f32 v41, v41
    s_add_u32 m0, s41, 65536
    s_add_u32 s43, s40, 16384
    buffer_load_dwordx4 v0, s[8:11], s43 offen offset:0 sc1 lds
    ds_read_b128 v[84:87], v2 offset:17408
    v_exp_f32 v42, v42
    v_exp_f32 v43, v43
    v_mfma_f32_32x32x16_bf16 v[56:71], v[92:95], v[20:23], v[56:71]
    ds_read_b128 v[100:103], v2 offset:6144
    v_exp_f32 v44, v44
    v_exp_f32 v45, v45
    buffer_load_dwordx4 v0, s[8:11], s43 offen offset:1024 sc1 lds
    v_exp_f32 v46, v46
    v_exp_f32 v47, v47
    v_cvt_pk_bf16_f32 v72, v40, v41
    v_cvt_pk_bf16_f32 v73, v42, v43
    ds_read_b128 v[108:111], v2 offset:7168
    v_exp_f32 v48, v48
    v_exp_f32 v49, v49
    v_exp_f32 v50, v50
    v_exp_f32 v51, v51
    v_cvt_pk_bf16_f32 v74, v44, v45
    v_cvt_pk_bf16_f32 v75, v46, v47
    v_exp_f32 v52, v52
    v_exp_f32 v53, v53
    v_mfma_f32_32x32x16_bf16 v[24:39], v[96:99], v[72:75], v[24:39]
    v_exp_f32 v54, v54
    v_exp_f32 v55, v55
    v_cvt_pk_bf16_f32 v76, v48, v49
    v_cvt_pk_bf16_f32 v77, v50, v51
    v_cvt_pk_bf16_f32 v78, v52, v53
    v_cvt_pk_bf16_f32 v79, v54, v55
    s_waitcnt lgkmcnt(0)
    ds_read_b128 v[88:91], v2 offset:20480
    v_mfma_f32_32x32x16_bf16 v[40:55], v[80:83], v[16:19], 0
    v_exp_f32 v56, v56
    v_exp_f32 v57, v57
    s_add_u32 m0, s41, 73728
    s_add_u32 s43, s40, 81920
    buffer_load_dwordx4 v0, s[8:11], s43 offen offset:0 sc1 lds
    ds_read_b128 v[92:95], v2 offset:21504
    v_exp_f32 v58, v58
    v_exp_f32 v59, v59
    v_mfma_f32_32x32x16_bf16 v[40:55], v[84:87], v[20:23], v[40:55]
    ds_read_b128 v[96:99], v2 offset:18432
    v_exp_f32 v60, v60
    v_exp_f32 v61, v61
    buffer_load_dwordx4 v0, s[8:11], s43 offen offset:1024 sc1 lds
    v_exp_f32 v62, v62
    v_exp_f32 v63, v63
    v_cvt_pk_bf16_f32 v72, v56, v57
    v_cvt_pk_bf16_f32 v73, v58, v59
    v_mfma_f32_32x32x16_bf16 v[24:39], v[104:107], v[76:79], v[24:39]
    ds_read_b128 v[104:107], v2 offset:19456
    v_exp_f32 v64, v64
    v_exp_f32 v65, v65
    s_add_u32 m0, s47, 81920
    s_add_u32 s50, s46, 0
    buffer_load_dwordx4 v8, s[4:7], s50 offen lds
    v_exp_f32 v66, v66
    v_exp_f32 v67, v67
    v_cvt_pk_bf16_f32 v74, v60, v61
    v_cvt_pk_bf16_f32 v75, v62, v63
    v_exp_f32 v68, v68
    v_exp_f32 v69, v69
    v_mfma_f32_32x32x16_bf16 v[24:39], v[100:103], v[72:75], v[24:39]
    v_exp_f32 v70, v70
    v_exp_f32 v71, v71
    v_cvt_pk_bf16_f32 v76, v64, v65
    v_cvt_pk_bf16_f32 v77, v66, v67
    v_cvt_pk_bf16_f32 v78, v68, v69
    v_cvt_pk_bf16_f32 v79, v70, v71
    s_waitcnt vmcnt(9)
    s_barrier
    s_waitcnt lgkmcnt(0)
    ds_read_b128 v[80:83], v2 offset:32768
    v_mfma_f32_32x32x16_bf16 v[56:71], v[88:91], v[16:19], 0
    v_exp_f32 v40, v40
    v_exp_f32 v41, v41
    s_add_u32 m0, s41, 0
    s_add_u32 s43, s40, 20480
    buffer_load_dwordx4 v0, s[8:11], s43 offen offset:0 sc1 lds
    ds_read_b128 v[84:87], v2 offset:33792
    v_exp_f32 v42, v42
    v_exp_f32 v43, v43
    v_mfma_f32_32x32x16_bf16 v[56:71], v[92:95], v[20:23], v[56:71]
    ds_read_b128 v[100:103], v2 offset:22528
    v_exp_f32 v44, v44
    v_exp_f32 v45, v45
    buffer_load_dwordx4 v0, s[8:11], s43 offen offset:1024 sc1 lds
    v_exp_f32 v46, v46
    v_exp_f32 v47, v47
    v_cvt_pk_bf16_f32 v72, v40, v41
    v_cvt_pk_bf16_f32 v73, v42, v43
    v_mfma_f32_32x32x16_bf16 v[24:39], v[108:111], v[76:79], v[24:39]
    ds_read_b128 v[108:111], v2 offset:23552
    v_exp_f32 v48, v48
    v_exp_f32 v49, v49
    s_add_u32 m0, s47, 86016
    s_add_u32 s50, s46, 28672
    buffer_load_dwordx4 v8, s[4:7], s50 offen lds
    v_exp_f32 v50, v50
    v_exp_f32 v51, v51
    v_cvt_pk_bf16_f32 v74, v44, v45
    v_cvt_pk_bf16_f32 v75, v46, v47
    v_exp_f32 v52, v52
    v_exp_f32 v53, v53
    v_mfma_f32_32x32x16_bf16 v[24:39], v[96:99], v[72:75], v[24:39]
    v_exp_f32 v54, v54
    v_exp_f32 v55, v55
    v_cvt_pk_bf16_f32 v76, v48, v49
    v_cvt_pk_bf16_f32 v77, v50, v51
    v_cvt_pk_bf16_f32 v78, v52, v53
    v_cvt_pk_bf16_f32 v79, v54, v55
    s_waitcnt lgkmcnt(0)
    ds_read_b128 v[88:91], v2 offset:36864
    v_mfma_f32_32x32x16_bf16 v[40:55], v[80:83], v[16:19], 0
    v_exp_f32 v56, v56
    v_exp_f32 v57, v57
    s_add_u32 m0, s41, 8192
    s_add_u32 s43, s40, 86016
    buffer_load_dwordx4 v0, s[8:11], s43 offen offset:0 sc1 lds
    ds_read_b128 v[92:95], v2 offset:37888
    v_exp_f32 v58, v58
    v_exp_f32 v59, v59
    v_mfma_f32_32x32x16_bf16 v[40:55], v[84:87], v[20:23], v[40:55]
    ds_read_b128 v[96:99], v2 offset:34816
    v_exp_f32 v60, v60
    v_exp_f32 v61, v61
    buffer_load_dwordx4 v0, s[8:11], s43 offen offset:1024 sc1 lds
    v_exp_f32 v62, v62
    v_exp_f32 v63, v63
    v_cvt_pk_bf16_f32 v72, v56, v57
    v_cvt_pk_bf16_f32 v73, v58, v59
    v_mfma_f32_32x32x16_bf16 v[24:39], v[104:107], v[76:79], v[24:39]
    ds_read_b128 v[104:107], v2 offset:35840
    v_exp_f32 v64, v64
    v_exp_f32 v65, v65
    s_add_u32 m0, s47, 90112
    s_add_u32 s50, s46, 57344
    buffer_load_dwordx4 v8, s[4:7], s50 offen lds
    v_exp_f32 v66, v66
    v_exp_f32 v67, v67
    v_cvt_pk_bf16_f32 v74, v60, v61
    v_cvt_pk_bf16_f32 v75, v62, v63
    v_exp_f32 v68, v68
    v_exp_f32 v69, v69
    v_mfma_f32_32x32x16_bf16 v[24:39], v[100:103], v[72:75], v[24:39]
    v_exp_f32 v70, v70
    v_exp_f32 v71, v71
    v_cvt_pk_bf16_f32 v76, v64, v65
    v_cvt_pk_bf16_f32 v77, v66, v67
    v_cvt_pk_bf16_f32 v78, v68, v69
    v_cvt_pk_bf16_f32 v79, v70, v71
    s_waitcnt vmcnt(11)
    s_barrier
    s_waitcnt lgkmcnt(0)
    ds_read_b128 v[80:83], v2 offset:49152
    v_mfma_f32_32x32x16_bf16 v[56:71], v[88:91], v[16:19], 0
    v_exp_f32 v40, v40
    v_exp_f32 v41, v41
    s_add_u32 m0, s41, 16384
    s_add_u32 s43, s40, 24576
    buffer_load_dwordx4 v0, s[8:11], s43 offen offset:0 sc1 lds
    ds_read_b128 v[84:87], v2 offset:50176
    v_exp_f32 v42, v42
    v_exp_f32 v43, v43
    v_mfma_f32_32x32x16_bf16 v[56:71], v[92:95], v[20:23], v[56:71]
    ds_read_b128 v[100:103], v2 offset:38912
    v_exp_f32 v44, v44
    v_exp_f32 v45, v45
    buffer_load_dwordx4 v0, s[8:11], s43 offen offset:1024 sc1 lds
    v_exp_f32 v46, v46
    v_exp_f32 v47, v47
    v_cvt_pk_bf16_f32 v72, v40, v41
    v_cvt_pk_bf16_f32 v73, v42, v43
    v_mfma_f32_32x32x16_bf16 v[24:39], v[108:111], v[76:79], v[24:39]
    ds_read_b128 v[108:111], v2 offset:39936
    v_exp_f32 v48, v48
    v_exp_f32 v49, v49
    s_add_u32 m0, s47, 94208
    s_add_u32 s50, s46, 86016
    buffer_load_dwordx4 v8, s[4:7], s50 offen lds
    v_exp_f32 v50, v50
    v_exp_f32 v51, v51
    v_cvt_pk_bf16_f32 v74, v44, v45
    v_cvt_pk_bf16_f32 v75, v46, v47
    v_exp_f32 v52, v52
    v_exp_f32 v53, v53
    v_mfma_f32_32x32x16_bf16 v[24:39], v[96:99], v[72:75], v[24:39]
    v_exp_f32 v54, v54
    v_exp_f32 v55, v55
    v_cvt_pk_bf16_f32 v76, v48, v49
    v_cvt_pk_bf16_f32 v77, v50, v51
    v_cvt_pk_bf16_f32 v78, v52, v53
    v_cvt_pk_bf16_f32 v79, v54, v55
    s_waitcnt lgkmcnt(0)
    ds_read_b128 v[88:91], v2 offset:53248
    v_mfma_f32_32x32x16_bf16 v[40:55], v[80:83], v[16:19], 0
    v_exp_f32 v56, v56
    v_exp_f32 v57, v57
    s_add_u32 m0, s41, 24576
    s_add_u32 s43, s40, 90112
    buffer_load_dwordx4 v0, s[8:11], s43 offen offset:0 sc1 lds
    ds_read_b128 v[92:95], v2 offset:54272
    v_exp_f32 v58, v58
    v_exp_f32 v59, v59
    v_mfma_f32_32x32x16_bf16 v[40:55], v[84:87], v[20:23], v[40:55]
    ds_read_b128 v[96:99], v2 offset:51200
    v_exp_f32 v60, v60
    v_exp_f32 v61, v61
    buffer_load_dwordx4 v0, s[8:11], s43 offen offset:1024 sc1 lds
    v_exp_f32 v62, v62
    v_exp_f32 v63, v63
    v_cvt_pk_bf16_f32 v72, v56, v57
    v_cvt_pk_bf16_f32 v73, v58, v59
    v_mfma_f32_32x32x16_bf16 v[24:39], v[104:107], v[76:79], v[24:39]
    ds_read_b128 v[104:107], v2 offset:52224
    v_exp_f32 v64, v64
    v_exp_f32 v65, v65
    s_add_u32 m0, s47, 98304
    s_add_u32 s50, s46, 114688
    buffer_load_dwordx4 v8, s[4:7], s50 offen lds
    v_exp_f32 v66, v66
    v_exp_f32 v67, v67
    v_cvt_pk_bf16_f32 v74, v60, v61
    v_cvt_pk_bf16_f32 v75, v62, v63
    v_exp_f32 v68, v68
    v_exp_f32 v69, v69
    v_mfma_f32_32x32x16_bf16 v[24:39], v[100:103], v[72:75], v[24:39]
    v_exp_f32 v70, v70
    v_exp_f32 v71, v71
    v_cvt_pk_bf16_f32 v76, v64, v65
    v_cvt_pk_bf16_f32 v77, v66, v67
    v_cvt_pk_bf16_f32 v78, v68, v69
    v_cvt_pk_bf16_f32 v79, v70, v71
    s_waitcnt vmcnt(13)
    s_barrier
    s_waitcnt lgkmcnt(0)
    ds_read_b128 v[80:83], v3 offset:0
    v_mfma_f32_32x32x16_bf16 v[56:71], v[88:91], v[16:19], 0
    v_exp_f32 v40, v40
    v_exp_f32 v41, v41
    s_add_u32 m0, s41, 32768
    s_add_u32 s43, s40, 28672
    buffer_load_dwordx4 v0, s[8:11], s43 offen offset:0 sc1 lds
    ds_read_b128 v[84:87], v3 offset:1024
    v_exp_f32 v42, v42
    v_exp_f32 v43, v43
    v_mfma_f32_32x32x16_bf16 v[56:71], v[92:95], v[20:23], v[56:71]
    ds_read_b128 v[100:103], v2 offset:55296
    v_exp_f32 v44, v44
    v_exp_f32 v45, v45
    buffer_load_dwordx4 v0, s[8:11], s43 offen offset:1024 sc1 lds
    v_exp_f32 v46, v46
    v_exp_f32 v47, v47
    v_cvt_pk_bf16_f32 v72, v40, v41
    v_cvt_pk_bf16_f32 v73, v42, v43
    v_mfma_f32_32x32x16_bf16 v[24:39], v[108:111], v[76:79], v[24:39]
    ds_read_b128 v[108:111], v2 offset:56320
    v_exp_f32 v48, v48
    v_exp_f32 v49, v49
    s_add_u32 m0, s47, 102400
    s_add_u32 s50, s46, 143360
    buffer_load_dwordx4 v8, s[4:7], s50 offen lds
    v_exp_f32 v50, v50
    v_exp_f32 v51, v51
    v_cvt_pk_bf16_f32 v74, v44, v45
    v_cvt_pk_bf16_f32 v75, v46, v47
    v_exp_f32 v52, v52
    v_exp_f32 v53, v53
    v_mfma_f32_32x32x16_bf16 v[24:39], v[96:99], v[72:75], v[24:39]
    v_exp_f32 v54, v54
    v_exp_f32 v55, v55
    v_cvt_pk_bf16_f32 v76, v48, v49
    v_cvt_pk_bf16_f32 v77, v50, v51
    v_cvt_pk_bf16_f32 v78, v52, v53
    v_cvt_pk_bf16_f32 v79, v54, v55
    s_waitcnt lgkmcnt(0)
    ds_read_b128 v[88:91], v3 offset:4096
    v_mfma_f32_32x32x16_bf16 v[40:55], v[80:83], v[16:19], 0
    v_exp_f32 v56, v56
    v_exp_f32 v57, v57
    s_add_u32 m0, s41, 40960
    s_add_u32 s43, s40, 94208
    buffer_load_dwordx4 v0, s[8:11], s43 offen offset:0 sc1 lds
    ds_read_b128 v[92:95], v3 offset:5120
    v_exp_f32 v58, v58
    v_exp_f32 v59, v59
    v_mfma_f32_32x32x16_bf16 v[40:55], v[84:87], v[20:23], v[40:55]
    ds_read_b128 v[96:99], v3 offset:2048
    v_exp_f32 v60, v60
    v_exp_f32 v61, v61
    buffer_load_dwordx4 v0, s[8:11], s43 offen offset:1024 sc1 lds
    v_exp_f32 v62, v62
    v_exp_f32 v63, v63
    v_cvt_pk_bf16_f32 v72, v56, v57
    v_cvt_pk_bf16_f32 v73, v58, v59
    v_mfma_f32_32x32x16_bf16 v[24:39], v[104:107], v[76:79], v[24:39]
    ds_read_b128 v[104:107], v3 offset:3072
    v_exp_f32 v64, v64
    v_exp_f32 v65, v65
    s_add_u32 m0, s47, 106496
    s_add_u32 s50, s46, 172032
    buffer_load_dwordx4 v8, s[4:7], s50 offen lds
    v_exp_f32 v66, v66
    v_exp_f32 v67, v67
    v_cvt_pk_bf16_f32 v74, v60, v61
    v_cvt_pk_bf16_f32 v75, v62, v63
    v_exp_f32 v68, v68
    v_exp_f32 v69, v69
    v_mfma_f32_32x32x16_bf16 v[24:39], v[100:103], v[72:75], v[24:39]
    v_exp_f32 v70, v70
    v_exp_f32 v71, v71
    v_cvt_pk_bf16_f32 v76, v64, v65
    v_cvt_pk_bf16_f32 v77, v66, v67
    v_cvt_pk_bf16_f32 v78, v68, v69
    v_cvt_pk_bf16_f32 v79, v70, v71
    s_waitcnt vmcnt(13)
    s_barrier
    s_waitcnt lgkmcnt(0)
    ds_read_b128 v[80:83], v2 offset:0
    v_mfma_f32_32x32x16_bf16 v[56:71], v[88:91], v[16:19], 0
    v_exp_f32 v40, v40
    v_exp_f32 v41, v41
    s_add_u32 m0, s41, 49152
    s_add_u32 s43, s40, 32768
    buffer_load_dwordx4 v0, s[8:11], s43 offen offset:0 sc1 lds
    ds_read_b128 v[84:87], v2 offset:1024
    v_exp_f32 v42, v42
    v_exp_f32 v43, v43
    v_mfma_f32_32x32x16_bf16 v[56:71], v[92:95], v[20:23], v[56:71]
    ds_read_b128 v[100:103], v3 offset:6144
    v_exp_f32 v44, v44
    v_exp_f32 v45, v45
    buffer_load_dwordx4 v0, s[8:11], s43 offen offset:1024 sc1 lds
    v_exp_f32 v46, v46
    v_exp_f32 v47, v47
    v_cvt_pk_bf16_f32 v72, v40, v41
    v_cvt_pk_bf16_f32 v73, v42, v43
    v_mfma_f32_32x32x16_bf16 v[24:39], v[108:111], v[76:79], v[24:39]
    ds_read_b128 v[108:111], v3 offset:7168
    v_exp_f32 v48, v48
    v_exp_f32 v49, v49
    s_add_u32 m0, s47, 110592
    s_add_u32 s50, s46, 200704
    buffer_load_dwordx4 v8, s[4:7], s50 offen lds
    v_exp_f32 v50, v50
    v_exp_f32 v51, v51
    v_cvt_pk_bf16_f32 v74, v44, v45
    v_cvt_pk_bf16_f32 v75, v46, v47
    v_exp_f32 v52, v52
    v_exp_f32 v53, v53
    v_mfma_f32_32x32x16_bf16 v[24:39], v[96:99], v[72:75], v[24:39]
    v_exp_f32 v54, v54
    v_exp_f32 v55, v55
    v_cvt_pk_bf16_f32 v76, v48, v49
    v_cvt_pk_bf16_f32 v77, v50, v51
    v_cvt_pk_bf16_f32 v78, v52, v53
    v_cvt_pk_bf16_f32 v79, v54, v55
    s_waitcnt lgkmcnt(0)
    ds_read_b128 v[88:91], v2 offset:4096
    v_mfma_f32_32x32x16_bf16 v[40:55], v[80:83], v[16:19], 0
    v_exp_f32 v56, v56
    v_exp_f32 v57, v57
    s_add_u32 m0, s41, 57344
    s_add_u32 s43, s40, 98304
    buffer_load_dwordx4 v0, s[8:11], s43 offen offset:0 sc1 lds
    ds_read_b128 v[92:95], v2 offset:5120
    v_exp_f32 v58, v58
    v_exp_f32 v59, v59
    v_mfma_f32_32x32x16_bf16 v[40:55], v[84:87], v[20:23], v[40:55]
    ds_read_b128 v[96:99], v2 offset:2048
    v_exp_f32 v60, v60
    v_exp_f32 v61, v61
    buffer_load_dwordx4 v0, s[8:11], s43 offen offset:1024 sc1 lds
    v_exp_f32 v62, v62
    v_exp_f32 v63, v63
    v_cvt_pk_bf16_f32 v72, v56, v57
    v_cvt_pk_bf16_f32 v73, v58, v59
    v_mfma_f32_32x32x16_bf16 v[24:39], v[104:107], v[76:79], v[24:39]
    ds_read_b128 v[104:107], v2 offset:3072
    v_exp_f32 v64, v64
    v_exp_f32 v65, v65
    s_add_u32 m0, s47, 114688
    s_add_u32 s50, s46, 229376
    buffer_load_dwordx4 v8, s[4:7], s50 offen lds
    v_exp_f32 v66, v66
    v_exp_f32 v67, v67
    v_cvt_pk_bf16_f32 v74, v60, v61
    v_cvt_pk_bf16_f32 v75, v62, v63
    v_exp_f32 v68, v68
    v_exp_f32 v69, v69
    v_mfma_f32_32x32x16_bf16 v[24:39], v[100:103], v[72:75], v[24:39]
    v_exp_f32 v70, v70
    v_exp_f32 v71, v71
    v_cvt_pk_bf16_f32 v76, v64, v65
    v_cvt_pk_bf16_f32 v77, v66, v67
    v_cvt_pk_bf16_f32 v78, v68, v69
    v_cvt_pk_bf16_f32 v79, v70, v71
    s_waitcnt vmcnt(13)
    s_barrier
    s_waitcnt lgkmcnt(0)
    ds_read_b128 v[80:83], v2 offset:16384
    v_mfma_f32_32x32x16_bf16 v[56:71], v[88:91], v[16:19], 0
    v_exp_f32 v40, v40
    v_exp_f32 v41, v41
    s_add_u32 m0, s41, 65536
    s_add_u32 s43, s40, 36864
    buffer_load_dwordx4 v0, s[8:11], s43 offen offset:0 sc1 lds
    ds_read_b128 v[84:87], v2 offset:17408
    v_exp_f32 v42, v42
    v_exp_f32 v43, v43
    v_mfma_f32_32x32x16_bf16 v[56:71], v[92:95], v[20:23], v[56:71]
    ds_read_b128 v[100:103], v2 offset:6144
    v_exp_f32 v44, v44
    v_exp_f32 v45, v45
    buffer_load_dwordx4 v0, s[8:11], s43 offen offset:1024 sc1 lds
    v_exp_f32 v46, v46
    v_exp_f32 v47, v47
    v_cvt_pk_bf16_f32 v72, v40, v41
    v_cvt_pk_bf16_f32 v73, v42, v43
    v_mfma_f32_32x32x16_bf16 v[24:39], v[108:111], v[76:79], v[24:39]
    ds_read_b128 v[108:111], v2 offset:7168
    v_exp_f32 v48, v48
    v_exp_f32 v49, v49
    s_add_u32 m0, s47, 118784
    s_add_u32 s50, s46, 258048
    buffer_load_dwordx4 v8, s[4:7], s50 offen lds
    v_exp_f32 v50, v50
    v_exp_f32 v51, v51
    v_cvt_pk_bf16_f32 v74, v44, v45
    v_cvt_pk_bf16_f32 v75, v46, v47
    v_exp_f32 v52, v52
    v_exp_f32 v53, v53
    v_mfma_f32_32x32x16_bf16 v[24:39], v[96:99], v[72:75], v[24:39]
    v_exp_f32 v54, v54
    v_exp_f32 v55, v55
    v_cvt_pk_bf16_f32 v76, v48, v49
    v_cvt_pk_bf16_f32 v77, v50, v51
    v_cvt_pk_bf16_f32 v78, v52, v53
    v_cvt_pk_bf16_f32 v79, v54, v55
    s_waitcnt lgkmcnt(0)
    ds_read_b128 v[88:91], v2 offset:20480
    v_mfma_f32_32x32x16_bf16 v[40:55], v[80:83], v[16:19], 0
    v_exp_f32 v56, v56
    v_exp_f32 v57, v57
    s_add_u32 m0, s41, 73728
    s_add_u32 s43, s40, 102400
    buffer_load_dwordx4 v0, s[8:11], s43 offen offset:0 sc1 lds
    ds_read_b128 v[92:95], v2 offset:21504
    v_exp_f32 v58, v58
    v_exp_f32 v59, v59
    v_mfma_f32_32x32x16_bf16 v[40:55], v[84:87], v[20:23], v[40:55]
    ds_read_b128 v[96:99], v2 offset:18432
    v_exp_f32 v60, v60
    v_exp_f32 v61, v61
    buffer_load_dwordx4 v0, s[8:11], s43 offen offset:1024 sc1 lds
    v_exp_f32 v62, v62
    v_exp_f32 v63, v63
    v_cvt_pk_bf16_f32 v72, v56, v57
    v_cvt_pk_bf16_f32 v73, v58, v59
    v_mfma_f32_32x32x16_bf16 v[24:39], v[104:107], v[76:79], v[24:39]
    ds_read_b128 v[104:107], v2 offset:19456
    v_exp_f32 v64, v64
    v_exp_f32 v65, v65
    s_add_u32 m0, s47, 122880
    s_add_u32 s50, s46, 286720
    buffer_load_dwordx4 v8, s[4:7], s50 offen lds
    v_exp_f32 v66, v66
    v_exp_f32 v67, v67
    v_cvt_pk_bf16_f32 v74, v60, v61
    v_cvt_pk_bf16_f32 v75, v62, v63
    v_exp_f32 v68, v68
    v_exp_f32 v69, v69
    v_mfma_f32_32x32x16_bf16 v[24:39], v[100:103], v[72:75], v[24:39]
    v_exp_f32 v70, v70
    v_exp_f32 v71, v71
    v_cvt_pk_bf16_f32 v76, v64, v65
    v_cvt_pk_bf16_f32 v77, v66, v67
    v_cvt_pk_bf16_f32 v78, v68, v69
    v_cvt_pk_bf16_f32 v79, v70, v71
    s_waitcnt vmcnt(13)
    s_barrier
    s_waitcnt lgkmcnt(0)
    ds_read_b128 v[80:83], v2 offset:32768
    v_mfma_f32_32x32x16_bf16 v[56:71], v[88:91], v[16:19], 0
    v_exp_f32 v40, v40
    v_exp_f32 v41, v41
    s_add_u32 m0, s41, 0
    s_add_u32 s43, s40, 40960
    buffer_load_dwordx4 v0, s[8:11], s43 offen offset:0 sc1 lds
    ds_read_b128 v[84:87], v2 offset:33792
    v_exp_f32 v42, v42
    v_exp_f32 v43, v43
    v_mfma_f32_32x32x16_bf16 v[56:71], v[92:95], v[20:23], v[56:71]
    ds_read_b128 v[100:103], v2 offset:22528
    v_exp_f32 v44, v44
    v_exp_f32 v45, v45
    buffer_load_dwordx4 v0, s[8:11], s43 offen offset:1024 sc1 lds
    v_exp_f32 v46, v46
    v_exp_f32 v47, v47
    v_cvt_pk_bf16_f32 v72, v40, v41
    v_cvt_pk_bf16_f32 v73, v42, v43
    v_mfma_f32_32x32x16_bf16 v[24:39], v[108:111], v[76:79], v[24:39]
    ds_read_b128 v[108:111], v2 offset:23552
    v_exp_f32 v48, v48
    v_exp_f32 v49, v49
    s_add_u32 m0, s47, 126976
    s_add_u32 s50, s46, 315392
    buffer_load_dwordx4 v8, s[4:7], s50 offen lds
    v_exp_f32 v50, v50
    v_exp_f32 v51, v51
    v_cvt_pk_bf16_f32 v74, v44, v45
    v_cvt_pk_bf16_f32 v75, v46, v47
    v_exp_f32 v52, v52
    v_exp_f32 v53, v53
    v_mfma_f32_32x32x16_bf16 v[24:39], v[96:99], v[72:75], v[24:39]
    v_exp_f32 v54, v54
    v_exp_f32 v55, v55
    v_cvt_pk_bf16_f32 v76, v48, v49
    v_cvt_pk_bf16_f32 v77, v50, v51
    v_cvt_pk_bf16_f32 v78, v52, v53
    v_cvt_pk_bf16_f32 v79, v54, v55
    s_waitcnt lgkmcnt(0)
    ds_read_b128 v[88:91], v2 offset:36864
    v_mfma_f32_32x32x16_bf16 v[40:55], v[80:83], v[16:19], 0
    v_exp_f32 v56, v56
    v_exp_f32 v57, v57
    s_add_u32 m0, s41, 8192
    s_add_u32 s43, s40, 106496
    buffer_load_dwordx4 v0, s[8:11], s43 offen offset:0 sc1 lds
    ds_read_b128 v[92:95], v2 offset:37888
    v_exp_f32 v58, v58
    v_exp_f32 v59, v59
    v_mfma_f32_32x32x16_bf16 v[40:55], v[84:87], v[20:23], v[40:55]
    ds_read_b128 v[96:99], v2 offset:34816
    v_exp_f32 v60, v60
    v_exp_f32 v61, v61
    buffer_load_dwordx4 v0, s[8:11], s43 offen offset:1024 sc1 lds
    v_exp_f32 v62, v62
    v_exp_f32 v63, v63
    v_cvt_pk_bf16_f32 v72, v56, v57
    v_cvt_pk_bf16_f32 v73, v58, v59
    v_mfma_f32_32x32x16_bf16 v[24:39], v[104:107], v[76:79], v[24:39]
    ds_read_b128 v[104:107], v2 offset:35840
    v_exp_f32 v64, v64
    v_exp_f32 v65, v65
    s_add_u32 m0, s47, 131072
    s_add_u32 s50, s46, 344064
    buffer_load_dwordx4 v8, s[4:7], s50 offen lds
    v_exp_f32 v66, v66
    v_exp_f32 v67, v67
    v_cvt_pk_bf16_f32 v74, v60, v61
    v_cvt_pk_bf16_f32 v75, v62, v63
    v_exp_f32 v68, v68
    v_exp_f32 v69, v69
    v_mfma_f32_32x32x16_bf16 v[24:39], v[100:103], v[72:75], v[24:39]
    v_exp_f32 v70, v70
    v_exp_f32 v71, v71
    v_cvt_pk_bf16_f32 v76, v64, v65
    v_cvt_pk_bf16_f32 v77, v66, v67
    v_cvt_pk_bf16_f32 v78, v68, v69
    v_cvt_pk_bf16_f32 v79, v70, v71
    s_waitcnt vmcnt(13)
    s_barrier
    s_waitcnt lgkmcnt(0)
    ds_read_b128 v[80:83], v2 offset:49152
    v_mfma_f32_32x32x16_bf16 v[56:71], v[88:91], v[16:19], 0
    v_exp_f32 v40, v40
    v_exp_f32 v41, v41
    s_add_u32 m0, s41, 16384
    s_add_u32 s43, s40, 45056
    buffer_load_dwordx4 v0, s[8:11], s43 offen offset:0 sc1 lds
    ds_read_b128 v[84:87], v2 offset:50176
    v_exp_f32 v42, v42
    v_exp_f32 v43, v43
    v_mfma_f32_32x32x16_bf16 v[56:71], v[92:95], v[20:23], v[56:71]
    ds_read_b128 v[100:103], v2 offset:38912
    v_exp_f32 v44, v44
    v_exp_f32 v45, v45
    buffer_load_dwordx4 v0, s[8:11], s43 offen offset:1024 sc1 lds
    v_exp_f32 v46, v46
    v_exp_f32 v47, v47
    v_cvt_pk_bf16_f32 v72, v40, v41
    v_cvt_pk_bf16_f32 v73, v42, v43
    v_mfma_f32_32x32x16_bf16 v[24:39], v[108:111], v[76:79], v[24:39]
    ds_read_b128 v[108:111], v2 offset:39936
    v_exp_f32 v48, v48
    v_exp_f32 v49, v49
    s_add_u32 m0, s47, 135168
    s_add_u32 s50, s46, 372736
    buffer_load_dwordx4 v8, s[4:7], s50 offen lds
    v_exp_f32 v50, v50
    v_exp_f32 v51, v51
    v_cvt_pk_bf16_f32 v74, v44, v45
    v_cvt_pk_bf16_f32 v75, v46, v47
    v_exp_f32 v52, v52
    v_exp_f32 v53, v53
    v_mfma_f32_32x32x16_bf16 v[24:39], v[96:99], v[72:75], v[24:39]
    v_exp_f32 v54, v54
    v_exp_f32 v55, v55
    v_cvt_pk_bf16_f32 v76, v48, v49
    v_cvt_pk_bf16_f32 v77, v50, v51
    v_cvt_pk_bf16_f32 v78, v52, v53
    v_cvt_pk_bf16_f32 v79, v54, v55
    s_waitcnt lgkmcnt(0)
    ds_read_b128 v[88:91], v2 offset:53248
    v_mfma_f32_32x32x16_bf16 v[40:55], v[80:83], v[16:19], 0
    v_exp_f32 v56, v56
    v_exp_f32 v57, v57
    s_add_u32 m0, s41, 24576
    s_add_u32 s43, s40, 110592
    buffer_load_dwordx4 v0, s[8:11], s43 offen offset:0 sc1 lds
    ds_read_b128 v[92:95], v2 offset:54272
    v_exp_f32 v58, v58
    v_exp_f32 v59, v59
    v_mfma_f32_32x32x16_bf16 v[40:55], v[84:87], v[20:23], v[40:55]
    ds_read_b128 v[96:99], v2 offset:51200
    v_exp_f32 v60, v60
    v_exp_f32 v61, v61
    buffer_load_dwordx4 v0, s[8:11], s43 offen offset:1024 sc1 lds
    v_exp_f32 v62, v62
    v_exp_f32 v63, v63
    v_cvt_pk_bf16_f32 v72, v56, v57
    v_cvt_pk_bf16_f32 v73, v58, v59
    v_mfma_f32_32x32x16_bf16 v[24:39], v[104:107], v[76:79], v[24:39]
    ds_read_b128 v[104:107], v2 offset:52224
    v_exp_f32 v64, v64
    v_exp_f32 v65, v65
    s_add_u32 m0, s47, 139264
    s_add_u32 s50, s46, 401408
    buffer_load_dwordx4 v8, s[4:7], s50 offen lds
    v_exp_f32 v66, v66
    v_exp_f32 v67, v67
    v_cvt_pk_bf16_f32 v74, v60, v61
    v_cvt_pk_bf16_f32 v75, v62, v63
    v_exp_f32 v68, v68
    v_exp_f32 v69, v69
    v_mfma_f32_32x32x16_bf16 v[24:39], v[100:103], v[72:75], v[24:39]
    v_exp_f32 v70, v70
    v_exp_f32 v71, v71
    v_cvt_pk_bf16_f32 v76, v64, v65
    v_cvt_pk_bf16_f32 v77, v66, v67
    v_cvt_pk_bf16_f32 v78, v68, v69
    v_cvt_pk_bf16_f32 v79, v70, v71
    s_waitcnt vmcnt(13)
    s_barrier
    s_waitcnt lgkmcnt(0)
    ds_read_b128 v[80:83], v3 offset:0
    v_mfma_f32_32x32x16_bf16 v[56:71], v[88:91], v[16:19], 0
    v_exp_f32 v40, v40
    v_exp_f32 v41, v41
    s_add_u32 m0, s41, 32768
    s_add_u32 s43, s40, 49152
    buffer_load_dwordx4 v0, s[8:11], s43 offen offset:0 sc1 lds
    ds_read_b128 v[84:87], v3 offset:1024
    v_exp_f32 v42, v42
    v_exp_f32 v43, v43
    v_mfma_f32_32x32x16_bf16 v[56:71], v[92:95], v[20:23], v[56:71]
    ds_read_b128 v[100:103], v2 offset:55296
    v_exp_f32 v44, v44
    v_exp_f32 v45, v45
    buffer_load_dwordx4 v0, s[8:11], s43 offen offset:1024 sc1 lds
    v_exp_f32 v46, v46
    v_exp_f32 v47, v47
    v_cvt_pk_bf16_f32 v72, v40, v41
    v_cvt_pk_bf16_f32 v73, v42, v43
    v_mfma_f32_32x32x16_bf16 v[24:39], v[108:111], v[76:79], v[24:39]
    ds_read_b128 v[108:111], v2 offset:56320
    v_exp_f32 v48, v48
    v_exp_f32 v49, v49
    s_add_u32 s50, s51, 1792
    buffer_load_dwordx4 v[112:115], v9, s[12:15], s50 offen
    v_exp_f32 v50, v50
    v_exp_f32 v51, v51
    v_cvt_pk_bf16_f32 v74, v44, v45
    v_cvt_pk_bf16_f32 v75, v46, v47
    v_exp_f32 v52, v52
    v_exp_f32 v53, v53
    v_mfma_f32_32x32x16_bf16 v[24:39], v[96:99], v[72:75], v[24:39]
    v_exp_f32 v54, v54
    v_exp_f32 v55, v55
    v_cvt_pk_bf16_f32 v76, v48, v49
    v_cvt_pk_bf16_f32 v77, v50, v51
    v_cvt_pk_bf16_f32 v78, v52, v53
    v_cvt_pk_bf16_f32 v79, v54, v55
    s_waitcnt lgkmcnt(0)
    ds_read_b128 v[88:91], v3 offset:4096
    v_mfma_f32_32x32x16_bf16 v[40:55], v[80:83], v[16:19], 0
    v_exp_f32 v56, v56
    v_exp_f32 v57, v57
    s_add_u32 m0, s41, 40960
    s_add_u32 s43, s40, 114688
    buffer_load_dwordx4 v0, s[8:11], s43 offen offset:0 sc1 lds
    ds_read_b128 v[92:95], v3 offset:5120
    v_exp_f32 v58, v58
    v_exp_f32 v59, v59
    v_mfma_f32_32x32x16_bf16 v[40:55], v[84:87], v[20:23], v[40:55]
    ds_read_b128 v[96:99], v3 offset:2048
    v_exp_f32 v60, v60
    v_exp_f32 v61, v61
    buffer_load_dwordx4 v0, s[8:11], s43 offen offset:1024 sc1 lds
    v_exp_f32 v62, v62
    v_exp_f32 v63, v63
    v_cvt_pk_bf16_f32 v72, v56, v57
    v_cvt_pk_bf16_f32 v73, v58, v59
    v_mfma_f32_32x32x16_bf16 v[24:39], v[104:107], v[76:79], v[24:39]
    ds_read_b128 v[104:107], v3 offset:3072
    v_exp_f32 v64, v64
    v_exp_f32 v65, v65
    s_add_u32 s50, s51, 116480
    buffer_load_dwordx4 v[116:119], v9, s[12:15], s50 offen
    v_exp_f32 v66, v66
    v_exp_f32 v67, v67
    v_cvt_pk_bf16_f32 v74, v60, v61
    v_cvt_pk_bf16_f32 v75, v62, v63
    v_exp_f32 v68, v68
    v_exp_f32 v69, v69
    v_mfma_f32_32x32x16_bf16 v[24:39], v[100:103], v[72:75], v[24:39]
    v_exp_f32 v70, v70
    v_exp_f32 v71, v71
    v_cvt_pk_bf16_f32 v76, v64, v65
    v_cvt_pk_bf16_f32 v77, v66, v67
    v_cvt_pk_bf16_f32 v78, v68, v69
    v_cvt_pk_bf16_f32 v79, v70, v71
    s_waitcnt vmcnt(13)
    s_barrier
    s_waitcnt lgkmcnt(0)
    ds_read_b128 v[80:83], v2 offset:0
    v_mfma_f32_32x32x16_bf16 v[56:71], v[88:91], v[16:19], 0
    v_exp_f32 v40, v40
    v_exp_f32 v41, v41
    s_add_u32 m0, s41, 49152
    s_add_u32 s43, s40, 53248
    buffer_load_dwordx4 v0, s[8:11], s43 offen offset:0 sc1 lds
    ds_read_b128 v[84:87], v2 offset:1024
    v_exp_f32 v42, v42
    v_exp_f32 v43, v43
    v_mfma_f32_32x32x16_bf16 v[56:71], v[92:95], v[20:23], v[56:71]
    ds_read_b128 v[100:103], v3 offset:6144
    v_exp_f32 v44, v44
    v_exp_f32 v45, v45
    buffer_load_dwordx4 v0, s[8:11], s43 offen offset:1024 sc1 lds
    v_exp_f32 v46, v46
    v_exp_f32 v47, v47
    v_cvt_pk_bf16_f32 v72, v40, v41
    v_cvt_pk_bf16_f32 v73, v42, v43
    v_mfma_f32_32x32x16_bf16 v[24:39], v[108:111], v[76:79], v[24:39]
    ds_read_b128 v[108:111], v3 offset:7168
    v_exp_f32 v48, v48
    v_exp_f32 v49, v49
    s_add_u32 s50, s51, 231168
    buffer_load_dwordx4 v[120:123], v9, s[12:15], s50 offen
    v_exp_f32 v50, v50
    v_exp_f32 v51, v51
    v_cvt_pk_bf16_f32 v74, v44, v45
    v_cvt_pk_bf16_f32 v75, v46, v47
    v_exp_f32 v52, v52
    v_exp_f32 v53, v53
    v_mfma_f32_32x32x16_bf16 v[24:39], v[96:99], v[72:75], v[24:39]
    v_exp_f32 v54, v54
    v_exp_f32 v55, v55
    v_cvt_pk_bf16_f32 v76, v48, v49
    v_cvt_pk_bf16_f32 v77, v50, v51
    v_cvt_pk_bf16_f32 v78, v52, v53
    v_cvt_pk_bf16_f32 v79, v54, v55
    s_waitcnt lgkmcnt(0)
    ds_read_b128 v[88:91], v2 offset:4096
    v_mfma_f32_32x32x16_bf16 v[40:55], v[80:83], v[16:19], 0
    v_exp_f32 v56, v56
    v_exp_f32 v57, v57
    s_add_u32 m0, s41, 57344
    s_add_u32 s43, s40, 118784
    buffer_load_dwordx4 v0, s[8:11], s43 offen offset:0 sc1 lds
    ds_read_b128 v[92:95], v2 offset:5120
    v_exp_f32 v58, v58
    v_exp_f32 v59, v59
    v_mfma_f32_32x32x16_bf16 v[40:55], v[84:87], v[20:23], v[40:55]
    ds_read_b128 v[96:99], v2 offset:2048
    v_exp_f32 v60, v60
    v_exp_f32 v61, v61
    buffer_load_dwordx4 v0, s[8:11], s43 offen offset:1024 sc1 lds
    v_exp_f32 v62, v62
    v_exp_f32 v63, v63
    v_cvt_pk_bf16_f32 v72, v56, v57
    v_cvt_pk_bf16_f32 v73, v58, v59
    v_mfma_f32_32x32x16_bf16 v[24:39], v[104:107], v[76:79], v[24:39]
    ds_read_b128 v[104:107], v2 offset:3072
    v_exp_f32 v64, v64
    v_exp_f32 v65, v65
    s_add_u32 s50, s51, 345856
    buffer_load_dwordx4 v[124:127], v9, s[12:15], s50 offen
    v_exp_f32 v66, v66
    v_exp_f32 v67, v67
    v_cvt_pk_bf16_f32 v74, v60, v61
    v_cvt_pk_bf16_f32 v75, v62, v63
    v_exp_f32 v68, v68
    v_exp_f32 v69, v69
    v_mfma_f32_32x32x16_bf16 v[24:39], v[100:103], v[72:75], v[24:39]
    v_exp_f32 v70, v70
    v_exp_f32 v71, v71
    v_cvt_pk_bf16_f32 v76, v64, v65
    v_cvt_pk_bf16_f32 v77, v66, v67
    v_cvt_pk_bf16_f32 v78, v68, v69
    v_cvt_pk_bf16_f32 v79, v70, v71
    s_waitcnt vmcnt(13)
    s_barrier
    s_waitcnt lgkmcnt(0)
    ds_read_b128 v[80:83], v2 offset:16384
    v_mfma_f32_32x32x16_bf16 v[56:71], v[88:91], v[16:19], 0
    v_exp_f32 v40, v40
    v_exp_f32 v41, v41
    s_add_u32 m0, s41, 65536
    s_add_u32 s43, s40, 57344
    buffer_load_dwordx4 v0, s[8:11], s43 offen offset:0 sc1 lds
    ds_read_b128 v[84:87], v2 offset:17408
    v_exp_f32 v42, v42
    v_exp_f32 v43, v43
    v_mfma_f32_32x32x16_bf16 v[56:71], v[92:95], v[20:23], v[56:71]
    ds_read_b128 v[100:103], v2 offset:6144
    v_exp_f32 v44, v44
    v_exp_f32 v45, v45
    buffer_load_dwordx4 v0, s[8:11], s43 offen offset:1024 sc1 lds
    v_exp_f32 v46, v46
    v_exp_f32 v47, v47
    v_cvt_pk_bf16_f32 v72, v40, v41
    v_cvt_pk_bf16_f32 v73, v42, v43
    v_mfma_f32_32x32x16_bf16 v[24:39], v[108:111], v[76:79], v[24:39]
    ds_read_b128 v[108:111], v2 offset:7168
    v_exp_f32 v48, v48
    v_exp_f32 v49, v49
    s_add_u32 s50, s51, 460544
    buffer_load_dwordx4 v[128:131], v9, s[12:15], s50 offen
    v_exp_f32 v50, v50
    v_exp_f32 v51, v51
    v_cvt_pk_bf16_f32 v74, v44, v45
    v_cvt_pk_bf16_f32 v75, v46, v47
    v_exp_f32 v52, v52
    v_exp_f32 v53, v53
    v_mfma_f32_32x32x16_bf16 v[24:39], v[96:99], v[72:75], v[24:39]
    v_exp_f32 v54, v54
    v_exp_f32 v55, v55
    v_cvt_pk_bf16_f32 v76, v48, v49
    v_cvt_pk_bf16_f32 v77, v50, v51
    v_cvt_pk_bf16_f32 v78, v52, v53
    v_cvt_pk_bf16_f32 v79, v54, v55
    s_waitcnt lgkmcnt(0)
    ds_read_b128 v[88:91], v2 offset:20480
    v_mfma_f32_32x32x16_bf16 v[40:55], v[80:83], v[16:19], 0
    v_exp_f32 v56, v56
    v_exp_f32 v57, v57
    s_add_u32 m0, s41, 73728
    s_add_u32 s43, s40, 122880
    buffer_load_dwordx4 v0, s[8:11], s43 offen offset:0 sc1 lds
    ds_read_b128 v[92:95], v2 offset:21504
    v_exp_f32 v58, v58
    v_exp_f32 v59, v59
    v_mfma_f32_32x32x16_bf16 v[40:55], v[84:87], v[20:23], v[40:55]
    ds_read_b128 v[96:99], v2 offset:18432
    v_exp_f32 v60, v60
    v_exp_f32 v61, v61
    buffer_load_dwordx4 v0, s[8:11], s43 offen offset:1024 sc1 lds
    v_exp_f32 v62, v62
    v_exp_f32 v63, v63
    v_cvt_pk_bf16_f32 v72, v56, v57
    v_cvt_pk_bf16_f32 v73, v58, v59
    v_mfma_f32_32x32x16_bf16 v[24:39], v[104:107], v[76:79], v[24:39]
    ds_read_b128 v[104:107], v2 offset:19456
    v_exp_f32 v64, v64
    v_exp_f32 v65, v65
    s_add_u32 s50, s51, 575232
    buffer_load_dwordx4 v[132:135], v9, s[12:15], s50 offen
    v_exp_f32 v66, v66
    v_exp_f32 v67, v67
    v_cvt_pk_bf16_f32 v74, v60, v61
    v_cvt_pk_bf16_f32 v75, v62, v63
    v_exp_f32 v68, v68
    v_exp_f32 v69, v69
    v_mfma_f32_32x32x16_bf16 v[24:39], v[100:103], v[72:75], v[24:39]
    v_exp_f32 v70, v70
    v_exp_f32 v71, v71
    v_cvt_pk_bf16_f32 v76, v64, v65
    v_cvt_pk_bf16_f32 v77, v66, v67
    v_cvt_pk_bf16_f32 v78, v68, v69
    v_cvt_pk_bf16_f32 v79, v70, v71
    s_waitcnt vmcnt(13)
    s_barrier
    s_waitcnt lgkmcnt(0)
    ds_read_b128 v[80:83], v2 offset:32768
    v_mfma_f32_32x32x16_bf16 v[56:71], v[88:91], v[16:19], 0
    v_exp_f32 v40, v40
    v_exp_f32 v41, v41
    s_add_u32 m0, s41, 0
    s_add_u32 s43, s40, 61440
    buffer_load_dwordx4 v0, s[8:11], s43 offen offset:0 sc1 lds
    ds_read_b128 v[84:87], v2 offset:33792
    v_exp_f32 v42, v42
    v_exp_f32 v43, v43
    v_mfma_f32_32x32x16_bf16 v[56:71], v[92:95], v[20:23], v[56:71]
    ds_read_b128 v[100:103], v2 offset:22528
    v_exp_f32 v44, v44
    v_exp_f32 v45, v45
    buffer_load_dwordx4 v0, s[8:11], s43 offen offset:1024 sc1 lds
    v_exp_f32 v46, v46
    v_exp_f32 v47, v47
    v_cvt_pk_bf16_f32 v72, v40, v41
    v_cvt_pk_bf16_f32 v73, v42, v43
    v_mfma_f32_32x32x16_bf16 v[24:39], v[108:111], v[76:79], v[24:39]
    ds_read_b128 v[108:111], v2 offset:23552
    v_exp_f32 v48, v48
    v_exp_f32 v49, v49
    s_add_u32 s50, s51, 689920
    buffer_load_dwordx4 v[136:139], v9, s[12:15], s50 offen
    v_exp_f32 v50, v50
    v_exp_f32 v51, v51
    v_cvt_pk_bf16_f32 v74, v44, v45
    v_cvt_pk_bf16_f32 v75, v46, v47
    v_exp_f32 v52, v52
    v_exp_f32 v53, v53
    v_mfma_f32_32x32x16_bf16 v[24:39], v[96:99], v[72:75], v[24:39]
    v_exp_f32 v54, v54
    v_exp_f32 v55, v55
    v_cvt_pk_bf16_f32 v76, v48, v49
    v_cvt_pk_bf16_f32 v77, v50, v51
    v_cvt_pk_bf16_f32 v78, v52, v53
    v_cvt_pk_bf16_f32 v79, v54, v55
    s_waitcnt lgkmcnt(0)
    ds_read_b128 v[88:91], v2 offset:36864
    v_mfma_f32_32x32x16_bf16 v[40:55], v[80:83], v[16:19], 0
    v_exp_f32 v56, v56
    v_exp_f32 v57, v57
    s_add_u32 m0, s41, 8192
    s_add_u32 s43, s40, 126976
    buffer_load_dwordx4 v0, s[8:11], s43 offen offset:0 sc1 lds
    ds_read_b128 v[92:95], v2 offset:37888
    v_exp_f32 v58, v58
    v_exp_f32 v59, v59
    v_mfma_f32_32x32x16_bf16 v[40:55], v[84:87], v[20:23], v[40:55]
    ds_read_b128 v[96:99], v2 offset:34816
    v_exp_f32 v60, v60
    v_exp_f32 v61, v61
    buffer_load_dwordx4 v0, s[8:11], s43 offen offset:1024 sc1 lds
    v_exp_f32 v62, v62
    v_exp_f32 v63, v63
    v_cvt_pk_bf16_f32 v72, v56, v57
    v_cvt_pk_bf16_f32 v73, v58, v59
    v_mfma_f32_32x32x16_bf16 v[24:39], v[104:107], v[76:79], v[24:39]
    ds_read_b128 v[104:107], v2 offset:35840
    v_exp_f32 v64, v64
    v_exp_f32 v65, v65
    s_add_u32 s50, s51, 804608
    buffer_load_dwordx4 v[140:143], v9, s[12:15], s50 offen
    v_exp_f32 v66, v66
    v_exp_f32 v67, v67
    v_cvt_pk_bf16_f32 v74, v60, v61
    v_cvt_pk_bf16_f32 v75, v62, v63
    v_exp_f32 v68, v68
    v_exp_f32 v69, v69
    v_mfma_f32_32x32x16_bf16 v[24:39], v[100:103], v[72:75], v[24:39]
    v_exp_f32 v70, v70
    v_exp_f32 v71, v71
    v_cvt_pk_bf16_f32 v76, v64, v65
    v_cvt_pk_bf16_f32 v77, v66, v67
    v_cvt_pk_bf16_f32 v78, v68, v69
    v_cvt_pk_bf16_f32 v79, v70, v71
    s_waitcnt vmcnt(13)
    s_barrier
    s_waitcnt lgkmcnt(0)
    ds_read_b128 v[80:83], v2 offset:49152
    v_mfma_f32_32x32x16_bf16 v[56:71], v[88:91], v[16:19], 0
    v_exp_f32 v40, v40
    v_exp_f32 v41, v41
    ds_read_b128 v[84:87], v2 offset:50176
    v_exp_f32 v42, v42
    v_exp_f32 v43, v43
    v_mfma_f32_32x32x16_bf16 v[56:71], v[92:95], v[20:23], v[56:71]
    ds_read_b128 v[100:103], v2 offset:38912
    v_exp_f32 v44, v44
    v_exp_f32 v45, v45
    v_exp_f32 v46, v46
    v_exp_f32 v47, v47
    v_cvt_pk_bf16_f32 v72, v40, v41
    v_cvt_pk_bf16_f32 v73, v42, v43
    v_mfma_f32_32x32x16_bf16 v[24:39], v[108:111], v[76:79], v[24:39]
    ds_read_b128 v[108:111], v2 offset:39936
    v_exp_f32 v48, v48
    v_exp_f32 v49, v49
    s_add_u32 s50, s51, 919296
    buffer_load_dwordx4 v[144:147], v9, s[12:15], s50 offen
    v_exp_f32 v50, v50
    v_exp_f32 v51, v51
    v_cvt_pk_bf16_f32 v74, v44, v45
    v_cvt_pk_bf16_f32 v75, v46, v47
    v_exp_f32 v52, v52
    v_exp_f32 v53, v53
    v_mfma_f32_32x32x16_bf16 v[24:39], v[96:99], v[72:75], v[24:39]
    v_exp_f32 v54, v54
    v_exp_f32 v55, v55
    v_cvt_pk_bf16_f32 v76, v48, v49
    v_cvt_pk_bf16_f32 v77, v50, v51
    v_cvt_pk_bf16_f32 v78, v52, v53
    v_cvt_pk_bf16_f32 v79, v54, v55
    s_waitcnt lgkmcnt(0)
    ds_read_b128 v[88:91], v2 offset:53248
    v_mfma_f32_32x32x16_bf16 v[40:55], v[80:83], v[16:19], 0
    v_exp_f32 v56, v56
    v_exp_f32 v57, v57
    ds_read_b128 v[92:95], v2 offset:54272
    v_exp_f32 v58, v58
    v_exp_f32 v59, v59
    v_mfma_f32_32x32x16_bf16 v[40:55], v[84:87], v[20:23], v[40:55]
    ds_read_b128 v[96:99], v2 offset:51200
    v_exp_f32 v60, v60
    v_exp_f32 v61, v61
    v_exp_f32 v62, v62
    v_exp_f32 v63, v63
    v_cvt_pk_bf16_f32 v72, v56, v57
    v_cvt_pk_bf16_f32 v73, v58, v59
    v_mfma_f32_32x32x16_bf16 v[24:39], v[104:107], v[76:79], v[24:39]
    ds_read_b128 v[104:107], v2 offset:52224
    v_exp_f32 v64, v64
    v_exp_f32 v65, v65
    s_add_u32 s50, s51, 1033984
    buffer_load_dwordx4 v[148:151], v9, s[12:15], s50 offen
    v_exp_f32 v66, v66
    v_exp_f32 v67, v67
    v_cvt_pk_bf16_f32 v74, v60, v61
    v_cvt_pk_bf16_f32 v75, v62, v63
    v_exp_f32 v68, v68
    v_exp_f32 v69, v69
    v_mfma_f32_32x32x16_bf16 v[24:39], v[100:103], v[72:75], v[24:39]
    v_exp_f32 v70, v70
    v_exp_f32 v71, v71
    v_cvt_pk_bf16_f32 v76, v64, v65
    v_cvt_pk_bf16_f32 v77, v66, v67
    v_cvt_pk_bf16_f32 v78, v68, v69
    v_cvt_pk_bf16_f32 v79, v70, v71
    s_waitcnt vmcnt(9)
    s_barrier
    s_waitcnt lgkmcnt(0)
    ds_read_b128 v[80:83], v3 offset:0
    v_mfma_f32_32x32x16_bf16 v[56:71], v[88:91], v[16:19], 0
    v_exp_f32 v40, v40
    v_exp_f32 v41, v41
    ds_read_b128 v[84:87], v3 offset:1024
    v_exp_f32 v42, v42
    v_exp_f32 v43, v43
    v_mfma_f32_32x32x16_bf16 v[56:71], v[92:95], v[20:23], v[56:71]
    ds_read_b128 v[100:103], v2 offset:55296
    v_exp_f32 v44, v44
    v_exp_f32 v45, v45
    v_exp_f32 v46, v46
    v_exp_f32 v47, v47
    v_cvt_pk_bf16_f32 v72, v40, v41
    v_cvt_pk_bf16_f32 v73, v42, v43
    v_mfma_f32_32x32x16_bf16 v[24:39], v[108:111], v[76:79], v[24:39]
    ds_read_b128 v[108:111], v2 offset:56320
    v_exp_f32 v48, v48
    v_exp_f32 v49, v49
    s_add_u32 s50, s51, 1148672
    buffer_load_dwordx4 v[152:155], v9, s[12:15], s50 offen
    v_exp_f32 v50, v50
    v_exp_f32 v51, v51
    v_cvt_pk_bf16_f32 v74, v44, v45
    v_cvt_pk_bf16_f32 v75, v46, v47
    v_exp_f32 v52, v52
    v_exp_f32 v53, v53
    v_mfma_f32_32x32x16_bf16 v[24:39], v[96:99], v[72:75], v[24:39]
    v_exp_f32 v54, v54
    v_exp_f32 v55, v55
    v_cvt_pk_bf16_f32 v76, v48, v49
    v_cvt_pk_bf16_f32 v77, v50, v51
    v_cvt_pk_bf16_f32 v78, v52, v53
    v_cvt_pk_bf16_f32 v79, v54, v55
    s_waitcnt lgkmcnt(0)
    ds_read_b128 v[88:91], v3 offset:4096
    v_mfma_f32_32x32x16_bf16 v[40:55], v[80:83], v[16:19], 0
    v_exp_f32 v56, v56
    v_exp_f32 v57, v57
    ds_read_b128 v[92:95], v3 offset:5120
    v_exp_f32 v58, v58
    v_exp_f32 v59, v59
    v_mfma_f32_32x32x16_bf16 v[40:55], v[84:87], v[20:23], v[40:55]
    ds_read_b128 v[96:99], v3 offset:2048
    v_exp_f32 v60, v60
    v_exp_f32 v61, v61
    v_exp_f32 v62, v62
    v_exp_f32 v63, v63
    v_cvt_pk_bf16_f32 v72, v56, v57
    v_cvt_pk_bf16_f32 v73, v58, v59
    v_mfma_f32_32x32x16_bf16 v[24:39], v[104:107], v[76:79], v[24:39]
    ds_read_b128 v[104:107], v3 offset:3072
    v_exp_f32 v64, v64
    v_exp_f32 v65, v65
    s_add_u32 s50, s51, 1263360
    buffer_load_dwordx4 v[156:159], v9, s[12:15], s50 offen
    v_exp_f32 v66, v66
    v_exp_f32 v67, v67
    v_cvt_pk_bf16_f32 v74, v60, v61
    v_cvt_pk_bf16_f32 v75, v62, v63
    v_exp_f32 v68, v68
    v_exp_f32 v69, v69
    v_mfma_f32_32x32x16_bf16 v[24:39], v[100:103], v[72:75], v[24:39]
    v_exp_f32 v70, v70
    v_exp_f32 v71, v71
    v_cvt_pk_bf16_f32 v76, v64, v65
    v_cvt_pk_bf16_f32 v77, v66, v67
    v_cvt_pk_bf16_f32 v78, v68, v69
    v_cvt_pk_bf16_f32 v79, v70, v71
    s_waitcnt vmcnt(5)
    s_barrier
    s_waitcnt lgkmcnt(0)
    ds_read_b128 v[80:83], v2 offset:0
    v_mfma_f32_32x32x16_bf16 v[56:71], v[88:91], v[16:19], 0
    v_exp_f32 v40, v40
    v_exp_f32 v41, v41
    ds_read_b128 v[84:87], v2 offset:1024
    v_exp_f32 v42, v42
    v_exp_f32 v43, v43
    v_mfma_f32_32x32x16_bf16 v[56:71], v[92:95], v[20:23], v[56:71]
    ds_read_b128 v[100:103], v3 offset:6144
    v_exp_f32 v44, v44
    v_exp_f32 v45, v45
    v_exp_f32 v46, v46
    v_exp_f32 v47, v47
    v_cvt_pk_bf16_f32 v72, v40, v41
    v_cvt_pk_bf16_f32 v73, v42, v43
    v_mfma_f32_32x32x16_bf16 v[24:39], v[108:111], v[76:79], v[24:39]
    ds_read_b128 v[108:111], v3 offset:7168
    v_exp_f32 v48, v48
    v_exp_f32 v49, v49
    s_add_u32 s50, s51, 1378048
    buffer_load_dwordx4 v[160:163], v9, s[12:15], s50 offen
    v_exp_f32 v50, v50
    v_exp_f32 v51, v51
    v_cvt_pk_bf16_f32 v74, v44, v45
    v_cvt_pk_bf16_f32 v75, v46, v47
    v_exp_f32 v52, v52
    v_exp_f32 v53, v53
    v_mfma_f32_32x32x16_bf16 v[24:39], v[96:99], v[72:75], v[24:39]
    v_exp_f32 v54, v54
    v_exp_f32 v55, v55
    v_cvt_pk_bf16_f32 v76, v48, v49
    v_cvt_pk_bf16_f32 v77, v50, v51
    v_cvt_pk_bf16_f32 v78, v52, v53
    v_cvt_pk_bf16_f32 v79, v54, v55
    s_waitcnt lgkmcnt(0)
    ds_read_b128 v[88:91], v2 offset:4096
    v_mfma_f32_32x32x16_bf16 v[40:55], v[80:83], v[16:19], 0
    v_exp_f32 v56, v56
    v_exp_f32 v57, v57
    ds_read_b128 v[92:95], v2 offset:5120
    v_exp_f32 v58, v58
    v_exp_f32 v59, v59
    v_mfma_f32_32x32x16_bf16 v[40:55], v[84:87], v[20:23], v[40:55]
    ds_read_b128 v[96:99], v2 offset:2048
    v_exp_f32 v60, v60
    v_exp_f32 v61, v61
    v_exp_f32 v62, v62
    v_exp_f32 v63, v63
    v_cvt_pk_bf16_f32 v72, v56, v57
    v_cvt_pk_bf16_f32 v73, v58, v59
    v_mfma_f32_32x32x16_bf16 v[24:39], v[104:107], v[76:79], v[24:39]
    ds_read_b128 v[104:107], v2 offset:3072
    v_exp_f32 v64, v64
    v_exp_f32 v65, v65
    s_add_u32 s50, s51, 1492736
    buffer_load_dwordx4 v[164:167], v9, s[12:15], s50 offen
    v_exp_f32 v66, v66
    v_exp_f32 v67, v67
    v_cvt_pk_bf16_f32 v74, v60, v61
    v_cvt_pk_bf16_f32 v75, v62, v63
    v_exp_f32 v68, v68
    v_exp_f32 v69, v69
    v_mfma_f32_32x32x16_bf16 v[24:39], v[100:103], v[72:75], v[24:39]
    v_exp_f32 v70, v70
    v_exp_f32 v71, v71
    v_cvt_pk_bf16_f32 v76, v64, v65
    v_cvt_pk_bf16_f32 v77, v66, v67
    v_cvt_pk_bf16_f32 v78, v68, v69
    v_cvt_pk_bf16_f32 v79, v70, v71
    s_waitcnt lgkmcnt(0)
    v_mfma_f32_32x32x16_bf16 v[56:71], v[88:91], v[16:19], 0
    v_exp_f32 v40, v40
    v_exp_f32 v41, v41
    v_exp_f32 v42, v42
    v_exp_f32 v43, v43
    v_mfma_f32_32x32x16_bf16 v[56:71], v[92:95], v[20:23], v[56:71]
    ds_read_b128 v[100:103], v2 offset:6144
    v_exp_f32 v44, v44
    v_exp_f32 v45, v45
    v_exp_f32 v46, v46
    v_exp_f32 v47, v47
    v_cvt_pk_bf16_f32 v72, v40, v41
    v_cvt_pk_bf16_f32 v73, v42, v43
    v_mfma_f32_32x32x16_bf16 v[24:39], v[108:111], v[76:79], v[24:39]
    ds_read_b128 v[108:111], v2 offset:7168
    v_exp_f32 v48, v48
    v_exp_f32 v49, v49
    v_exp_f32 v50, v50
    v_exp_f32 v51, v51
    v_cvt_pk_bf16_f32 v74, v44, v45
    v_cvt_pk_bf16_f32 v75, v46, v47
    v_exp_f32 v52, v52
    v_exp_f32 v53, v53
    v_mfma_f32_32x32x16_bf16 v[24:39], v[96:99], v[72:75], v[24:39]
    v_exp_f32 v54, v54
    v_exp_f32 v55, v55
    v_cvt_pk_bf16_f32 v76, v48, v49
    v_cvt_pk_bf16_f32 v77, v50, v51
    v_cvt_pk_bf16_f32 v78, v52, v53
    v_cvt_pk_bf16_f32 v79, v54, v55
    s_waitcnt lgkmcnt(0)
    v_exp_f32 v56, v56
    v_exp_f32 v57, v57
    v_exp_f32 v58, v58
    v_exp_f32 v59, v59
    v_exp_f32 v60, v60
    v_exp_f32 v61, v61
    v_exp_f32 v62, v62
    v_exp_f32 v63, v63
    v_cvt_pk_bf16_f32 v72, v56, v57
    v_cvt_pk_bf16_f32 v73, v58, v59
    v_mfma_f32_32x32x16_bf16 v[24:39], v[104:107], v[76:79], v[24:39]
    v_exp_f32 v64, v64
    v_exp_f32 v65, v65
    v_exp_f32 v66, v66
    v_exp_f32 v67, v67
    v_cvt_pk_bf16_f32 v74, v60, v61
    v_cvt_pk_bf16_f32 v75, v62, v63
    v_exp_f32 v68, v68
    v_exp_f32 v69, v69
    v_mfma_f32_32x32x16_bf16 v[24:39], v[100:103], v[72:75], v[24:39]
    v_exp_f32 v70, v70
    v_exp_f32 v71, v71
    v_cvt_pk_bf16_f32 v76, v64, v65
    v_cvt_pk_bf16_f32 v77, v66, v67
    v_cvt_pk_bf16_f32 v78, v68, v69
    v_cvt_pk_bf16_f32 v79, v70, v71
    s_nop 1
    v_mfma_f32_32x32x16_bf16 v[24:39], v[108:111], v[76:79], v[24:39]
    s_setprio 0
    s_branch L_att_loopd_14
L_att_role1_13:
    v_add_u32 v3, 0x10000, v2
    s_barrier
    s_setprio 0
    s_barrier
    ds_read_b128 v[16:19], v4
    ds_read_b128 v[20:23], v4 offset:1024
    ds_read_b128 v[80:83], v2 offset:0
    ds_read_b128 v[84:87], v2 offset:1024
    ds_read_b128 v[88:91], v2 offset:4096
    ds_read_b128 v[92:95], v2 offset:5120
    ds_read_b128 v[104:107], v2 offset:3072
    ds_read_b128 v[96:99], v2 offset:2048
    s_waitcnt lgkmcnt(4)
    v_mfma_f32_32x32x16_bf16 v[40:55], v[80:83], v[16:19], 0
    v_mfma_f32_32x32x16_bf16 v[40:55], v[84:87], v[20:23], v[40:55]
    s_nop 9
    s_barrier
    s_waitcnt lgkmcnt(0)
    ds_read_b128 v[80:83], v2 offset:16384
    v_mfma_f32_32x32x16_bf16 v[56:71], v[88:91], v[16:19], 0
    v_exp_f32 v40, v40
    v_exp_f32 v41, v41
    ds_read_b128 v[84:87], v2 offset:17408
    v_exp_f32 v42, v42
    v_exp_f32 v43, v43
    v_mfma_f32_32x32x16_bf16 v[56:71], v[92:95], v[20:23], v[56:71]
    ds_read_b128 v[100:103], v2 offset:6144
    v_exp_f32 v44, v44
    v_exp_f32 v45, v45
    v_exp_f32 v46, v46
    v_exp_f32 v47, v47
    v_cvt_pk_bf16_f32 v72, v40, v41
    v_cvt_pk_bf16_f32 v73, v42, v43
    ds_read_b128 v[108:111], v2 offset:7168
    v_exp_f32 v48, v48
    v_exp_f32 v49, v49
    v_exp_f32 v50, v50
    v_exp_f32 v51, v51
    v_cvt_pk_bf16_f32 v74, v44, v45
    v_cvt_pk_bf16_f32 v75, v46, v47
    v_exp_f32 v52, v52
    v_exp_f32 v53, v53
    v_mfma_f32_32x32x16_bf16 v[24:39], v[96:99], v[72:75], v[24:39]
    v_exp_f32 v54, v54
    v_exp_f32 v55, v55
    v_cvt_pk_bf16_f32 v76, v48, v49
    v_cvt_pk_bf16_f32 v77, v50, v51
    v_cvt_pk_bf16_f32 v78, v52, v53
    v_cvt_pk_bf16_f32 v79, v54, v55
    s_waitcnt lgkmcnt(0)
    ds_read_b128 v[88:91], v2 offset:20480
    v_mfma_f32_32x32x16_bf16 v[40:55], v[80:83], v[16:19], 0
    v_exp_f32 v56, v56
    v_exp_f32 v57, v57
    ds_read_b128 v[92:95], v2 offset:21504
    v_exp_f32 v58, v58
    v_exp_f32 v59, v59
    v_mfma_f32_32x32x16_bf16 v[40:55], v[84:87], v[20:23], v[40:55]
    ds_read_b128 v[96:99], v2 offset:18432
    v_exp_f32 v60, v60
    v_exp_f32 v61, v61
    v_exp_f32 v62, v62
    v_exp_f32 v63, v63
    v_cvt_pk_bf16_f32 v72, v56, v57
    v_cvt_pk_bf16_f32 v73, v58, v59
    v_mfma_f32_32x32x16_bf16 v[24:39], v[104:107], v[76:79], v[24:39]
    ds_read_b128 v[104:107], v2 offset:19456
    v_exp_f32 v64, v64
    v_exp_f32 v65, v65
    v_exp_f32 v66, v66
    v_exp_f32 v67, v67
    v_cvt_pk_bf16_f32 v74, v60, v61
    v_cvt_pk_bf16_f32 v75, v62, v63
    v_exp_f32 v68, v68
    v_exp_f32 v69, v69
    v_mfma_f32_32x32x16_bf16 v[24:39], v[100:103], v[72:75], v[24:39]
    v_exp_f32 v70, v70
    v_exp_f32 v71, v71
    v_cvt_pk_bf16_f32 v76, v64, v65
    v_cvt_pk_bf16_f32 v77, v66, v67
    v_cvt_pk_bf16_f32 v78, v68, v69
    v_cvt_pk_bf16_f32 v79, v70, v71
    s_barrier
    s_waitcnt lgkmcnt(0)
    ds_read_b128 v[80:83], v2 offset:32768
    v_mfma_f32_32x32x16_bf16 v[56:71], v[88:91], v[16:19], 0
    v_exp_f32 v40, v40
    v_exp_f32 v41, v41
    ds_read_b128 v[84:87], v2 offset:33792
    v_exp_f32 v42, v42
    v_exp_f32 v43, v43
    v_mfma_f32_32x32x16_bf16 v[56:71], v[92:95], v[20:23], v[56:71]
    ds_read_b128 v[100:103], v2 offset:22528
    v_exp_f32 v44, v44
    v_exp_f32 v45, v45
    v_exp_f32 v46, v46
    v_exp_f32 v47, v47
    v_cvt_pk_bf16_f32 v72, v40, v41
    v_cvt_pk_bf16_f32 v73, v42, v43
    v_mfma_f32_32x32x16_bf16 v[24:39], v[108:111], v[76:79], v[24:39]
    ds_read_b128 v[108:111], v2 offset:23552
    v_exp_f32 v48, v48
    v_exp_f32 v49, v49
    v_exp_f32 v50, v50
    v_exp_f32 v51, v51
    v_cvt_pk_bf16_f32 v74, v44, v45
    v_cvt_pk_bf16_f32 v75, v46, v47
    v_exp_f32 v52, v52
    v_exp_f32 v53, v53
    v_mfma_f32_32x32x16_bf16 v[24:39], v[96:99], v[72:75], v[24:39]
    v_exp_f32 v54, v54
    v_exp_f32 v55, v55
    v_cvt_pk_bf16_f32 v76, v48, v49
    v_cvt_pk_bf16_f32 v77, v50, v51
    v_cvt_pk_bf16_f32 v78, v52, v53
    v_cvt_pk_bf16_f32 v79, v54, v55
    s_waitcnt lgkmcnt(0)
    ds_read_b128 v[88:91], v2 offset:36864
    v_mfma_f32_32x32x16_bf16 v[40:55], v[80:83], v[16:19], 0
    v_exp_f32 v56, v56
    v_exp_f32 v57, v57
    ds_read_b128 v[92:95], v2 offset:37888
    v_exp_f32 v58, v58
    v_exp_f32 v59, v59
    v_mfma_f32_32x32x16_bf16 v[40:55], v[84:87], v[20:23], v[40:55]
    ds_read_b128 v[96:99], v2 offset:34816
    v_exp_f32 v60, v60
    v_exp_f32 v61, v61
    v_exp_f32 v62, v62
    v_exp_f32 v63, v63
    v_cvt_pk_bf16_f32 v72, v56, v57
    v_cvt_pk_bf16_f32 v73, v58, v59
    v_mfma_f32_32x32x16_bf16 v[24:39], v[104:107], v[76:79], v[24:39]
    ds_read_b128 v[104:107], v2 offset:35840
    v_exp_f32 v64, v64
    v_exp_f32 v65, v65
    v_exp_f32 v66, v66
    v_exp_f32 v67, v67
    v_cvt_pk_bf16_f32 v74, v60, v61
    v_cvt_pk_bf16_f32 v75, v62, v63
    v_exp_f32 v68, v68
    v_exp_f32 v69, v69
    v_mfma_f32_32x32x16_bf16 v[24:39], v[100:103], v[72:75], v[24:39]
    v_exp_f32 v70, v70
    v_exp_f32 v71, v71
    v_cvt_pk_bf16_f32 v76, v64, v65
    v_cvt_pk_bf16_f32 v77, v66, v67
    v_cvt_pk_bf16_f32 v78, v68, v69
    v_cvt_pk_bf16_f32 v79, v70, v71
    s_barrier
    s_waitcnt lgkmcnt(0)
    ds_read_b128 v[80:83], v2 offset:49152
    v_mfma_f32_32x32x16_bf16 v[56:71], v[88:91], v[16:19], 0
    v_exp_f32 v40, v40
    v_exp_f32 v41, v41
    ds_read_b128 v[84:87], v2 offset:50176
    v_exp_f32 v42, v42
    v_exp_f32 v43, v43
    v_mfma_f32_32x32x16_bf16 v[56:71], v[92:95], v[20:23], v[56:71]
    ds_read_b128 v[100:103], v2 offset:38912
    v_exp_f32 v44, v44
    v_exp_f32 v45, v45
    v_exp_f32 v46, v46
    v_exp_f32 v47, v47
    v_cvt_pk_bf16_f32 v72, v40, v41
    v_cvt_pk_bf16_f32 v73, v42, v43
    v_mfma_f32_32x32x16_bf16 v[24:39], v[108:111], v[76:79], v[24:39]
    ds_read_b128 v[108:111], v2 offset:39936
    v_exp_f32 v48, v48
    v_exp_f32 v49, v49
    v_exp_f32 v50, v50
    v_exp_f32 v51, v51
    v_cvt_pk_bf16_f32 v74, v44, v45
    v_cvt_pk_bf16_f32 v75, v46, v47
    v_exp_f32 v52, v52
    v_exp_f32 v53, v53
    v_mfma_f32_32x32x16_bf16 v[24:39], v[96:99], v[72:75], v[24:39]
    v_exp_f32 v54, v54
    v_exp_f32 v55, v55
    v_cvt_pk_bf16_f32 v76, v48, v49
    v_cvt_pk_bf16_f32 v77, v50, v51
    v_cvt_pk_bf16_f32 v78, v52, v53
    v_cvt_pk_bf16_f32 v79, v54, v55
    s_waitcnt lgkmcnt(0)
    ds_read_b128 v[88:91], v2 offset:53248
    v_mfma_f32_32x32x16_bf16 v[40:55], v[80:83], v[16:19], 0
    v_exp_f32 v56, v56
    v_exp_f32 v57, v57
    ds_read_b128 v[92:95], v2 offset:54272
    v_exp_f32 v58, v58
    v_exp_f32 v59, v59
    v_mfma_f32_32x32x16_bf16 v[40:55], v[84:87], v[20:23], v[40:55]
    ds_read_b128 v[96:99], v2 offset:51200
    v_exp_f32 v60, v60
    v_exp_f32 v61, v61
    v_exp_f32 v62, v62
    v_exp_f32 v63, v63
    v_cvt_pk_bf16_f32 v72, v56, v57
    v_cvt_pk_bf16_f32 v73, v58, v59
    v_mfma_f32_32x32x16_bf16 v[24:39], v[104:107], v[76:79], v[24:39]
    ds_read_b128 v[104:107], v2 offset:52224
    v_exp_f32 v64, v64
    v_exp_f32 v65, v65
    v_exp_f32 v66, v66
    v_exp_f32 v67, v67
    v_cvt_pk_bf16_f32 v74, v60, v61
    v_cvt_pk_bf16_f32 v75, v62, v63
    v_exp_f32 v68, v68
    v_exp_f32 v69, v69
    v_mfma_f32_32x32x16_bf16 v[24:39], v[100:103], v[72:75], v[24:39]
    v_exp_f32 v70, v70
    v_exp_f32 v71, v71
    v_cvt_pk_bf16_f32 v76, v64, v65
    v_cvt_pk_bf16_f32 v77, v66, v67
    v_cvt_pk_bf16_f32 v78, v68, v69
    v_cvt_pk_bf16_f32 v79, v70, v71
    s_barrier
    s_waitcnt lgkmcnt(0)
    ds_read_b128 v[80:83], v3 offset:0
    v_mfma_f32_32x32x16_bf16 v[56:71], v[88:91], v[16:19], 0
    v_exp_f32 v40, v40
    v_exp_f32 v41, v41
    ds_read_b128 v[84:87], v3 offset:1024
    v_exp_f32 v42, v42
    v_exp_f32 v43, v43
    v_mfma_f32_32x32x16_bf16 v[56:71], v[92:95], v[20:23], v[56:71]
    ds_read_b128 v[100:103], v2 offset:55296
    v_exp_f32 v44, v44
    v_exp_f32 v45, v45
    v_exp_f32 v46, v46
    v_exp_f32 v47, v47
    v_cvt_pk_bf16_f32 v72, v40, v41
    v_cvt_pk_bf16_f32 v73, v42, v43
    v_mfma_f32_32x32x16_bf16 v[24:39], v[108:111], v[76:79], v[24:39]
    ds_read_b128 v[108:111], v2 offset:56320
    v_exp_f32 v48, v48
    v_exp_f32 v49, v49
    v_exp_f32 v50, v50
    v_exp_f32 v51, v51
    v_cvt_pk_bf16_f32 v74, v44, v45
    v_cvt_pk_bf16_f32 v75, v46, v47
    v_exp_f32 v52, v52
    v_exp_f32 v53, v53
    v_mfma_f32_32x32x16_bf16 v[24:39], v[96:99], v[72:75], v[24:39]
    v_exp_f32 v54, v54
    v_exp_f32 v55, v55
    v_cvt_pk_bf16_f32 v76, v48, v49
    v_cvt_pk_bf16_f32 v77, v50, v51
    v_cvt_pk_bf16_f32 v78, v52, v53
    v_cvt_pk_bf16_f32 v79, v54, v55
    s_waitcnt lgkmcnt(0)
    ds_read_b128 v[88:91], v3 offset:4096
    v_mfma_f32_32x32x16_bf16 v[40:55], v[80:83], v[16:19], 0
    v_exp_f32 v56, v56
    v_exp_f32 v57, v57
    ds_read_b128 v[92:95], v3 offset:5120
    v_exp_f32 v58, v58
    v_exp_f32 v59, v59
    v_mfma_f32_32x32x16_bf16 v[40:55], v[84:87], v[20:23], v[40:55]
    ds_read_b128 v[96:99], v3 offset:2048
    v_exp_f32 v60, v60
    v_exp_f32 v61, v61
    v_exp_f32 v62, v62
    v_exp_f32 v63, v63
    v_cvt_pk_bf16_f32 v72, v56, v57
    v_cvt_pk_bf16_f32 v73, v58, v59
    v_mfma_f32_32x32x16_bf16 v[24:39], v[104:107], v[76:79], v[24:39]
    ds_read_b128 v[104:107], v3 offset:3072
    v_exp_f32 v64, v64
    v_exp_f32 v65, v65
    v_exp_f32 v66, v66
    v_exp_f32 v67, v67
    v_cvt_pk_bf16_f32 v74, v60, v61
    v_cvt_pk_bf16_f32 v75, v62, v63
    v_exp_f32 v68, v68
    v_exp_f32 v69, v69
    v_mfma_f32_32x32x16_bf16 v[24:39], v[100:103], v[72:75], v[24:39]
    v_exp_f32 v70, v70
    v_exp_f32 v71, v71
    v_cvt_pk_bf16_f32 v76, v64, v65
    v_cvt_pk_bf16_f32 v77, v66, v67
    v_cvt_pk_bf16_f32 v78, v68, v69
    v_cvt_pk_bf16_f32 v79, v70, v71
    s_barrier
    s_waitcnt lgkmcnt(0)
    ds_read_b128 v[80:83], v2 offset:0
    v_mfma_f32_32x32x16_bf16 v[56:71], v[88:91], v[16:19], 0
    v_exp_f32 v40, v40
    v_exp_f32 v41, v41
    ds_read_b128 v[84:87], v2 offset:1024
    v_exp_f32 v42, v42
    v_exp_f32 v43, v43
    v_mfma_f32_32x32x16_bf16 v[56:71], v[92:95], v[20:23], v[56:71]
    ds_read_b128 v[100:103], v3 offset:6144
    v_exp_f32 v44, v44
    v_exp_f32 v45, v45
    v_exp_f32 v46, v46
    v_exp_f32 v47, v47
    v_cvt_pk_bf16_f32 v72, v40, v41
    v_cvt_pk_bf16_f32 v73, v42, v43
    v_mfma_f32_32x32x16_bf16 v[24:39], v[108:111], v[76:79], v[24:39]
    ds_read_b128 v[108:111], v3 offset:7168
    v_exp_f32 v48, v48
    v_exp_f32 v49, v49
    v_exp_f32 v50, v50
    v_exp_f32 v51, v51
    v_cvt_pk_bf16_f32 v74, v44, v45
    v_cvt_pk_bf16_f32 v75, v46, v47
    v_exp_f32 v52, v52
    v_exp_f32 v53, v53
    v_mfma_f32_32x32x16_bf16 v[24:39], v[96:99], v[72:75], v[24:39]
    v_exp_f32 v54, v54
    v_exp_f32 v55, v55
    v_cvt_pk_bf16_f32 v76, v48, v49
    v_cvt_pk_bf16_f32 v77, v50, v51
    v_cvt_pk_bf16_f32 v78, v52, v53
    v_cvt_pk_bf16_f32 v79, v54, v55
    s_waitcnt lgkmcnt(0)
    ds_read_b128 v[88:91], v2 offset:4096
    v_mfma_f32_32x32x16_bf16 v[40:55], v[80:83], v[16:19], 0
    v_exp_f32 v56, v56
    v_exp_f32 v57, v57
    ds_read_b128 v[92:95], v2 offset:5120
    v_exp_f32 v58, v58
    v_exp_f32 v59, v59
    v_mfma_f32_32x32x16_bf16 v[40:55], v[84:87], v[20:23], v[40:55]
    ds_read_b128 v[96:99], v2 offset:2048
    v_exp_f32 v60, v60
    v_exp_f32 v61, v61
    v_exp_f32 v62, v62
    v_exp_f32 v63, v63
    v_cvt_pk_bf16_f32 v72, v56, v57
    v_cvt_pk_bf16_f32 v73, v58, v59
    v_mfma_f32_32x32x16_bf16 v[24:39], v[104:107], v[76:79], v[24:39]
    ds_read_b128 v[104:107], v2 offset:3072
    v_exp_f32 v64, v64
    v_exp_f32 v65, v65
    v_exp_f32 v66, v66
    v_exp_f32 v67, v67
    v_cvt_pk_bf16_f32 v74, v60, v61
    v_cvt_pk_bf16_f32 v75, v62, v63
    v_exp_f32 v68, v68
    v_exp_f32 v69, v69
    v_mfma_f32_32x32x16_bf16 v[24:39], v[100:103], v[72:75], v[24:39]
    v_exp_f32 v70, v70
    v_exp_f32 v71, v71
    v_cvt_pk_bf16_f32 v76, v64, v65
    v_cvt_pk_bf16_f32 v77, v66, v67
    v_cvt_pk_bf16_f32 v78, v68, v69
    v_cvt_pk_bf16_f32 v79, v70, v71
    s_barrier
    s_waitcnt lgkmcnt(0)
    ds_read_b128 v[80:83], v2 offset:16384
    v_mfma_f32_32x32x16_bf16 v[56:71], v[88:91], v[16:19], 0
    v_exp_f32 v40, v40
    v_exp_f32 v41, v41
    ds_read_b128 v[84:87], v2 offset:17408
    v_exp_f32 v42, v42
    v_exp_f32 v43, v43
    v_mfma_f32_32x32x16_bf16 v[56:71], v[92:95], v[20:23], v[56:71]
    ds_read_b128 v[100:103], v2 offset:6144
    v_exp_f32 v44, v44
    v_exp_f32 v45, v45
    v_exp_f32 v46, v46
    v_exp_f32 v47, v47
    v_cvt_pk_bf16_f32 v72, v40, v41
    v_cvt_pk_bf16_f32 v73, v42, v43
    v_mfma_f32_32x32x16_bf16 v[24:39], v[108:111], v[76:79], v[24:39]
    ds_read_b128 v[108:111], v2 offset:7168
    v_exp_f32 v48, v48
    v_exp_f32 v49, v49
    v_exp_f32 v50, v50
    v_exp_f32 v51, v51
    v_cvt_pk_bf16_f32 v74, v44, v45
    v_cvt_pk_bf16_f32 v75, v46, v47
    v_exp_f32 v52, v52
    v_exp_f32 v53, v53
    v_mfma_f32_32x32x16_bf16 v[24:39], v[96:99], v[72:75], v[24:39]
    v_exp_f32 v54, v54
    v_exp_f32 v55, v55
    v_cvt_pk_bf16_f32 v76, v48, v49
    v_cvt_pk_bf16_f32 v77, v50, v51
    v_cvt_pk_bf16_f32 v78, v52, v53
    v_cvt_pk_bf16_f32 v79, v54, v55
    s_waitcnt lgkmcnt(0)
    ds_read_b128 v[88:91], v2 offset:20480
    v_mfma_f32_32x32x16_bf16 v[40:55], v[80:83], v[16:19], 0
    v_exp_f32 v56, v56
    v_exp_f32 v57, v57
    ds_read_b128 v[92:95], v2 offset:21504
    v_exp_f32 v58, v58
    v_exp_f32 v59, v59
    v_mfma_f32_32x32x16_bf16 v[40:55], v[84:87], v[20:23], v[40:55]
    ds_read_b128 v[96:99], v2 offset:18432
    v_exp_f32 v60, v60
    v_exp_f32 v61, v61
    v_exp_f32 v62, v62
    v_exp_f32 v63, v63
    v_cvt_pk_bf16_f32 v72, v56, v57
    v_cvt_pk_bf16_f32 v73, v58, v59
    v_mfma_f32_32x32x16_bf16 v[24:39], v[104:107], v[76:79], v[24:39]
    ds_read_b128 v[104:107], v2 offset:19456
    v_exp_f32 v64, v64
    v_exp_f32 v65, v65
    v_exp_f32 v66, v66
    v_exp_f32 v67, v67
    v_cvt_pk_bf16_f32 v74, v60, v61
    v_cvt_pk_bf16_f32 v75, v62, v63
    v_exp_f32 v68, v68
    v_exp_f32 v69, v69
    v_mfma_f32_32x32x16_bf16 v[24:39], v[100:103], v[72:75], v[24:39]
    v_exp_f32 v70, v70
    v_exp_f32 v71, v71
    v_cvt_pk_bf16_f32 v76, v64, v65
    v_cvt_pk_bf16_f32 v77, v66, v67
    v_cvt_pk_bf16_f32 v78, v68, v69
    v_cvt_pk_bf16_f32 v79, v70, v71
    s_barrier
    s_waitcnt lgkmcnt(0)
    ds_read_b128 v[80:83], v2 offset:32768
    v_mfma_f32_32x32x16_bf16 v[56:71], v[88:91], v[16:19], 0
    v_exp_f32 v40, v40
    v_exp_f32 v41, v41
    ds_read_b128 v[84:87], v2 offset:33792
    v_exp_f32 v42, v42
    v_exp_f32 v43, v43
    v_mfma_f32_32x32x16_bf16 v[56:71], v[92:95], v[20:23], v[56:71]
    ds_read_b128 v[100:103], v2 offset:22528
    v_exp_f32 v44, v44
    v_exp_f32 v45, v45
    v_exp_f32 v46, v46
    v_exp_f32 v47, v47
    v_cvt_pk_bf16_f32 v72, v40, v41
    v_cvt_pk_bf16_f32 v73, v42, v43
    v_mfma_f32_32x32x16_bf16 v[24:39], v[108:111], v[76:79], v[24:39]
    ds_read_b128 v[108:111], v2 offset:23552
    v_exp_f32 v48, v48
    v_exp_f32 v49, v49
    v_exp_f32 v50, v50
    v_exp_f32 v51, v51
    v_cvt_pk_bf16_f32 v74, v44, v45
    v_cvt_pk_bf16_f32 v75, v46, v47
    v_exp_f32 v52, v52
    v_exp_f32 v53, v53
    v_mfma_f32_32x32x16_bf16 v[24:39], v[96:99], v[72:75], v[24:39]
    v_exp_f32 v54, v54
    v_exp_f32 v55, v55
    v_cvt_pk_bf16_f32 v76, v48, v49
    v_cvt_pk_bf16_f32 v77, v50, v51
    v_cvt_pk_bf16_f32 v78, v52, v53
    v_cvt_pk_bf16_f32 v79, v54, v55
    s_waitcnt lgkmcnt(0)
    ds_read_b128 v[88:91], v2 offset:36864
    v_mfma_f32_32x32x16_bf16 v[40:55], v[80:83], v[16:19], 0
    v_exp_f32 v56, v56
    v_exp_f32 v57, v57
    ds_read_b128 v[92:95], v2 offset:37888
    v_exp_f32 v58, v58
    v_exp_f32 v59, v59
    v_mfma_f32_32x32x16_bf16 v[40:55], v[84:87], v[20:23], v[40:55]
    ds_read_b128 v[96:99], v2 offset:34816
    v_exp_f32 v60, v60
    v_exp_f32 v61, v61
    v_exp_f32 v62, v62
    v_exp_f32 v63, v63
    v_cvt_pk_bf16_f32 v72, v56, v57
    v_cvt_pk_bf16_f32 v73, v58, v59
    v_mfma_f32_32x32x16_bf16 v[24:39], v[104:107], v[76:79], v[24:39]
    ds_read_b128 v[104:107], v2 offset:35840
    v_exp_f32 v64, v64
    v_exp_f32 v65, v65
    v_exp_f32 v66, v66
    v_exp_f32 v67, v67
    v_cvt_pk_bf16_f32 v74, v60, v61
    v_cvt_pk_bf16_f32 v75, v62, v63
    v_exp_f32 v68, v68
    v_exp_f32 v69, v69
    v_mfma_f32_32x32x16_bf16 v[24:39], v[100:103], v[72:75], v[24:39]
    v_exp_f32 v70, v70
    v_exp_f32 v71, v71
    v_cvt_pk_bf16_f32 v76, v64, v65
    v_cvt_pk_bf16_f32 v77, v66, v67
    v_cvt_pk_bf16_f32 v78, v68, v69
    v_cvt_pk_bf16_f32 v79, v70, v71
    s_barrier
    s_waitcnt lgkmcnt(0)
    ds_read_b128 v[80:83], v2 offset:49152
    v_mfma_f32_32x32x16_bf16 v[56:71], v[88:91], v[16:19], 0
    v_exp_f32 v40, v40
    v_exp_f32 v41, v41
    ds_read_b128 v[84:87], v2 offset:50176
    v_exp_f32 v42, v42
    v_exp_f32 v43, v43
    v_mfma_f32_32x32x16_bf16 v[56:71], v[92:95], v[20:23], v[56:71]
    ds_read_b128 v[100:103], v2 offset:38912
    v_exp_f32 v44, v44
    v_exp_f32 v45, v45
    v_exp_f32 v46, v46
    v_exp_f32 v47, v47
    v_cvt_pk_bf16_f32 v72, v40, v41
    v_cvt_pk_bf16_f32 v73, v42, v43
    v_mfma_f32_32x32x16_bf16 v[24:39], v[108:111], v[76:79], v[24:39]
    ds_read_b128 v[108:111], v2 offset:39936
    v_exp_f32 v48, v48
    v_exp_f32 v49, v49
    v_exp_f32 v50, v50
    v_exp_f32 v51, v51
    v_cvt_pk_bf16_f32 v74, v44, v45
    v_cvt_pk_bf16_f32 v75, v46, v47
    v_exp_f32 v52, v52
    v_exp_f32 v53, v53
    v_mfma_f32_32x32x16_bf16 v[24:39], v[96:99], v[72:75], v[24:39]
    v_exp_f32 v54, v54
    v_exp_f32 v55, v55
    v_cvt_pk_bf16_f32 v76, v48, v49
    v_cvt_pk_bf16_f32 v77, v50, v51
    v_cvt_pk_bf16_f32 v78, v52, v53
    v_cvt_pk_bf16_f32 v79, v54, v55
    s_waitcnt lgkmcnt(0)
    ds_read_b128 v[88:91], v2 offset:53248
    v_mfma_f32_32x32x16_bf16 v[40:55], v[80:83], v[16:19], 0
    v_exp_f32 v56, v56
    v_exp_f32 v57, v57
    ds_read_b128 v[92:95], v2 offset:54272
    v_exp_f32 v58, v58
    v_exp_f32 v59, v59
    v_mfma_f32_32x32x16_bf16 v[40:55], v[84:87], v[20:23], v[40:55]
    ds_read_b128 v[96:99], v2 offset:51200
    v_exp_f32 v60, v60
    v_exp_f32 v61, v61
    v_exp_f32 v62, v62
    v_exp_f32 v63, v63
    v_cvt_pk_bf16_f32 v72, v56, v57
    v_cvt_pk_bf16_f32 v73, v58, v59
    v_mfma_f32_32x32x16_bf16 v[24:39], v[104:107], v[76:79], v[24:39]
    ds_read_b128 v[104:107], v2 offset:52224
    v_exp_f32 v64, v64
    v_exp_f32 v65, v65
    v_exp_f32 v66, v66
    v_exp_f32 v67, v67
    v_cvt_pk_bf16_f32 v74, v60, v61
    v_cvt_pk_bf16_f32 v75, v62, v63
    v_exp_f32 v68, v68
    v_exp_f32 v69, v69
    v_mfma_f32_32x32x16_bf16 v[24:39], v[100:103], v[72:75], v[24:39]
    v_exp_f32 v70, v70
    v_exp_f32 v71, v71
    v_cvt_pk_bf16_f32 v76, v64, v65
    v_cvt_pk_bf16_f32 v77, v66, v67
    v_cvt_pk_bf16_f32 v78, v68, v69
    v_cvt_pk_bf16_f32 v79, v70, v71
    s_barrier
    s_waitcnt lgkmcnt(0)
    ds_read_b128 v[80:83], v3 offset:0
    v_mfma_f32_32x32x16_bf16 v[56:71], v[88:91], v[16:19], 0
    v_exp_f32 v40, v40
    v_exp_f32 v41, v41
    ds_read_b128 v[84:87], v3 offset:1024
    v_exp_f32 v42, v42
    v_exp_f32 v43, v43
    v_mfma_f32_32x32x16_bf16 v[56:71], v[92:95], v[20:23], v[56:71]
    ds_read_b128 v[100:103], v2 offset:55296
    v_exp_f32 v44, v44
    v_exp_f32 v45, v45
    v_exp_f32 v46, v46
    v_exp_f32 v47, v47
    v_cvt_pk_bf16_f32 v72, v40, v41
    v_cvt_pk_bf16_f32 v73, v42, v43
    v_mfma_f32_32x32x16_bf16 v[24:39], v[108:111], v[76:79], v[24:39]
    ds_read_b128 v[108:111], v2 offset:56320
    v_exp_f32 v48, v48
    v_exp_f32 v49, v49
    v_exp_f32 v50, v50
    v_exp_f32 v51, v51
    v_cvt_pk_bf16_f32 v74, v44, v45
    v_cvt_pk_bf16_f32 v75, v46, v47
    v_exp_f32 v52, v52
    v_exp_f32 v53, v53
    v_mfma_f32_32x32x16_bf16 v[24:39], v[96:99], v[72:75], v[24:39]
    v_exp_f32 v54, v54
    v_exp_f32 v55, v55
    v_cvt_pk_bf16_f32 v76, v48, v49
    v_cvt_pk_bf16_f32 v77, v50, v51
    v_cvt_pk_bf16_f32 v78, v52, v53
    v_cvt_pk_bf16_f32 v79, v54, v55
    s_waitcnt lgkmcnt(0)
    ds_read_b128 v[88:91], v3 offset:4096
    v_mfma_f32_32x32x16_bf16 v[40:55], v[80:83], v[16:19], 0
    v_exp_f32 v56, v56
    v_exp_f32 v57, v57
    ds_read_b128 v[92:95], v3 offset:5120
    v_exp_f32 v58, v58
    v_exp_f32 v59, v59
    v_mfma_f32_32x32x16_bf16 v[40:55], v[84:87], v[20:23], v[40:55]
    ds_read_b128 v[96:99], v3 offset:2048
    v_exp_f32 v60, v60
    v_exp_f32 v61, v61
    v_exp_f32 v62, v62
    v_exp_f32 v63, v63
    v_cvt_pk_bf16_f32 v72, v56, v57
    v_cvt_pk_bf16_f32 v73, v58, v59
    v_mfma_f32_32x32x16_bf16 v[24:39], v[104:107], v[76:79], v[24:39]
    ds_read_b128 v[104:107], v3 offset:3072
    v_exp_f32 v64, v64
    v_exp_f32 v65, v65
    v_exp_f32 v66, v66
    v_exp_f32 v67, v67
    v_cvt_pk_bf16_f32 v74, v60, v61
    v_cvt_pk_bf16_f32 v75, v62, v63
    v_exp_f32 v68, v68
    v_exp_f32 v69, v69
    v_mfma_f32_32x32x16_bf16 v[24:39], v[100:103], v[72:75], v[24:39]
    v_exp_f32 v70, v70
    v_exp_f32 v71, v71
    v_cvt_pk_bf16_f32 v76, v64, v65
    v_cvt_pk_bf16_f32 v77, v66, v67
    v_cvt_pk_bf16_f32 v78, v68, v69
    v_cvt_pk_bf16_f32 v79, v70, v71
    s_barrier
    s_waitcnt lgkmcnt(0)
    ds_read_b128 v[80:83], v2 offset:0
    v_mfma_f32_32x32x16_bf16 v[56:71], v[88:91], v[16:19], 0
    v_exp_f32 v40, v40
    v_exp_f32 v41, v41
    ds_read_b128 v[84:87], v2 offset:1024
    v_exp_f32 v42, v42
    v_exp_f32 v43, v43
    v_mfma_f32_32x32x16_bf16 v[56:71], v[92:95], v[20:23], v[56:71]
    ds_read_b128 v[100:103], v3 offset:6144
    v_exp_f32 v44, v44
    v_exp_f32 v45, v45
    v_exp_f32 v46, v46
    v_exp_f32 v47, v47
    v_cvt_pk_bf16_f32 v72, v40, v41
    v_cvt_pk_bf16_f32 v73, v42, v43
    v_mfma_f32_32x32x16_bf16 v[24:39], v[108:111], v[76:79], v[24:39]
    ds_read_b128 v[108:111], v3 offset:7168
    v_exp_f32 v48, v48
    v_exp_f32 v49, v49
    v_exp_f32 v50, v50
    v_exp_f32 v51, v51
    v_cvt_pk_bf16_f32 v74, v44, v45
    v_cvt_pk_bf16_f32 v75, v46, v47
    v_exp_f32 v52, v52
    v_exp_f32 v53, v53
    v_mfma_f32_32x32x16_bf16 v[24:39], v[96:99], v[72:75], v[24:39]
    v_exp_f32 v54, v54
    v_exp_f32 v55, v55
    v_cvt_pk_bf16_f32 v76, v48, v49
    v_cvt_pk_bf16_f32 v77, v50, v51
    v_cvt_pk_bf16_f32 v78, v52, v53
    v_cvt_pk_bf16_f32 v79, v54, v55
    s_waitcnt lgkmcnt(0)
    ds_read_b128 v[88:91], v2 offset:4096
    v_mfma_f32_32x32x16_bf16 v[40:55], v[80:83], v[16:19], 0
    v_exp_f32 v56, v56
    v_exp_f32 v57, v57
    ds_read_b128 v[92:95], v2 offset:5120
    v_exp_f32 v58, v58
    v_exp_f32 v59, v59
    v_mfma_f32_32x32x16_bf16 v[40:55], v[84:87], v[20:23], v[40:55]
    ds_read_b128 v[96:99], v2 offset:2048
    v_exp_f32 v60, v60
    v_exp_f32 v61, v61
    v_exp_f32 v62, v62
    v_exp_f32 v63, v63
    v_cvt_pk_bf16_f32 v72, v56, v57
    v_cvt_pk_bf16_f32 v73, v58, v59
    v_mfma_f32_32x32x16_bf16 v[24:39], v[104:107], v[76:79], v[24:39]
    ds_read_b128 v[104:107], v2 offset:3072
    v_exp_f32 v64, v64
    v_exp_f32 v65, v65
    v_exp_f32 v66, v66
    v_exp_f32 v67, v67
    v_cvt_pk_bf16_f32 v74, v60, v61
    v_cvt_pk_bf16_f32 v75, v62, v63
    v_exp_f32 v68, v68
    v_exp_f32 v69, v69
    v_mfma_f32_32x32x16_bf16 v[24:39], v[100:103], v[72:75], v[24:39]
    v_exp_f32 v70, v70
    v_exp_f32 v71, v71
    v_cvt_pk_bf16_f32 v76, v64, v65
    v_cvt_pk_bf16_f32 v77, v66, v67
    v_cvt_pk_bf16_f32 v78, v68, v69
    v_cvt_pk_bf16_f32 v79, v70, v71
    s_barrier
    s_waitcnt lgkmcnt(0)
    ds_read_b128 v[80:83], v2 offset:16384
    v_mfma_f32_32x32x16_bf16 v[56:71], v[88:91], v[16:19], 0
    v_exp_f32 v40, v40
    v_exp_f32 v41, v41
    ds_read_b128 v[84:87], v2 offset:17408
    v_exp_f32 v42, v42
    v_exp_f32 v43, v43
    v_mfma_f32_32x32x16_bf16 v[56:71], v[92:95], v[20:23], v[56:71]
    ds_read_b128 v[100:103], v2 offset:6144
    v_exp_f32 v44, v44
    v_exp_f32 v45, v45
    v_exp_f32 v46, v46
    v_exp_f32 v47, v47
    v_cvt_pk_bf16_f32 v72, v40, v41
    v_cvt_pk_bf16_f32 v73, v42, v43
    v_mfma_f32_32x32x16_bf16 v[24:39], v[108:111], v[76:79], v[24:39]
    ds_read_b128 v[108:111], v2 offset:7168
    v_exp_f32 v48, v48
    v_exp_f32 v49, v49
    v_exp_f32 v50, v50
    v_exp_f32 v51, v51
    v_cvt_pk_bf16_f32 v74, v44, v45
    v_cvt_pk_bf16_f32 v75, v46, v47
    v_exp_f32 v52, v52
    v_exp_f32 v53, v53
    v_mfma_f32_32x32x16_bf16 v[24:39], v[96:99], v[72:75], v[24:39]
    v_exp_f32 v54, v54
    v_exp_f32 v55, v55
    v_cvt_pk_bf16_f32 v76, v48, v49
    v_cvt_pk_bf16_f32 v77, v50, v51
    v_cvt_pk_bf16_f32 v78, v52, v53
    v_cvt_pk_bf16_f32 v79, v54, v55
    s_waitcnt lgkmcnt(0)
    ds_read_b128 v[88:91], v2 offset:20480
    v_mfma_f32_32x32x16_bf16 v[40:55], v[80:83], v[16:19], 0
    v_exp_f32 v56, v56
    v_exp_f32 v57, v57
    ds_read_b128 v[92:95], v2 offset:21504
    v_exp_f32 v58, v58
    v_exp_f32 v59, v59
    v_mfma_f32_32x32x16_bf16 v[40:55], v[84:87], v[20:23], v[40:55]
    ds_read_b128 v[96:99], v2 offset:18432
    v_exp_f32 v60, v60
    v_exp_f32 v61, v61
    v_exp_f32 v62, v62
    v_exp_f32 v63, v63
    v_cvt_pk_bf16_f32 v72, v56, v57
    v_cvt_pk_bf16_f32 v73, v58, v59
    v_mfma_f32_32x32x16_bf16 v[24:39], v[104:107], v[76:79], v[24:39]
    ds_read_b128 v[104:107], v2 offset:19456
    v_exp_f32 v64, v64
    v_exp_f32 v65, v65
    v_exp_f32 v66, v66
    v_exp_f32 v67, v67
    v_cvt_pk_bf16_f32 v74, v60, v61
    v_cvt_pk_bf16_f32 v75, v62, v63
    v_exp_f32 v68, v68
    v_exp_f32 v69, v69
    v_mfma_f32_32x32x16_bf16 v[24:39], v[100:103], v[72:75], v[24:39]
    v_exp_f32 v70, v70
    v_exp_f32 v71, v71
    v_cvt_pk_bf16_f32 v76, v64, v65
    v_cvt_pk_bf16_f32 v77, v66, v67
    v_cvt_pk_bf16_f32 v78, v68, v69
    v_cvt_pk_bf16_f32 v79, v70, v71
    s_barrier
    s_waitcnt lgkmcnt(0)
    ds_read_b128 v[80:83], v2 offset:32768
    v_mfma_f32_32x32x16_bf16 v[56:71], v[88:91], v[16:19], 0
    v_exp_f32 v40, v40
    v_exp_f32 v41, v41
    ds_read_b128 v[84:87], v2 offset:33792
    v_exp_f32 v42, v42
    v_exp_f32 v43, v43
    v_mfma_f32_32x32x16_bf16 v[56:71], v[92:95], v[20:23], v[56:71]
    ds_read_b128 v[100:103], v2 offset:22528
    v_exp_f32 v44, v44
    v_exp_f32 v45, v45
    v_exp_f32 v46, v46
    v_exp_f32 v47, v47
    v_cvt_pk_bf16_f32 v72, v40, v41
    v_cvt_pk_bf16_f32 v73, v42, v43
    v_mfma_f32_32x32x16_bf16 v[24:39], v[108:111], v[76:79], v[24:39]
    ds_read_b128 v[108:111], v2 offset:23552
    v_exp_f32 v48, v48
    v_exp_f32 v49, v49
    s_mul_i32 s40, s2, 2097152
    s_add_u32 s40, s40, 17825792
    s_lshl_b32 s41, s16, 2
    s_add_u32 s41, s41, s3
    s_lshl_b32 s41, s41, 15
    s_add_u32 s40, s40, s41
    s_lshl_b32 s41, s17, 11
    s_add_u32 s40, s40, s41
    buffer_load_dwordx4 v[112:115], v0, s[8:11], s40 offen offset:0
    buffer_load_dwordx4 v[116:119], v0, s[8:11], s40 offen offset:1024
    v_exp_f32 v50, v50
    v_exp_f32 v51, v51
    v_cvt_pk_bf16_f32 v74, v44, v45
    v_cvt_pk_bf16_f32 v75, v46, v47
    v_exp_f32 v52, v52
    v_exp_f32 v53, v53
    v_mfma_f32_32x32x16_bf16 v[24:39], v[96:99], v[72:75], v[24:39]
    v_exp_f32 v54, v54
    v_exp_f32 v55, v55
    v_cvt_pk_bf16_f32 v76, v48, v49
    v_cvt_pk_bf16_f32 v77, v50, v51
    v_cvt_pk_bf16_f32 v78, v52, v53
    v_cvt_pk_bf16_f32 v79, v54, v55
    s_waitcnt lgkmcnt(0)
    ds_read_b128 v[88:91], v2 offset:36864
    v_mfma_f32_32x32x16_bf16 v[40:55], v[80:83], v[16:19], 0
    v_exp_f32 v56, v56
    v_exp_f32 v57, v57
    ds_read_b128 v[92:95], v2 offset:37888
    v_exp_f32 v58, v58
    v_exp_f32 v59, v59
    v_mfma_f32_32x32x16_bf16 v[40:55], v[84:87], v[20:23], v[40:55]
    ds_read_b128 v[96:99], v2 offset:34816
    v_exp_f32 v60, v60
    v_exp_f32 v61, v61
    v_exp_f32 v62, v62
    v_exp_f32 v63, v63
    v_cvt_pk_bf16_f32 v72, v56, v57
    v_cvt_pk_bf16_f32 v73, v58, v59
    v_mfma_f32_32x32x16_bf16 v[24:39], v[104:107], v[76:79], v[24:39]
    ds_read_b128 v[104:107], v2 offset:35840
    v_exp_f32 v64, v64
    v_exp_f32 v65, v65
    v_exp_f32 v66, v66
    v_exp_f32 v67, v67
    v_cvt_pk_bf16_f32 v74, v60, v61
    v_cvt_pk_bf16_f32 v75, v62, v63
    v_exp_f32 v68, v68
    v_exp_f32 v69, v69
    v_mfma_f32_32x32x16_bf16 v[24:39], v[100:103], v[72:75], v[24:39]
    v_exp_f32 v70, v70
    v_exp_f32 v71, v71
    v_cvt_pk_bf16_f32 v76, v64, v65
    v_cvt_pk_bf16_f32 v77, v66, v67
    v_cvt_pk_bf16_f32 v78, v68, v69
    v_cvt_pk_bf16_f32 v79, v70, v71
    s_barrier
    s_waitcnt lgkmcnt(0)
    ds_read_b128 v[80:83], v2 offset:49152
    v_mfma_f32_32x32x16_bf16 v[56:71], v[88:91], v[16:19], 0
    v_exp_f32 v40, v40
    v_exp_f32 v41, v41
    ds_read_b128 v[84:87], v2 offset:50176
    v_exp_f32 v42, v42
    v_exp_f32 v43, v43
    v_mfma_f32_32x32x16_bf16 v[56:71], v[92:95], v[20:23], v[56:71]
    ds_read_b128 v[100:103], v2 offset:38912
    v_exp_f32 v44, v44
    v_exp_f32 v45, v45
    v_exp_f32 v46, v46
    v_exp_f32 v47, v47
    v_cvt_pk_bf16_f32 v72, v40, v41
    v_cvt_pk_bf16_f32 v73, v42, v43
    v_mfma_f32_32x32x16_bf16 v[24:39], v[108:111], v[76:79], v[24:39]
    ds_read_b128 v[108:111], v2 offset:39936
    v_exp_f32 v48, v48
    v_exp_f32 v49, v49
    s_lshl_b32 s42, s16, 2
    s_lshl_b32 s41, s37, 1
    s_add_u32 s42, s42, s41
    s_and_b32 s41, s3, 1
    s_add_u32 s42, s42, s41
    s_mul_i32 s42, s42, 14
    s_lshl_b32 s41, s38, 1
    s_add_u32 s42, s42, s41
    s_lshr_b32 s41, s3, 1
    s_add_u32 s42, s42, s41
    s_mul_i32 s40, s2, 4194304
    s_add_u32 s40, s40, 3145728
    s_lshl_b32 s41, s42, 11
    s_add_u32 s40, s40, s41
    buffer_load_dwordx4 v[120:123], v0, s[8:11], s40 offen offset:0
    buffer_load_dwordx4 v[124:127], v0, s[8:11], s40 offen offset:1024
    s_mul_i32 s40, s2, 524288
    s_add_u32 s40, s40, 39583744
    s_lshl_b32 s41, s42, 8
    s_add_u32 s40, s40, s41
    v_lshlrev_b32 v129, 2, v1
    buffer_load_dword v128, v129, s[8:11], s40 offen
    v_exp_f32 v50, v50
    v_exp_f32 v51, v51
    v_cvt_pk_bf16_f32 v74, v44, v45
    v_cvt_pk_bf16_f32 v75, v46, v47
    v_exp_f32 v52, v52
    v_exp_f32 v53, v53
    v_mfma_f32_32x32x16_bf16 v[24:39], v[96:99], v[72:75], v[24:39]
    v_exp_f32 v54, v54
    v_exp_f32 v55, v55
    v_cvt_pk_bf16_f32 v76, v48, v49
    v_cvt_pk_bf16_f32 v77, v50, v51
    v_cvt_pk_bf16_f32 v78, v52, v53
    v_cvt_pk_bf16_f32 v79, v54, v55
    s_waitcnt lgkmcnt(0)
    ds_read_b128 v[88:91], v2 offset:53248
    v_mfma_f32_32x32x16_bf16 v[40:55], v[80:83], v[16:19], 0
    v_exp_f32 v56, v56
    v_exp_f32 v57, v57
    ds_read_b128 v[92:95], v2 offset:54272
    v_exp_f32 v58, v58
    v_exp_f32 v59, v59
    v_mfma_f32_32x32x16_bf16 v[40:55], v[84:87], v[20:23], v[40:55]
    ds_read_b128 v[96:99], v2 offset:51200
    v_exp_f32 v60, v60
    v_exp_f32 v61, v61
    v_exp_f32 v62, v62
    v_exp_f32 v63, v63
    v_cvt_pk_bf16_f32 v72, v56, v57
    v_cvt_pk_bf16_f32 v73, v58, v59
    v_mfma_f32_32x32x16_bf16 v[24:39], v[104:107], v[76:79], v[24:39]
    ds_read_b128 v[104:107], v2 offset:52224
    v_exp_f32 v64, v64
    v_exp_f32 v65, v65
    v_exp_f32 v66, v66
    v_exp_f32 v67, v67
    v_cvt_pk_bf16_f32 v74, v60, v61
    v_cvt_pk_bf16_f32 v75, v62, v63
    v_exp_f32 v68, v68
    v_exp_f32 v69, v69
    v_mfma_f32_32x32x16_bf16 v[24:39], v[100:103], v[72:75], v[24:39]
    v_exp_f32 v70, v70
    v_exp_f32 v71, v71
    v_cvt_pk_bf16_f32 v76, v64, v65
    v_cvt_pk_bf16_f32 v77, v66, v67
    v_cvt_pk_bf16_f32 v78, v68, v69
    v_cvt_pk_bf16_f32 v79, v70, v71
    s_barrier
    s_waitcnt lgkmcnt(0)
    ds_read_b128 v[80:83], v3 offset:0
    v_mfma_f32_32x32x16_bf16 v[56:71], v[88:91], v[16:19], 0
    v_exp_f32 v40, v40
    v_exp_f32 v41, v41
    ds_read_b128 v[84:87], v3 offset:1024
    v_exp_f32 v42, v42
    v_exp_f32 v43, v43
    v_mfma_f32_32x32x16_bf16 v[56:71], v[92:95], v[20:23], v[56:71]
    ds_read_b128 v[100:103], v2 offset:55296
    v_exp_f32 v44, v44
    v_exp_f32 v45, v45
    v_exp_f32 v46, v46
    v_exp_f32 v47, v47
    v_cvt_pk_bf16_f32 v72, v40, v41
    v_cvt_pk_bf16_f32 v73, v42, v43
    v_mfma_f32_32x32x16_bf16 v[24:39], v[108:111], v[76:79], v[24:39]
    ds_read_b128 v[108:111], v2 offset:56320
    v_exp_f32 v48, v48
    v_exp_f32 v49, v49
    s_mul_i32 s40, s19, 262144
    s_add_u32 s40, s40, 38797312
    s_mul_i32 s41, s16, 14
    s_add_u32 s41, s41, s17
    s_lshl_b32 s41, s41, 10
    s_add_u32 s40, s40, s41
    s_lshl_b32 s41, s3, 8
    s_add_u32 s40, s40, s41
    v_lshlrev_b32 v131, 2, v1
    buffer_load_dword v130, v131, s[8:11], s40 offen
    v_exp_f32 v50, v50
    v_exp_f32 v51, v51
    v_cvt_pk_bf16_f32 v74, v44, v45
    v_cvt_pk_bf16_f32 v75, v46, v47
    v_exp_f32 v52, v52
    v_exp_f32 v53, v53
    v_mfma_f32_32x32x16_bf16 v[24:39], v[96:99], v[72:75], v[24:39]
    v_exp_f32 v54, v54
    v_exp_f32 v55, v55
    v_cvt_pk_bf16_f32 v76, v48, v49
    v_cvt_pk_bf16_f32 v77, v50, v51
    v_cvt_pk_bf16_f32 v78, v52, v53
    v_cvt_pk_bf16_f32 v79, v54, v55
    s_waitcnt lgkmcnt(0)
    ds_read_b128 v[88:91], v3 offset:4096
    v_mfma_f32_32x32x16_bf16 v[40:55], v[80:83], v[16:19], 0
    v_exp_f32 v56, v56
    v_exp_f32 v57, v57
    ds_read_b128 v[92:95], v3 offset:5120
    v_exp_f32 v58, v58
    v_exp_f32 v59, v59
    v_mfma_f32_32x32x16_bf16 v[40:55], v[84:87], v[20:23], v[40:55]
    ds_read_b128 v[96:99], v3 offset:2048
    v_exp_f32 v60, v60
    v_exp_f32 v61, v61
    v_exp_f32 v62, v62
    v_exp_f32 v63, v63
    v_cvt_pk_bf16_f32 v72, v56, v57
    v_cvt_pk_bf16_f32 v73, v58, v59
    v_mfma_f32_32x32x16_bf16 v[24:39], v[104:107], v[76:79], v[24:39]
    ds_read_b128 v[104:107], v3 offset:3072
    v_exp_f32 v64, v64
    v_exp_f32 v65, v65
    v_exp_f32 v66, v66
    v_exp_f32 v67, v67
    v_cvt_pk_bf16_f32 v74, v60, v61
    v_cvt_pk_bf16_f32 v75, v62, v63
    v_exp_f32 v68, v68
    v_exp_f32 v69, v69
    v_mfma_f32_32x32x16_bf16 v[24:39], v[100:103], v[72:75], v[24:39]
    v_exp_f32 v70, v70
    v_exp_f32 v71, v71
    v_cvt_pk_bf16_f32 v76, v64, v65
    v_cvt_pk_bf16_f32 v77, v66, v67
    v_cvt_pk_bf16_f32 v78, v68, v69
    v_cvt_pk_bf16_f32 v79, v70, v71
    s_barrier
    s_waitcnt lgkmcnt(0)
    ds_read_b128 v[80:83], v2 offset:0
    v_mfma_f32_32x32x16_bf16 v[56:71], v[88:91], v[16:19], 0
    v_exp_f32 v40, v40
    v_exp_f32 v41, v41
    ds_read_b128 v[84:87], v2 offset:1024
    v_exp_f32 v42, v42
    v_exp_f32 v43, v43
    v_mfma_f32_32x32x16_bf16 v[56:71], v[92:95], v[20:23], v[56:71]
    ds_read_b128 v[100:103], v3 offset:6144
    v_exp_f32 v44, v44
    v_exp_f32 v45, v45
    v_exp_f32 v46, v46
    v_exp_f32 v47, v47
    v_cvt_pk_bf16_f32 v72, v40, v41
    v_cvt_pk_bf16_f32 v73, v42, v43
    v_mfma_f32_32x32x16_bf16 v[24:39], v[108:111], v[76:79], v[24:39]
    ds_read_b128 v[108:111], v3 offset:7168
    v_exp_f32 v48, v48
    v_exp_f32 v49, v49
    v_exp_f32 v50, v50
    v_exp_f32 v51, v51
    v_cvt_pk_bf16_f32 v74, v44, v45
    v_cvt_pk_bf16_f32 v75, v46, v47
    v_exp_f32 v52, v52
    v_exp_f32 v53, v53
    v_mfma_f32_32x32x16_bf16 v[24:39], v[96:99], v[72:75], v[24:39]
    v_exp_f32 v54, v54
    v_exp_f32 v55, v55
    v_cvt_pk_bf16_f32 v76, v48, v49
    v_cvt_pk_bf16_f32 v77, v50, v51
    v_cvt_pk_bf16_f32 v78, v52, v53
    v_cvt_pk_bf16_f32 v79, v54, v55
    s_waitcnt lgkmcnt(0)
    ds_read_b128 v[88:91], v2 offset:4096
    v_mfma_f32_32x32x16_bf16 v[40:55], v[80:83], v[16:19], 0
    v_exp_f32 v56, v56
    v_exp_f32 v57, v57
    ds_read_b128 v[92:95], v2 offset:5120
    v_exp_f32 v58, v58
    v_exp_f32 v59, v59
    v_mfma_f32_32x32x16_bf16 v[40:55], v[84:87], v[20:23], v[40:55]
    ds_read_b128 v[96:99], v2 offset:2048
    v_exp_f32 v60, v60
    v_exp_f32 v61, v61
    v_exp_f32 v62, v62
    v_exp_f32 v63, v63
    v_cvt_pk_bf16_f32 v72, v56, v57
    v_cvt_pk_bf16_f32 v73, v58, v59
    v_mfma_f32_32x32x16_bf16 v[24:39], v[104:107], v[76:79], v[24:39]
    ds_read_b128 v[104:107], v2 offset:3072
    v_exp_f32 v64, v64
    v_exp_f32 v65, v65
    v_exp_f32 v66, v66
    v_exp_f32 v67, v67
    v_cvt_pk_bf16_f32 v74, v60, v61
    v_cvt_pk_bf16_f32 v75, v62, v63
    v_exp_f32 v68, v68
    v_exp_f32 v69, v69
    v_mfma_f32_32x32x16_bf16 v[24:39], v[100:103], v[72:75], v[24:39]
    v_exp_f32 v70, v70
    v_exp_f32 v71, v71
    v_cvt_pk_bf16_f32 v76, v64, v65
    v_cvt_pk_bf16_f32 v77, v66, v67
    v_cvt_pk_bf16_f32 v78, v68, v69
    v_cvt_pk_bf16_f32 v79, v70, v71
    s_waitcnt lgkmcnt(0)
    v_mfma_f32_32x32x16_bf16 v[56:71], v[88:91], v[16:19], 0
    v_exp_f32 v40, v40
    v_exp_f32 v41, v41
    v_exp_f32 v42, v42
    v_exp_f32 v43, v43
    v_mfma_f32_32x32x16_bf16 v[56:71], v[92:95], v[20:23], v[56:71]
    ds_read_b128 v[100:103], v2 offset:6144
    v_exp_f32 v44, v44
    v_exp_f32 v45, v45
    v_exp_f32 v46, v46
    v_exp_f32 v47, v47
    v_cvt_pk_bf16_f32 v72, v40, v41
    v_cvt_pk_bf16_f32 v73, v42, v43
    v_mfma_f32_32x32x16_bf16 v[24:39], v[108:111], v[76:79], v[24:39]
    ds_read_b128 v[108:111], v2 offset:7168
    v_exp_f32 v48, v48
    v_exp_f32 v49, v49
    v_exp_f32 v50, v50
    v_exp_f32 v51, v51
    v_cvt_pk_bf16_f32 v74, v44, v45
    v_cvt_pk_bf16_f32 v75, v46, v47
    v_exp_f32 v52, v52
    v_exp_f32 v53, v53
    v_mfma_f32_32x32x16_bf16 v[24:39], v[96:99], v[72:75], v[24:39]
    v_exp_f32 v54, v54
    v_exp_f32 v55, v55
    v_cvt_pk_bf16_f32 v76, v48, v49
    v_cvt_pk_bf16_f32 v77, v50, v51
    v_cvt_pk_bf16_f32 v78, v52, v53
    v_cvt_pk_bf16_f32 v79, v54, v55
    s_waitcnt lgkmcnt(0)
    v_exp_f32 v56, v56
    v_exp_f32 v57, v57
    v_exp_f32 v58, v58
    v_exp_f32 v59, v59
    v_exp_f32 v60, v60
    v_exp_f32 v61, v61
    v_exp_f32 v62, v62
    v_exp_f32 v63, v63
    v_cvt_pk_bf16_f32 v72, v56, v57
    v_cvt_pk_bf16_f32 v73, v58, v59
    v_mfma_f32_32x32x16_bf16 v[24:39], v[104:107], v[76:79], v[24:39]
    v_exp_f32 v64, v64
    v_exp_f32 v65, v65
    v_exp_f32 v66, v66
    v_exp_f32 v67, v67
    v_cvt_pk_bf16_f32 v74, v60, v61
    v_cvt_pk_bf16_f32 v75, v62, v63
    v_exp_f32 v68, v68
    v_exp_f32 v69, v69
    v_mfma_f32_32x32x16_bf16 v[24:39], v[100:103], v[72:75], v[24:39]
    v_exp_f32 v70, v70
    v_exp_f32 v71, v71
    v_cvt_pk_bf16_f32 v76, v64, v65
    v_cvt_pk_bf16_f32 v77, v66, v67
    v_cvt_pk_bf16_f32 v78, v68, v69
    v_cvt_pk_bf16_f32 v79, v70, v71
    s_waitcnt vmcnt(0)
    s_nop 1
    v_mfma_f32_32x32x16_bf16 v[24:39], v[108:111], v[76:79], v[24:39]
    s_setprio 0
L_att_loopd_14:
    s_nop 11
    v_add_f32 v40, abs(v24), abs(v25)
    v_add_f32 v40, abs(v26), v40
    v_add_f32 v40, abs(v27), v40
    v_add_f32 v40, abs(v28), v40
    v_add_f32 v40, abs(v29), v40
    v_add_f32 v40, abs(v30), v40
    v_add_f32 v40, abs(v31), v40
    v_add_f32 v40, abs(v32), v40
    v_add_f32 v40, abs(v33), v40
    v_add_f32 v40, abs(v34), v40
    v_add_f32 v40, abs(v35), v40
    v_add_f32 v40, abs(v36), v40
    v_add_f32 v40, abs(v37), v40
    v_add_f32 v40, abs(v38), v40
    v_add_f32 v40, abs(v39), v40
    v_mov_b32 v41, 0x7e800000
    v_cmp_nlt_f32 s[50:51], v40, v41
    v_mov_b32 v41, 0x1f800000
    v_mov_b32 v42, 0x5f800000
    v_cmp_nle_f32 s[52:53], v41, v36
    v_cmp_nge_f32 s[54:55], v42, v36
    s_nop 0
    s_or_b64 s[52:53], s[52:53], s[54:55]
    s_mov_b32 s52, 0
    s_or_b64 s[50:51], s[50:51], s[52:53]
    s_or_b32 s50, s50, s51
    v_mov_b32 v41, s50
    s_lshl_b32 s45, s18, 2
    s_add_u32 s45, s45, 162816
    v_mov_b32 v42, s45
    ds_write_b32 v42, v41
L_att_back_19:
    s_lshl_b32 s45, s48, 12
    s_add_u32 s45, s45, 145408
    v_add_u32 v5, s45, v0
    s_cmp_eq_u32 s49, 0
    s_cbranch_scc0 L_att_nowrite_20
    ds_write_b128 v5, v[24:27] offset:0
    ds_write_b128 v5, v[28:31] offset:1024
    ds_write_b128 v5, v[32:35] offset:2048
    ds_write_b128 v5, v[36:39] offset:3072
L_att_nowrite_20:
    s_waitcnt lgkmcnt(0)
    s_barrier
    v_mov_b32 v42, 162816
    ds_read_b128 v[44:47], v42
    ds_read_b128 v[48:51], v42 offset:16
    ds_read_b128 v[56:59], v5 offset:0
    ds_read_b128 v[60:63], v5 offset:1024
    ds_read_b128 v[64:67], v5 offset:2048
    ds_read_b128 v[68:71], v5 offset:3072
    s_mul_i32 s40, s2, 2097152
    s_add_u32 s40, s40, 17825792
    s_lshl_b32 s45, s16, 2
    s_add_u32 s45, s45, s48
    s_lshl_b32 s45, s45, 15
    s_add_u32 s40, s40, s45
    s_lshl_b32 s45, s17, 11
    s_add_u32 s40, s40, s45
    s_waitcnt lgkmcnt(4)
    v_or_b32 v44, v44, v45
    v_or_b32 v44, v44, v46
    v_or_b32 v44, v44, v47
    v_or_b32 v44, v44, v48
    v_or_b32 v44, v44, v49
    v_or_b32 v44, v44, v50
    v_or_b32 v44, v44, v51
    s_nop 0
    v_readfirstlane_b32 s50, v44
    s_nop 0
    s_cmp_lg_u32 s50, 0
    s_cbranch_scc1 L_att_fallback_18
    s_cmp_eq_u32 s49, 0
    s_cbranch_scc1 L_att_helper_21
    s_waitcnt lgkmcnt(0)
    v_pk_add_f32 v[24:25], v[24:25], v[56:57]
    v_pk_add_f32 v[26:27], v[26:27], v[58:59]
    v_pk_add_f32 v[28:29], v[28:29], v[60:61]
    v_pk_add_f32 v[30:31], v[30:31], v[62:63]
    v_pk_add_f32 v[32:33], v[32:33], v[64:65]
    v_pk_add_f32 v[34:35], v[34:35], v[66:67]
    v_pk_add_f32 v[36:37], v[36:37], v[68:69]
    v_pk_add_f32 v[38:39], v[38:39], v[70:71]
    v_mov_b32 v72, v36
    v_mov_b32 v74, v36
    s_nop 1
    v_permlane32_swap_b32 v72, v74
    s_nop 1
    v_rcp_f32 v74, v74
    s_nop 0
    v_pk_mul_f32 v[24:25], v[24:25], v[74:75] op_sel_hi:[1,0]
    v_pk_mul_f32 v[26:27], v[26:27], v[74:75] op_sel_hi:[1,0]
    v_pk_mul_f32 v[28:29], v[28:29], v[74:75] op_sel_hi:[1,0]
    v_pk_mul_f32 v[30:31], v[30:31], v[74:75] op_sel_hi:[1,0]
    v_pk_mul_f32 v[32:33], v[32:33], v[74:75] op_sel_hi:[1,0]
    v_pk_mul_f32 v[34:35], v[34:35], v[74:75] op_sel_hi:[1,0]
    v_pk_mul_f32 v[36:37], v[36:37], v[74:75] op_sel_hi:[1,0]
    v_pk_mul_f32 v[38:39], v[38:39], v[74:75] op_sel_hi:[1,0]
    s_mov_b32 exec_lo, 0
    v_mov_b32 v36, 0
    v_mov_b32 v37, 0
    v_mov_b32 v38, 0
    v_mov_b32 v39, 0
    s_mov_b64 exec, -1
    v_cvt_pk_bf16_f32 v40, v24, v25
    v_cvt_pk_bf16_f32 v41, v26, v27
    v_cvt_pk_bf16_f32 v42, v28, v29
    v_cvt_pk_bf16_f32 v43, v30, v31
    v_cvt_pk_bf16_f32 v44, v32, v33
    v_cvt_pk_bf16_f32 v45, v34, v35
    v_cvt_pk_bf16_f32 v46, v36, v37
    v_cvt_pk_bf16_f32 v47, v38, v39
    s_cmp_eq_u32 s39, 1
    s_cbranch_scc0 L_wt_23
    buffer_store_dwordx4 v[40:43], v0, s[8:11], s40 offen offset:0
    buffer_store_dwordx4 v[44:47], v0, s[8:11], s40 offen offset:1024
    s_branch L_wtd_24
L_wt_23:
    buffer_store_dwordx4 v[40:43], v0, s[8:11], s40 offen offset:0 sc1
    buffer_store_dwordx4 v[44:47], v0, s[8:11], s40 offen offset:1024 sc1
L_wtd_24:
    s_mul_i32 s57, s19, 32768
    s_add_u32 s57, s57, 65536
    s_lshl_b32 s58, s16, 11
    s_add_u32 s57, s57, s58
    s_lshl_b32 s58, s17, 7
    s_add_u32 s57, s57, s58
    s_lshl_b32 s58, s3, 2
    s_add_u32 s57, s57, s58
    v_mov_b32 v4, 1
    v_mov_b32 v5, 0
    s_waitcnt vmcnt(0)
    s_mov_b64 exec, 1
    s_cmp_eq_u32 s39, 1
    s_cbranch_scc0 L_wt_25
    buffer_store_dword v4, v5, s[8:11], s57 offen
    s_branch L_wtd_26
L_wt_25:
    buffer_store_dword v4, v5, s[8:11], s57 offen sc1
L_wtd_26:
    s_mov_b64 exec, -1
    s_branch L_att_join_22
L_att_helper_21:
    s_waitcnt lgkmcnt(0)
L_att_join_22:
    s_cmp_lt_u32 s17, 14
    s_cbranch_scc1 L_busy_27
    s_barrier
    s_lshl_b32 s40, s16, 1
    s_add_u32 s40, s40, s17
    s_sub_u32 s40, s40, 14
    s_lshl_b32 s41, s40, 3
    s_add_u32 s41, s41, s18
    s_lshl_b32 s41, s41, 7
    v_lshlrev_b32 v12, 15, v1
    s_cmp_eq_u32 s19, 0
    s_cbranch_scc0 L_idle_warm_28
    s_mov_b32 s12, s24
    s_mov_b32 s13, s25
    s_mov_b32 s14, 1605632
    s_mov_b32 s15, 0x20000
    buffer_load_dword v14, v12, s[12:15], s41 offen
    s_mov_b32 s12, s30
    s_mov_b32 s13, s31
    s_mov_b32 s14, 802816
    s_mov_b32 s15, 0x20000
    buffer_load_dword v15, v12, s[12:15], s41 offen
    s_mov_b32 s12, s26
    s_mov_b32 s13, s27
    s_mov_b32 s14, 8388608
    s_mov_b32 s15, 0x20000
    s_lshl_b32 s41, s40, 3
    s_add_u32 s41, s41, s18
    s_lshl_b32 s41, s41, 15
    v_lshrrev_b32 v12, 5, v1
    v_lshlrev_b32 v12, 12, v12
    v_and_b32 v13, 31, v1
    v_lshlrev_b32 v13, 7, v13
    v_add_u32 v12, v12, v13
    buffer_load_dword v16, v12, s[12:15], s41 offen
    s_add_u32 s41, s41, 8192
    buffer_load_dword v17, v12, s[12:15], s41 offen
    s_add_u32 s41, s41, 8192
    buffer_load_dword v18, v12, s[12:15], s41 offen
    s_add_u32 s41, s41, 8192
    buffer_load_dword v19, v12, s[12:15], s41 offen
L_idle_warm_28:
    s_cmp_eq_u32 s19, 0
    s_cbranch_scc0 L_layer_next_2
    s_cmp_lt_u32 s18, 4
    s_cbranch_scc0 L_layer_next_2
    s_lshl_b32 s40, s3, 10
    v_add_u32 v2, s40, v0
    v_add_u32 v3, 0x10000, v2
    ds_write_b128 v2, v[172:175] offset:0
    ds_write_b128 v2, v[176:179] offset:4096
    ds_write_b128 v2, v[180:183] offset:8192
    ds_write_b128 v2, v[184:187] offset:12288
    ds_write_b128 v2, v[188:191] offset:16384
    ds_write_b128 v2, v[192:195] offset:20480
    ds_write_b128 v2, v[196:199] offset:24576
    ds_write_b128 v2, v[200:203] offset:28672
    ds_write_b128 v2, v[204:207] offset:32768
    ds_write_b128 v2, v[208:211] offset:36864
    ds_write_b128 v2, v[212:215] offset:40960
    ds_write_b128 v2, v[216:219] offset:45056
    ds_write_b128 v2, v[220:223] offset:49152
    ds_write_b128 v2, v[224:227] offset:53248
    ds_write_b128 v2, v[228:231] offset:57344
    ds_write_b128 v2, v[232:235] offset:61440
    ds_write_b128 v3, v[236:239] offset:0
    ds_write_b128 v3, v[240:243] offset:4096
    ds_write_b128 v3, v[244:247] offset:8192
    ds_write_b128 v3, v[248:251] offset:12288
    ds_write_b128 v3, v[252:255] offset:16384
    s_branch L_layer_next_2
L_busy_27:
    s_cmp_ge_u32 s18, 4
    s_cbranch_scc0 L_op_helper_29
    s_and_b32 s48, s3, 1
    s_lshr_b32 s49, s3, 1
    s_lshl_b32 s50, s37, 1
    s_add_u32 s50, s50, s48
    s_mov_b32 s51, s50
    s_lshl_b32 s45, s16, 2
    s_add_u32 s50, s50, s45
    s_mul_i32 s53, s50, 14
    s_lshl_b32 s45, s38, 1
    s_add_u32 s53, s53, s45
    s_add_u32 s53, s53, s49
    s_lshl_b32 s52, s53, 11
    s_cmp_eq_u32 s19, 0
    s_cbranch_scc0 L_op_res1_31
    s_mov_b32 s12, s100
    s_mov_b32 s13, s101
    s_mov_b32 s14, 1835008
    s_mov_b32 s15, 0x20000
    v_and_b32 v2, 0x13, v1
    v_bfe_u32 v3, v1, 2, 1
    v_lshlrev_b32 v3, 3, v3
    v_or_b32 v2, v2, v3
    v_bfe_u32 v3, v1, 3, 1
    v_lshlrev_b32 v3, 2, v3
    v_or_b32 v2, v2, v3
    v_mul_u32_u24 v2, 896, v2
    v_lshrrev_b32 v3, 5, v1
    v_lshl_add_u32 v2, v3, 3, v2
    s_mul_i32 s44, s50, 28672
    s_lshl_b32 s45, s38, 7
    s_add_u32 s44, s44, s45
    s_lshl_b32 s45, s49, 6
    s_add_u32 s44, s44, s45
    buffer_load_dwordx2 v[152:153], v2, s[12:15], s44 offen offset:0
    buffer_load_dwordx2 v[154:155], v2, s[12:15], s44 offen offset:16
    buffer_load_dwordx2 v[156:157], v2, s[12:15], s44 offen offset:32
    buffer_load_dwordx2 v[158:159], v2, s[12:15], s44 offen offset:48
    s_branch L_op_resd_32
L_op_res1_31:
    s_mul_i32 s44, s19, 4194304
    s_add_u32 s44, s44, 1048576
    s_add_u32 s44, s44, s52
    buffer_load_dwordx4 v[152:155], v0, s[8:11], s44 offen sc1
    buffer_load_dwordx4 v[156:159], v0, s[8:11], s44 offen offset:1024 sc1
L_op_resd_32:
    v_lshrrev_b32 v2, 5, v1
    v_lshlrev_b32 v2, 2, v2
    v_bfe_u32 v3, v1, 2, 2
    v_add_u32 v2, v2, v3
    v_mul_u32_u24 v220, 128, v2
    v_bfe_u32 v3, v1, 4, 1
    v_lshlrev_b32 v3, 5, v3
    v_add_u32 v220, v220, v3
    v_and_b32 v3, 3, v1
    v_lshlrev_b32 v3, 3, v3
    v_add_u32 v220, v220, v3
    v_bfe_u32 v3, v1, 3, 1
    v_xor_b32 v3, s49, v3
    v_lshlrev_b32 v3, 6, v3
    v_add_u32 v220, v220, v3
    v_xor_b32 v221, 64, v220
    s_mul_i32 s45, s49, 28672
    s_add_u32 s45, s45, 81920
    v_add_u32 v220, s45, v220
    v_add_u32 v221, s45, v221
    s_mul_i32 s46, s2, 2097152
    s_add_u32 s46, s46, 17825792
    s_lshl_b32 s45, s50, 15
    s_add_u32 s46, s46, s45
    s_lshl_b32 s45, s49, 14
    s_add_u32 s46, s46, s45
    s_mul_i32 s44, s19, 32768
    s_add_u32 s44, s44, 65536
    s_lshl_b32 s45, s16, 11
    s_add_u32 s44, s44, s45
    s_mul_i32 s45, s49, 1024
    s_add_u32 s44, s44, s45
    s_lshl_b32 s45, s51, 2
    s_add_u32 s44, s44, s45
    v_min_u32 v2, 7, v1
    v_lshlrev_b32 v2, 7, v2
    s_mov_b32 s59, s36
L_poll_33:
    buffer_load_dword v3, v2, s[8:11], s44 offen sc1
    s_waitcnt vmcnt(0)
    v_cmp_eq_u32 vcc, 0, v3
    s_cbranch_vccz L_polld_34
    s_sub_u32 s59, s59, 1
    s_cmp_lg_u32 s59, 0
    s_cbranch_scc1 L_poll_33
    s_mov_b32 s36, 1
L_polld_34:
    buffer_load_dwordx4 v[16:19], v0, s[8:11], s46 offen offset:0 sc1
    buffer_load_dwordx4 v[20:23], v0, s[8:11], s46 offen offset:1024 sc1
    buffer_load_dwordx4 v[24:27], v0, s[8:11], s46 offen offset:2048 sc1
    buffer_load_dwordx4 v[28:31], v0, s[8:11], s46 offen offset:3072 sc1
    s_add_u32 s46, s46, 4096
    buffer_load_dwordx4 v[32:35], v0, s[8:11], s46 offen offset:0 sc1
    buffer_load_dwordx4 v[36:39], v0, s[8:11], s46 offen offset:1024 sc1
    buffer_load_dwordx4 v[40:43], v0, s[8:11], s46 offen offset:2048 sc1
    buffer_load_dwordx4 v[44:47], v0, s[8:11], s46 offen offset:3072 sc1
    s_add_u32 s46, s46, 4096
    buffer_load_dwordx4 v[48:51], v0, s[8:11], s46 offen offset:0 sc1
    buffer_load_dwordx4 v[52:55], v0, s[8:11], s46 offen offset:1024 sc1
    ds_read_b64_tr_b16 v[128:129], v220 offset:0
    ds_read_b64_tr_b16 v[130:131], v220 offset:1024
    ds_read_b64_tr_b16 v[132:133], v221 offset:0
    ds_read_b64_tr_b16 v[134:135], v221 offset:1024
    ds_read_b64_tr_b16 v[136:137], v220 offset:2048
    ds_read_b64_tr_b16 v[138:139], v220 offset:3072
    ds_read_b64_tr_b16 v[140:141], v221 offset:2048
    ds_read_b64_tr_b16 v[142:143], v221 offset:3072
    s_waitcnt vmcnt(9) lgkmcnt(4)
    v_mfma_f32_32x32x16_bf16 v[80:95], v[128:131], v[16:19], 0
    ds_read_b64_tr_b16 v[144:145], v220 offset:3584
    ds_read_b64_tr_b16 v[146:147], v220 offset:4608
    buffer_load_dwordx4 v[56:59], v0, s[8:11], s46 offen offset:2048 sc1
    v_mfma_f32_32x32x16_bf16 v[96:111], v[132:135], v[16:19], 0
    ds_read_b64_tr_b16 v[148:149], v221 offset:3584
    ds_read_b64_tr_b16 v[150:151], v221 offset:4608
    s_waitcnt vmcnt(9) lgkmcnt(4)
    v_mfma_f32_32x32x16_bf16 v[80:95], v[136:139], v[20:23], v[80:95]
    ds_read_b64_tr_b16 v[128:129], v220 offset:5632
    ds_read_b64_tr_b16 v[130:131], v220 offset:6656
    buffer_load_dwordx4 v[60:63], v0, s[8:11], s46 offen offset:3072 sc1
    v_mfma_f32_32x32x16_bf16 v[96:111], v[140:143], v[20:23], v[96:111]
    ds_read_b64_tr_b16 v[132:133], v221 offset:5632
    ds_read_b64_tr_b16 v[134:135], v221 offset:6656
    s_waitcnt vmcnt(9) lgkmcnt(4)
    v_mfma_f32_32x32x16_bf16 v[80:95], v[144:147], v[24:27], v[80:95]
    ds_read_b64_tr_b16 v[136:137], v220 offset:7168
    ds_read_b64_tr_b16 v[138:139], v220 offset:8192
    s_add_u32 s46, s46, 4096
    buffer_load_dwordx4 v[64:67], v0, s[8:11], s46 offen offset:0 sc1
    v_mfma_f32_32x32x16_bf16 v[96:111], v[148:151], v[24:27], v[96:111]
    ds_read_b64_tr_b16 v[140:141], v221 offset:7168
    ds_read_b64_tr_b16 v[142:143], v221 offset:8192
    s_waitcnt vmcnt(9) lgkmcnt(4)
    v_mfma_f32_32x32x16_bf16 v[80:95], v[128:131], v[28:31], v[80:95]
    ds_read_b64_tr_b16 v[144:145], v220 offset:9216
    ds_read_b64_tr_b16 v[146:147], v220 offset:10240
    buffer_load_dwordx4 v[68:71], v0, s[8:11], s46 offen offset:1024 sc1
    v_mfma_f32_32x32x16_bf16 v[96:111], v[132:135], v[28:31], v[96:111]
    ds_read_b64_tr_b16 v[148:149], v221 offset:9216
    ds_read_b64_tr_b16 v[150:151], v221 offset:10240
    s_waitcnt vmcnt(9) lgkmcnt(4)
    v_mfma_f32_32x32x16_bf16 v[80:95], v[136:139], v[32:35], v[80:95]
    ds_read_b64_tr_b16 v[128:129], v220 offset:10752
    ds_read_b64_tr_b16 v[130:131], v220 offset:11776
    buffer_load_dwordx4 v[72:75], v0, s[8:11], s46 offen offset:2048 sc1
    v_mfma_f32_32x32x16_bf16 v[96:111], v[140:143], v[32:35], v[96:111]
    ds_read_b64_tr_b16 v[132:133], v221 offset:10752
    ds_read_b64_tr_b16 v[134:135], v221 offset:11776
    s_waitcnt vmcnt(9) lgkmcnt(4)
    v_mfma_f32_32x32x16_bf16 v[80:95], v[144:147], v[36:39], v[80:95]
    ds_read_b64_tr_b16 v[136:137], v220 offset:12800
    ds_read_b64_tr_b16 v[138:139], v220 offset:13824
    buffer_load_dwordx4 v[76:79], v0, s[8:11], s46 offen offset:3072 sc1
    v_mfma_f32_32x32x16_bf16 v[96:111], v[148:151], v[36:39], v[96:111]
    ds_read_b64_tr_b16 v[140:141], v221 offset:12800
    ds_read_b64_tr_b16 v[142:143], v221 offset:13824
    s_waitcnt vmcnt(9) lgkmcnt(4)
    v_mfma_f32_32x32x16_bf16 v[80:95], v[128:131], v[40:43], v[80:95]
    ds_read_b64_tr_b16 v[144:145], v220 offset:14336
    ds_read_b64_tr_b16 v[146:147], v220 offset:15360
    v_mfma_f32_32x32x16_bf16 v[96:111], v[132:135], v[40:43], v[96:111]
    ds_read_b64_tr_b16 v[148:149], v221 offset:14336
    ds_read_b64_tr_b16 v[150:151], v221 offset:15360
    s_waitcnt vmcnt(8) lgkmcnt(4)
    v_mfma_f32_32x32x16_bf16 v[80:95], v[136:139], v[44:47], v[80:95]
    ds_read_b64_tr_b16 v[128:129], v220 offset:16384
    ds_read_b64_tr_b16 v[130:131], v220 offset:17408
    v_mfma_f32_32x32x16_bf16 v[96:111], v[140:143], v[44:47], v[96:111]
    ds_read_b64_tr_b16 v[132:133], v221 offset:16384
    ds_read_b64_tr_b16 v[134:135], v221 offset:17408
    s_waitcnt vmcnt(7) lgkmcnt(4)
    v_mfma_f32_32x32x16_bf16 v[80:95], v[144:147], v[48:51], v[80:95]
    ds_read_b64_tr_b16 v[136:137], v220 offset:17920
    ds_read_b64_tr_b16 v[138:139], v220 offset:18944
    v_mfma_f32_32x32x16_bf16 v[96:111], v[148:151], v[48:51], v[96:111]
    ds_read_b64_tr_b16 v[140:141], v221 offset:17920
    ds_read_b64_tr_b16 v[142:143], v221 offset:18944
    s_waitcnt vmcnt(6) lgkmcnt(4)
    v_mfma_f32_32x32x16_bf16 v[80:95], v[128:131], v[52:55], v[80:95]
    ds_read_b64_tr_b16 v[144:145], v220 offset:19968
    ds_read_b64_tr_b16 v[146:147], v220 offset:20992
    v_mfma_f32_32x32x16_bf16 v[96:111], v[132:135], v[52:55], v[96:111]
    ds_read_b64_tr_b16 v[148:149], v221 offset:19968
    ds_read_b64_tr_b16 v[150:151], v221 offset:20992
    s_waitcnt vmcnt(5) lgkmcnt(4)
    v_mfma_f32_32x32x16_bf16 v[80:95], v[136:139], v[56:59], v[80:95]
    ds_read_b64_tr_b16 v[128:129], v220 offset:21504
    ds_read_b64_tr_b16 v[130:131], v220 offset:22528
    v_mfma_f32_32x32x16_bf16 v[96:111], v[140:143], v[56:59], v[96:111]
    ds_read_b64_tr_b16 v[132:133], v221 offset:21504
    ds_read_b64_tr_b16 v[134:135], v221 offset:22528
    s_waitcnt vmcnt(4) lgkmcnt(4)
    v_mfma_f32_32x32x16_bf16 v[80:95], v[144:147], v[60:63], v[80:95]
    ds_read_b64_tr_b16 v[136:137], v220 offset:23552
    ds_read_b64_tr_b16 v[138:139], v220 offset:24576
    v_mfma_f32_32x32x16_bf16 v[96:111], v[148:151], v[60:63], v[96:111]
    ds_read_b64_tr_b16 v[140:141], v221 offset:23552
    ds_read_b64_tr_b16 v[142:143], v221 offset:24576
    s_waitcnt vmcnt(3) lgkmcnt(4)
    v_mfma_f32_32x32x16_bf16 v[80:95], v[128:131], v[64:67], v[80:95]
    ds_read_b64_tr_b16 v[144:145], v220 offset:25088
    ds_read_b64_tr_b16 v[146:147], v220 offset:26112
    v_mfma_f32_32x32x16_bf16 v[96:111], v[132:135], v[64:67], v[96:111]
    ds_read_b64_tr_b16 v[148:149], v221 offset:25088
    ds_read_b64_tr_b16 v[150:151], v221 offset:26112
    s_waitcnt vmcnt(2) lgkmcnt(4)
    v_mfma_f32_32x32x16_bf16 v[80:95], v[136:139], v[68:71], v[80:95]
    ds_read_b64_tr_b16 v[128:129], v220 offset:27136
    ds_read_b64_tr_b16 v[130:131], v220 offset:28160
    v_mfma_f32_32x32x16_bf16 v[96:111], v[140:143], v[68:71], v[96:111]
    ds_read_b64_tr_b16 v[132:133], v221 offset:27136
    ds_read_b64_tr_b16 v[134:135], v221 offset:28160
    s_waitcnt vmcnt(1) lgkmcnt(4)
    v_mfma_f32_32x32x16_bf16 v[80:95], v[144:147], v[72:75], v[80:95]
    v_mfma_f32_32x32x16_bf16 v[96:111], v[148:151], v[72:75], v[96:111]
    s_waitcnt vmcnt(0) lgkmcnt(0)
    v_mfma_f32_32x32x16_bf16 v[80:95], v[128:131], v[76:79], v[80:95]
    v_mfma_f32_32x32x16_bf16 v[96:111], v[132:135], v[76:79], v[96:111]
    s_lshl_b32 s45, s3, 12
    s_add_u32 s45, s45, 145408
    v_add_u32 v2, s45, v0
    s_xor_b32 s45, s3, 2
    s_lshl_b32 s45, s45, 12
    s_add_u32 s45, s45, 145408
    v_add_u32 v3, s45, v0
    s_nop 7
    ds_write_b128 v2, v[96:99] offset:0
    ds_write_b128 v2, v[100:103] offset:1024
    ds_write_b128 v2, v[104:107] offset:2048
    ds_write_b128 v2, v[108:111] offset:3072
    s_waitcnt lgkmcnt(0)
    s_barrier
    ds_read_b128 v[112:115], v3 offset:0
    ds_read_b128 v[116:119], v3 offset:1024
    ds_read_b128 v[120:123], v3 offset:2048
    ds_read_b128 v[124:127], v3 offset:3072
    v_lshlrev_b32 v16, 16, v152
    v_and_b32 v17, 0xffff0000, v152
    v_lshlrev_b32 v18, 16, v153
    v_and_b32 v19, 0xffff0000, v153
    v_lshlrev_b32 v20, 16, v154
    v_and_b32 v21, 0xffff0000, v154
    v_lshlrev_b32 v22, 16, v155
    v_and_b32 v23, 0xffff0000, v155
    v_lshlrev_b32 v24, 16, v156
    v_and_b32 v25, 0xffff0000, v156
    v_lshlrev_b32 v26, 16, v157
    v_and_b32 v27, 0xffff0000, v157
    v_lshlrev_b32 v28, 16, v158
    v_and_b32 v29, 0xffff0000, v158
    v_lshlrev_b32 v30, 16, v159
    v_and_b32 v31, 0xffff0000, v159
    v_add_f32 v80, v80, v16
    v_add_f32 v81, v81, v17
    v_add_f32 v82, v82, v18
    v_add_f32 v83, v83, v19
    v_add_f32 v84, v84, v20
    v_add_f32 v85, v85, v21
    v_add_f32 v86, v86, v22
    v_add_f32 v87, v87, v23
    v_add_f32 v88, v88, v24
    v_add_f32 v89, v89, v25
    v_add_f32 v90, v90, v26
    v_add_f32 v91, v91, v27
    v_add_f32 v92, v92, v28
    v_add_f32 v93, v93, v29
    v_add_f32 v94, v94, v30
    v_add_f32 v95, v95, v31
    s_waitcnt lgkmcnt(0)
    s_barrier
    v_add_f32 v80, v80, v112
    v_add_f32 v81, v81, v113
    v_add_f32 v82, v82, v114
    v_add_f32 v83, v83, v115
    v_add_f32 v84, v84, v116
    v_add_f32 v85, v85, v117
    v_add_f32 v86, v86, v118
    v_add_f32 v87, v87, v119
    v_add_f32 v88, v88, v120
    v_add_f32 v89, v89, v121
    v_add_f32 v90, v90, v122
    v_add_f32 v91, v91, v123
    v_add_f32 v92, v92, v124
    v_add_f32 v93, v93, v125
    v_add_f32 v94, v94, v126
    v_add_f32 v95, v95, v127
    v_cvt_pk_bf16_f32 v112, v80, v81
    v_cvt_pk_bf16_f32 v113, v82, v83
    v_cvt_pk_bf16_f32 v114, v84, v85
    v_cvt_pk_bf16_f32 v115, v86, v87
    v_cvt_pk_bf16_f32 v116, v88, v89
    v_cvt_pk_bf16_f32 v117, v90, v91
    v_cvt_pk_bf16_f32 v118, v92, v93
    v_cvt_pk_bf16_f32 v119, v94, v95
    s_mul_i32 s44, s2, 4194304
    s_add_u32 s44, s44, 3145728
    s_add_u32 s44, s44, s52
    s_cmp_eq_u32 s39, 1
    s_cbranch_scc0 L_wt_35
    buffer_store_dwordx4 v[112:115], v0, s[8:11], s44 offen offset:0
    buffer_store_dwordx4 v[116:119], v0, s[8:11], s44 offen offset:1024
    s_branch L_wtd_36
L_wt_35:
    buffer_store_dwordx4 v[112:115], v0, s[8:11], s44 offen offset:0 sc1
    buffer_store_dwordx4 v[116:119], v0, s[8:11], s44 offen offset:1024 sc1
L_wtd_36:
    v_pk_add_f32 v[4:5], v[80:81], v[82:83]
    v_pk_mul_f32 v[6:7], v[80:81], v[80:81]
    v_pk_fma_f32 v[6:7], v[82:83], v[82:83], v[6:7]
    v_pk_fma_f32 v[6:7], v[84:85], v[84:85], v[6:7]
    v_pk_add_f32 v[4:5], v[4:5], v[84:85]
    v_pk_fma_f32 v[6:7], v[86:87], v[86:87], v[6:7]
    v_pk_add_f32 v[4:5], v[4:5], v[86:87]
    v_pk_fma_f32 v[6:7], v[88:89], v[88:89], v[6:7]
    v_pk_add_f32 v[4:5], v[4:5], v[88:89]
    v_pk_fma_f32 v[6:7], v[90:91], v[90:91], v[6:7]
    v_pk_add_f32 v[4:5], v[4:5], v[90:91]
    v_pk_fma_f32 v[6:7], v[92:93], v[92:93], v[6:7]
    v_pk_add_f32 v[4:5], v[4:5], v[92:93]
    v_pk_fma_f32 v[6:7], v[94:95], v[94:95], v[6:7]
    v_pk_add_f32 v[4:5], v[4:5], v[94:95]
    v_add_f32 v4, v4, v5
    v_add_f32 v5, v6, v7
    v_mov_b32 v8, v4
    v_mov_b32 v9, v5
    s_nop 0
    v_permlane32_swap_b32 v4, v8
    v_permlane32_swap_b32 v5, v9
    s_nop 0
    v_add_f32 v4, v4, v8
    v_add_f32 v5, v5, v9
    s_mul_i32 s44, s2, 524288
    s_add_u32 s44, s44, 39583744
    s_lshl_b32 s45, s53, 8
    s_add_u32 s44, s44, s45
    v_lshlrev_b32 v2, 3, v1
    s_mov_b32 exec_hi, 0
    s_cmp_eq_u32 s39, 1
    s_cbranch_scc0 L_wt_37
    buffer_store_dwordx2 v[4:5], v2, s[8:11], s44 offen
    s_branch L_wtd_38
L_wt_37:
    buffer_store_dwordx2 v[4:5], v2, s[8:11], s44 offen sc1
L_wtd_38:
    s_mov_b64 exec, -1
    s_mul_i32 s57, s19, 32768
    s_add_u32 s57, s57, 131072
    s_lshl_b32 s58, s16, 11
    s_add_u32 s57, s57, s58
    s_lshl_b32 s58, s17, 7
    s_add_u32 s57, s57, s58
    s_lshl_b32 s58, s3, 2
    s_add_u32 s57, s57, s58
    v_mov_b32 v6, 1
    v_mov_b32 v7, 0
    s_waitcnt vmcnt(0)
    s_mov_b64 exec, 1
    s_cmp_eq_u32 s39, 1
    s_cbranch_scc0 L_wt_39
    buffer_store_dword v6, v7, s[8:11], s57 offen
    s_branch L_wtd_40
L_wt_39:
    buffer_store_dword v6, v7, s[8:11], s57 offen sc1
L_wtd_40:
    s_mov_b64 exec, -1
    s_branch L_op_join_30
L_op_helper_29:
    s_cmp_eq_u32 s18, 0
    s_cbranch_scc0 L_op_noE_41
    v_and_b32 v2, 31, v1
    v_lshrrev_b32 v3, 5, v1
    v_lshlrev_b32 v3, 2, v3
    v_sub_u32 v2, v2, v3
    v_mov_b32 v16, 0
    v_mov_b32 v3, 0x3f80
    v_cmp_eq_u32 vcc, 0, v2
    s_nop 1
    v_cndmask_b32 v16, v16, v3, vcc
    v_mov_b32 v3, 0x3f800000
    v_cmp_eq_u32 vcc, 1, v2
    s_nop 1
    v_cndmask_b32 v16, v16, v3, vcc
    v_mov_b32 v17, 0
    v_mov_b32 v3, 0x3f80
    v_cmp_eq_u32 vcc, 2, v2
    s_nop 1
    v_cndmask_b32 v17, v17, v3, vcc
    v_mov_b32 v3, 0x3f800000
    v_cmp_eq_u32 vcc, 3, v2
    s_nop 1
    v_cndmask_b32 v17, v17, v3, vcc
    v_mov_b32 v18, 0
    v_mov_b32 v3, 0x3f80
    v_cmp_eq_u32 vcc, 8, v2
    s_nop 1
    v_cndmask_b32 v18, v18, v3, vcc
    v_mov_b32 v3, 0x3f800000
    v_cmp_eq_u32 vcc, 9, v2
    s_nop 1
    v_cndmask_b32 v18, v18, v3, vcc
    v_mov_b32 v19, 0
    v_mov_b32 v3, 0x3f80
    v_cmp_eq_u32 vcc, 10, v2
    s_nop 1
    v_cndmask_b32 v19, v19, v3, vcc
    v_mov_b32 v3, 0x3f800000
    v_cmp_eq_u32 vcc, 11, v2
    s_nop 1
    v_cndmask_b32 v19, v19, v3, vcc
    v_mov_b32 v20, 0
    v_mov_b32 v3, 0x3f80
    v_cmp_eq_u32 vcc, 16, v2
    s_nop 1
    v_cndmask_b32 v20, v20, v3, vcc
    v_mov_b32 v3, 0x3f800000
    v_cmp_eq_u32 vcc, 17, v2
    s_nop 1
    v_cndmask_b32 v20, v20, v3, vcc
    v_mov_b32 v21, 0
    v_mov_b32 v3, 0x3f80
    v_cmp_eq_u32 vcc, 18, v2
    s_nop 1
    v_cndmask_b32 v21, v21, v3, vcc
    v_mov_b32 v3, 0x3f800000
    v_cmp_eq_u32 vcc, 19, v2
    s_nop 1
    v_cndmask_b32 v21, v21, v3, vcc
    v_mov_b32 v22, 0
    v_mov_b32 v3, 0x3f80
    v_cmp_eq_u32 vcc, 24, v2
    s_nop 1
    v_cndmask_b32 v22, v22, v3, vcc
    v_mov_b32 v3, 0x3f800000
    v_cmp_eq_u32 vcc, 25, v2
    s_nop 1
    v_cndmask_b32 v22, v22, v3, vcc
    v_mov_b32 v23, 0
    v_mov_b32 v3, 0x3f80
    v_cmp_eq_u32 vcc, 26, v2
    s_nop 1
    v_cndmask_b32 v23, v23, v3, vcc
    v_mov_b32 v3, 0x3f800000
    v_cmp_eq_u32 vcc, 27, v2
    s_nop 1
    v_cndmask_b32 v23, v23, v3, vcc
    v_add_u32 v3, 143360, v0
    ds_write_b128 v3, v[16:19]
    ds_write_b128 v3, v[20:23] offset:1024
L_op_noE_41:
    s_barrier
    s_barrier
    s_waitcnt vmcnt(0)
    s_lshl_b32 s54, s3, 10
    v_add_u32 v10, s54, v0
    ds_write_b128 v10, v[112:115] offset:0
    ds_write_b128 v10, v[116:119] offset:4096
    ds_write_b128 v10, v[120:123] offset:8192
    ds_write_b128 v10, v[124:127] offset:12288
    ds_write_b128 v10, v[128:131] offset:16384
    ds_write_b128 v10, v[132:135] offset:20480
    ds_write_b128 v10, v[136:139] offset:24576
    ds_write_b128 v10, v[140:143] offset:28672
    ds_write_b128 v10, v[144:147] offset:32768
    ds_write_b128 v10, v[148:151] offset:36864
    ds_write_b128 v10, v[152:155] offset:40960
    ds_write_b128 v10, v[156:159] offset:45056
    ds_write_b128 v10, v[160:163] offset:49152
    ds_write_b128 v10, v[164:167] offset:53248
L_op_join_30:
    s_cmp_ge_u32 s18, 4
    s_cbranch_scc0 L_win_helper_42
    v_lshrrev_b32 v2, 5, v1
    v_lshlrev_b32 v2, 2, v2
    v_bfe_u32 v3, v1, 2, 2
    v_add_u32 v2, v2, v3
    v_mul_u32_u24 v224, 128, v2
    v_bfe_u32 v3, v1, 4, 1
    v_lshlrev_b32 v3, 5, v3
    v_add_u32 v224, v224, v3
    v_and_b32 v3, 3, v1
    v_lshlrev_b32 v3, 3, v3
    v_add_u32 v224, v224, v3
    v_bfe_u32 v3, v1, 3, 1
    v_lshlrev_b32 v3, 6, v3
    v_add_u32 v224, v224, v3
    v_xor_b32 v225, 64, v224
    v_lshrrev_b32 v216, 5, v1
    v_lshlrev_b32 v216, 4, v216
    v_add_u32 v216, 161792, v216
    v_add_u32 v216, 512, v216
    s_lshl_b32 s50, s16, 2
    s_add_u32 s50, s50, s3
    s_mul_i32 s46, s2, 524288
    s_add_u32 s46, s46, 39583744
    s_mul_i32 s47, s50, 3584
    s_add_u32 s46, s46, s47
    v_lshrrev_b32 v8, 5, v1
    v_mul_u32_u24 v8, 1792, v8
    v_and_b32 v9, 31, v1
    v_lshl_add_u32 v8, v9, 3, v8
    s_mul_i32 s40, s2, 4194304
    s_add_u32 s40, s40, 3145728
    s_mul_i32 s41, s50, 28672
    s_add_u32 s40, s40, s41
    s_waitcnt lgkmcnt(0)
    s_barrier
    s_mul_i32 s42, s19, 32768
    s_add_u32 s42, s42, 131072
    s_lshl_b32 s43, s16, 11
    s_add_u32 s42, s42, s43
    s_lshr_b32 s43, s3, 1
    s_mul_i32 s43, s43, 896
    s_add_u32 s42, s42, s43
    s_and_b32 s43, s3, 1
    s_lshl_b32 s43, s43, 2
    s_add_u32 s42, s42, s43
    v_min_u32 v2, 13, v1
    v_lshrrev_b32 v3, 1, v2
    v_lshlrev_b32 v3, 7, v3
    v_and_b32 v2, 1, v2
    v_lshlrev_b32 v2, 3, v2
    v_add_u32 v2, v2, v3
    s_mov_b32 s59, s36
L_poll_44:
    buffer_load_dword v3, v2, s[8:11], s42 offen sc1
    s_waitcnt vmcnt(0)
    v_cmp_eq_u32 vcc, 0, v3
    s_cbranch_vccz L_polld_45
    s_sub_u32 s59, s59, 1
    s_cmp_lg_u32 s59, 0
    s_cbranch_scc1 L_poll_44
    s_mov_b32 s36, 1
L_polld_45:
    buffer_load_dwordx4 v[16:19], v0, s[8:11], s40 offen offset:0 sc1
    buffer_load_dwordx4 v[20:23], v0, s[8:11], s40 offen offset:1024 sc1
    buffer_load_dwordx4 v[24:27], v0, s[8:11], s40 offen offset:2048 sc1
    buffer_load_dwordx4 v[28:31], v0, s[8:11], s40 offen offset:3072 sc1
    s_add_u32 s40, s40, 4096
    buffer_load_dwordx4 v[32:35], v0, s[8:11], s40 offen offset:0 sc1
    buffer_load_dwordx4 v[36:39], v0, s[8:11], s40 offen offset:1024 sc1
    buffer_load_dwordx4 v[40:43], v0, s[8:11], s40 offen offset:2048 sc1
    buffer_load_dwordx4 v[44:47], v0, s[8:11], s40 offen offset:3072 sc1
    s_add_u32 s40, s40, 4096
    buffer_load_dwordx4 v[48:51], v0, s[8:11], s40 offen offset:0 sc1
    buffer_load_dwordx4 v[52:55], v0, s[8:11], s40 offen offset:1024 sc1
    buffer_load_dwordx2 v[226:227], v8, s[8:11], s46 offen offset:0 sc1
    buffer_load_dwordx2 v[228:229], v8, s[8:11], s46 offen offset:256 sc1
    buffer_load_dwordx2 v[230:231], v8, s[8:11], s46 offen offset:512 sc1
    buffer_load_dwordx2 v[232:233], v8, s[8:11], s46 offen offset:768 sc1
    buffer_load_dwordx2 v[234:235], v8, s[8:11], s46 offen offset:1024 sc1
    buffer_load_dwordx2 v[236:237], v8, s[8:11], s46 offen offset:1280 sc1
    buffer_load_dwordx2 v[238:239], v8, s[8:11], s46 offen offset:1536 sc1
    ds_read_b64_tr_b16 v[192:193], v224 offset:0
    ds_read_b64_tr_b16 v[194:195], v224 offset:1024
    ds_read_b64_tr_b16 v[196:197], v225 offset:0
    ds_read_b64_tr_b16 v[198:199], v225 offset:1024
    ds_read_b64_tr_b16 v[200:201], v224 offset:2048
    ds_read_b64_tr_b16 v[202:203], v224 offset:3072
    ds_read_b64_tr_b16 v[204:205], v225 offset:2048
    ds_read_b64_tr_b16 v[206:207], v225 offset:3072
    s_waitcnt vmcnt(16) lgkmcnt(4)
    v_mfma_f32_32x32x16_bf16 v[128:143], v[192:195], v[16:19], 0
    ds_read_b64_tr_b16 v[208:209], v224 offset:4096
    ds_read_b64_tr_b16 v[210:211], v224 offset:5120
    buffer_load_dwordx4 v[56:59], v0, s[8:11], s40 offen offset:2048 sc1
    v_mfma_f32_32x32x16_bf16 v[144:159], v[196:199], v[16:19], 0
    ds_read_b64_tr_b16 v[212:213], v225 offset:4096
    ds_read_b64_tr_b16 v[214:215], v225 offset:5120
    s_waitcnt vmcnt(16) lgkmcnt(4)
    v_mfma_f32_32x32x16_bf16 v[128:143], v[200:203], v[20:23], v[128:143]
    ds_read_b64_tr_b16 v[192:193], v224 offset:6144
    ds_read_b64_tr_b16 v[194:195], v224 offset:7168
    buffer_load_dwordx4 v[60:63], v0, s[8:11], s40 offen offset:3072 sc1
    v_mfma_f32_32x32x16_bf16 v[144:159], v[204:207], v[20:23], v[144:159]
    ds_read_b64_tr_b16 v[196:197], v225 offset:6144
    ds_read_b64_tr_b16 v[198:199], v225 offset:7168
    s_waitcnt vmcnt(16) lgkmcnt(4)
    v_mfma_f32_32x32x16_bf16 v[128:143], v[208:211], v[24:27], v[128:143]
    ds_read_b64_tr_b16 v[200:201], v224 offset:8192
    ds_read_b64_tr_b16 v[202:203], v224 offset:9216
    s_add_u32 s40, s40, 4096
    buffer_load_dwordx4 v[64:67], v0, s[8:11], s40 offen offset:0 sc1
    v_mfma_f32_32x32x16_bf16 v[144:159], v[212:215], v[24:27], v[144:159]
    ds_read_b64_tr_b16 v[204:205], v225 offset:8192
    ds_read_b64_tr_b16 v[206:207], v225 offset:9216
    s_waitcnt vmcnt(16) lgkmcnt(4)
    v_mfma_f32_32x32x16_bf16 v[128:143], v[192:195], v[28:31], v[128:143]
    ds_read_b64_tr_b16 v[208:209], v224 offset:10240
    ds_read_b64_tr_b16 v[210:211], v224 offset:11264
    buffer_load_dwordx4 v[68:71], v0, s[8:11], s40 offen offset:1024 sc1
    v_mfma_f32_32x32x16_bf16 v[144:159], v[196:199], v[28:31], v[144:159]
    ds_read_b64_tr_b16 v[212:213], v225 offset:10240
    ds_read_b64_tr_b16 v[214:215], v225 offset:11264
    s_waitcnt vmcnt(16) lgkmcnt(4)
    v_mfma_f32_32x32x16_bf16 v[128:143], v[200:203], v[32:35], v[128:143]
    ds_read_b64_tr_b16 v[192:193], v224 offset:12288
    ds_read_b64_tr_b16 v[194:195], v224 offset:13312
    buffer_load_dwordx4 v[72:75], v0, s[8:11], s40 offen offset:2048 sc1
    v_mfma_f32_32x32x16_bf16 v[144:159], v[204:207], v[32:35], v[144:159]
    ds_read_b64_tr_b16 v[196:197], v225 offset:12288
    ds_read_b64_tr_b16 v[198:199], v225 offset:13312
    s_waitcnt vmcnt(16) lgkmcnt(4)
    v_mfma_f32_32x32x16_bf16 v[128:143], v[208:211], v[36:39], v[128:143]
    ds_read_b64_tr_b16 v[200:201], v224 offset:14336
    ds_read_b64_tr_b16 v[202:203], v224 offset:15360
    buffer_load_dwordx4 v[76:79], v0, s[8:11], s40 offen offset:3072 sc1
    v_mfma_f32_32x32x16_bf16 v[144:159], v[212:215], v[36:39], v[144:159]
    ds_read_b64_tr_b16 v[204:205], v225 offset:14336
    ds_read_b64_tr_b16 v[206:207], v225 offset:15360
    s_waitcnt vmcnt(16) lgkmcnt(4)
    v_mfma_f32_32x32x16_bf16 v[128:143], v[192:195], v[40:43], v[128:143]
    ds_read_b64_tr_b16 v[208:209], v224 offset:16384
    ds_read_b64_tr_b16 v[210:211], v224 offset:17408
    s_add_u32 s40, s40, 4096
    buffer_load_dwordx4 v[80:83], v0, s[8:11], s40 offen offset:0 sc1
    v_mfma_f32_32x32x16_bf16 v[144:159], v[196:199], v[40:43], v[144:159]
    ds_read_b64_tr_b16 v[212:213], v225 offset:16384
    ds_read_b64_tr_b16 v[214:215], v225 offset:17408
    s_waitcnt vmcnt(16) lgkmcnt(4)
    v_mfma_f32_32x32x16_bf16 v[128:143], v[200:203], v[44:47], v[128:143]
    ds_read_b64_tr_b16 v[192:193], v224 offset:18432
    ds_read_b64_tr_b16 v[194:195], v224 offset:19456
    buffer_load_dwordx4 v[84:87], v0, s[8:11], s40 offen offset:1024 sc1
    v_mfma_f32_32x32x16_bf16 v[144:159], v[204:207], v[44:47], v[144:159]
    ds_read_b64_tr_b16 v[196:197], v225 offset:18432
    ds_read_b64_tr_b16 v[198:199], v225 offset:19456
    s_waitcnt vmcnt(16) lgkmcnt(4)
    v_mfma_f32_32x32x16_bf16 v[128:143], v[208:211], v[48:51], v[128:143]
    ds_read_b64_tr_b16 v[200:201], v224 offset:20480
    ds_read_b64_tr_b16 v[202:203], v224 offset:21504
    buffer_load_dwordx4 v[88:91], v0, s[8:11], s40 offen offset:2048 sc1
    v_mfma_f32_32x32x16_bf16 v[144:159], v[212:215], v[48:51], v[144:159]
    ds_read_b64_tr_b16 v[204:205], v225 offset:20480
    ds_read_b64_tr_b16 v[206:207], v225 offset:21504
    s_waitcnt vmcnt(16) lgkmcnt(4)
    v_mfma_f32_32x32x16_bf16 v[128:143], v[192:195], v[52:55], v[128:143]
    ds_read_b64_tr_b16 v[208:209], v224 offset:22528
    ds_read_b64_tr_b16 v[210:211], v224 offset:23552
    buffer_load_dwordx4 v[92:95], v0, s[8:11], s40 offen offset:3072 sc1
    v_mfma_f32_32x32x16_bf16 v[144:159], v[196:199], v[52:55], v[144:159]
    ds_read_b64_tr_b16 v[212:213], v225 offset:22528
    ds_read_b64_tr_b16 v[214:215], v225 offset:23552
    s_waitcnt vmcnt(9) lgkmcnt(4)
    v_mfma_f32_32x32x16_bf16 v[128:143], v[200:203], v[56:59], v[128:143]
    ds_read_b64_tr_b16 v[192:193], v224 offset:24576
    ds_read_b64_tr_b16 v[194:195], v224 offset:25600
    s_add_u32 s40, s40, 4096
    buffer_load_dwordx4 v[96:99], v0, s[8:11], s40 offen offset:0 sc1
    v_mfma_f32_32x32x16_bf16 v[144:159], v[204:207], v[56:59], v[144:159]
    ds_read_b64_tr_b16 v[196:197], v225 offset:24576
    ds_read_b64_tr_b16 v[198:199], v225 offset:25600
    s_waitcnt vmcnt(9) lgkmcnt(4)
    v_mfma_f32_32x32x16_bf16 v[128:143], v[208:211], v[60:63], v[128:143]
    ds_read_b64_tr_b16 v[200:201], v224 offset:26624
    ds_read_b64_tr_b16 v[202:203], v224 offset:27648
    buffer_load_dwordx4 v[100:103], v0, s[8:11], s40 offen offset:1024 sc1
    v_mfma_f32_32x32x16_bf16 v[144:159], v[212:215], v[60:63], v[144:159]
    ds_read_b64_tr_b16 v[204:205], v225 offset:26624
    ds_read_b64_tr_b16 v[206:207], v225 offset:27648
    v_add_f32 v226, v226, v228
    v_add_f32 v227, v227, v229
    v_add_f32 v226, v226, v230
    v_add_f32 v227, v227, v231
    v_add_f32 v226, v226, v232
    v_add_f32 v227, v227, v233
    v_add_f32 v226, v226, v234
    v_add_f32 v227, v227, v235
    v_add_f32 v226, v226, v236
    v_add_f32 v227, v227, v237
    v_add_f32 v226, v226, v238
    v_add_f32 v227, v227, v239
    v_mov_b32 v228, v226
    v_mov_b32 v229, v227
    s_nop 0
    v_permlane32_swap_b32 v226, v228
    v_permlane32_swap_b32 v227, v229
    s_nop 0
    v_add_f32 v226, v226, v228
    v_add_f32 v227, v227, v229
    v_mul_f32 v226, 0x3b124925, v226
    v_mul_f32 v227, 0x3b124925, v227
    v_fma_f32 v227, -v226, v226, v227
    v_max_f32 v227, 0, v227
    v_add_f32 v227, 0x3727c5ac, v227
    v_rsq_f32 v222, v227
    s_nop 0
    v_mul_f32 v10, v226, v222
    s_waitcnt vmcnt(9) lgkmcnt(4)
    v_mfma_f32_32x32x16_bf16 v[128:143], v[192:195], v[64:67], v[128:143]
    ds_read_b64_tr_b16 v[208:209], v224 offset:28672
    ds_read_b64_tr_b16 v[210:211], v224 offset:29696
    buffer_load_dwordx4 v[104:107], v0, s[8:11], s40 offen offset:2048 sc1
    v_mfma_f32_32x32x16_bf16 v[144:159], v[196:199], v[64:67], v[144:159]
    ds_read_b64_tr_b16 v[212:213], v225 offset:28672
    ds_read_b64_tr_b16 v[214:215], v225 offset:29696
    s_waitcnt vmcnt(9) lgkmcnt(4)
    v_mfma_f32_32x32x16_bf16 v[128:143], v[200:203], v[68:71], v[128:143]
    ds_read_b64_tr_b16 v[192:193], v224 offset:30720
    ds_read_b64_tr_b16 v[194:195], v224 offset:31744
    buffer_load_dwordx4 v[108:111], v0, s[8:11], s40 offen offset:3072 sc1
    v_mfma_f32_32x32x16_bf16 v[144:159], v[204:207], v[68:71], v[144:159]
    ds_read_b64_tr_b16 v[196:197], v225 offset:30720
    ds_read_b64_tr_b16 v[198:199], v225 offset:31744
    s_waitcnt vmcnt(9) lgkmcnt(4)
    v_mfma_f32_32x32x16_bf16 v[128:143], v[208:211], v[72:75], v[128:143]
    ds_read_b64_tr_b16 v[200:201], v224 offset:32768
    ds_read_b64_tr_b16 v[202:203], v224 offset:33792
    s_add_u32 s40, s40, 4096
    buffer_load_dwordx4 v[112:115], v0, s[8:11], s40 offen offset:0 sc1
    v_mfma_f32_32x32x16_bf16 v[144:159], v[212:215], v[72:75], v[144:159]
    ds_read_b64_tr_b16 v[204:205], v225 offset:32768
    ds_read_b64_tr_b16 v[206:207], v225 offset:33792
    s_waitcnt vmcnt(9) lgkmcnt(4)
    v_mfma_f32_32x32x16_bf16 v[128:143], v[192:195], v[76:79], v[128:143]
    ds_read_b64_tr_b16 v[208:209], v224 offset:34816
    ds_read_b64_tr_b16 v[210:211], v224 offset:35840
    buffer_load_dwordx4 v[116:119], v0, s[8:11], s40 offen offset:1024 sc1
    v_mfma_f32_32x32x16_bf16 v[144:159], v[196:199], v[76:79], v[144:159]
    ds_read_b64_tr_b16 v[212:213], v225 offset:34816
    ds_read_b64_tr_b16 v[214:215], v225 offset:35840
    s_waitcnt vmcnt(9) lgkmcnt(4)
    v_mfma_f32_32x32x16_bf16 v[128:143], v[200:203], v[80:83], v[128:143]
    ds_read_b64_tr_b16 v[192:193], v224 offset:36864
    ds_read_b64_tr_b16 v[194:195], v224 offset:37888
    buffer_load_dwordx4 v[120:123], v0, s[8:11], s40 offen offset:2048 sc1
    v_mfma_f32_32x32x16_bf16 v[144:159], v[204:207], v[80:83], v[144:159]
    ds_read_b64_tr_b16 v[196:197], v225 offset:36864
    ds_read_b64_tr_b16 v[198:199], v225 offset:37888
    s_waitcnt vmcnt(9) lgkmcnt(4)
    v_mfma_f32_32x32x16_bf16 v[128:143], v[208:211], v[84:87], v[128:143]
    ds_read_b64_tr_b16 v[200:201], v224 offset:38912
    ds_read_b64_tr_b16 v[202:203], v224 offset:39936
    buffer_load_dwordx4 v[124:127], v0, s[8:11], s40 offen offset:3072 sc1
    v_mfma_f32_32x32x16_bf16 v[144:159], v[212:215], v[84:87], v[144:159]
    ds_read_b64_tr_b16 v[204:205], v225 offset:38912
    ds_read_b64_tr_b16 v[206:207], v225 offset:39936
    s_waitcnt vmcnt(9) lgkmcnt(4)
    v_mfma_f32_32x32x16_bf16 v[128:143], v[192:195], v[88:91], v[128:143]
    ds_read_b64_tr_b16 v[208:209], v224 offset:40960
    ds_read_b64_tr_b16 v[210:211], v224 offset:41984
    v_mfma_f32_32x32x16_bf16 v[144:159], v[196:199], v[88:91], v[144:159]
    ds_read_b64_tr_b16 v[212:213], v225 offset:40960
    ds_read_b64_tr_b16 v[214:215], v225 offset:41984
    s_waitcnt vmcnt(8) lgkmcnt(4)
    v_mfma_f32_32x32x16_bf16 v[128:143], v[200:203], v[92:95], v[128:143]
    ds_read_b64_tr_b16 v[192:193], v224 offset:43008
    ds_read_b64_tr_b16 v[194:195], v224 offset:44032
    v_mfma_f32_32x32x16_bf16 v[144:159], v[204:207], v[92:95], v[144:159]
    ds_read_b64_tr_b16 v[196:197], v225 offset:43008
    ds_read_b64_tr_b16 v[198:199], v225 offset:44032
    s_barrier
    s_waitcnt vmcnt(7) lgkmcnt(4)
    v_mfma_f32_32x32x16_bf16 v[128:143], v[208:211], v[96:99], v[128:143]
    ds_read_b64_tr_b16 v[200:201], v224 offset:45056
    ds_read_b64_tr_b16 v[202:203], v224 offset:46080
    v_mfma_f32_32x32x16_bf16 v[144:159], v[212:215], v[96:99], v[144:159]
    ds_read_b64_tr_b16 v[204:205], v225 offset:45056
    ds_read_b64_tr_b16 v[206:207], v225 offset:46080
    s_waitcnt vmcnt(6) lgkmcnt(4)
    v_mfma_f32_32x32x16_bf16 v[128:143], v[192:195], v[100:103], v[128:143]
    ds_read_b64_tr_b16 v[208:209], v224 offset:47104
    ds_read_b64_tr_b16 v[210:211], v224 offset:48128
    v_mfma_f32_32x32x16_bf16 v[144:159], v[196:199], v[100:103], v[144:159]
    ds_read_b64_tr_b16 v[212:213], v225 offset:47104
    ds_read_b64_tr_b16 v[214:215], v225 offset:48128
    s_waitcnt vmcnt(5) lgkmcnt(4)
    v_mfma_f32_32x32x16_bf16 v[128:143], v[200:203], v[104:107], v[128:143]
    ds_read_b64_tr_b16 v[192:193], v224 offset:49152
    ds_read_b64_tr_b16 v[194:195], v224 offset:50176
    v_mfma_f32_32x32x16_bf16 v[144:159], v[204:207], v[104:107], v[144:159]
    ds_read_b64_tr_b16 v[196:197], v225 offset:49152
    ds_read_b64_tr_b16 v[198:199], v225 offset:50176
    s_waitcnt vmcnt(4) lgkmcnt(4)
    v_mfma_f32_32x32x16_bf16 v[128:143], v[208:211], v[108:111], v[128:143]
    ds_read_b64_tr_b16 v[200:201], v224 offset:51200
    ds_read_b64_tr_b16 v[202:203], v224 offset:52224
    v_mfma_f32_32x32x16_bf16 v[144:159], v[212:215], v[108:111], v[144:159]
    ds_read_b64_tr_b16 v[204:205], v225 offset:51200
    ds_read_b64_tr_b16 v[206:207], v225 offset:52224
    s_waitcnt vmcnt(3) lgkmcnt(4)
    v_mfma_f32_32x32x16_bf16 v[128:143], v[192:195], v[112:115], v[128:143]
    ds_read_b64_tr_b16 v[208:209], v224 offset:53248
    ds_read_b64_tr_b16 v[210:211], v224 offset:54272
    v_mfma_f32_32x32x16_bf16 v[144:159], v[196:199], v[112:115], v[144:159]
    ds_read_b64_tr_b16 v[212:213], v225 offset:53248
    ds_read_b64_tr_b16 v[214:215], v225 offset:54272
    s_waitcnt vmcnt(2) lgkmcnt(4)
    v_mfma_f32_32x32x16_bf16 v[128:143], v[200:203], v[116:119], v[128:143]
    ds_read_b64_tr_b16 v[192:193], v224 offset:55296
    ds_read_b64_tr_b16 v[194:195], v224 offset:56320
    v_mfma_f32_32x32x16_bf16 v[144:159], v[204:207], v[116:119], v[144:159]
    ds_read_b64_tr_b16 v[196:197], v225 offset:55296
    ds_read_b64_tr_b16 v[198:199], v225 offset:56320
    s_waitcnt vmcnt(1) lgkmcnt(4)
    v_mfma_f32_32x32x16_bf16 v[128:143], v[208:211], v[120:123], v[128:143]
    v_mfma_f32_32x32x16_bf16 v[144:159], v[212:215], v[120:123], v[144:159]
    s_waitcnt vmcnt(0) lgkmcnt(0)
    v_mfma_f32_32x32x16_bf16 v[128:143], v[192:195], v[124:127], v[128:143]
    v_mfma_f32_32x32x16_bf16 v[144:159], v[196:199], v[124:127], v[144:159]
    ds_read_b128 v[240:243], v216 offset:0
    ds_read_b128 v[244:247], v216 offset:32
    ds_read_b128 v[248:251], v216 offset:64
    ds_read_b128 v[252:255], v216 offset:96
    ds_read_b128 v[192:195], v216 offset:128
    ds_read_b128 v[196:199], v216 offset:160
    ds_read_b128 v[200:203], v216 offset:192
    ds_read_b128 v[204:207], v216 offset:224
    v_mov_b32 v4, 0xc0135761
    v_mov_b32 v12, 0xbdd2d3e8
    v_mov_b32 v14, 1.0
    s_waitcnt lgkmcnt(4)
    v_pk_mul_f32 v[240:241], v[240:241], v[10:11] op_sel_hi:[1,0]
    v_pk_mul_f32 v[242:243], v[242:243], v[10:11] op_sel_hi:[1,0]
    v_pk_mul_f32 v[244:245], v[244:245], v[10:11] op_sel_hi:[1,0]
    v_pk_mul_f32 v[246:247], v[246:247], v[10:11] op_sel_hi:[1,0]
    v_pk_mul_f32 v[248:249], v[248:249], v[10:11] op_sel_hi:[1,0]
    v_pk_mul_f32 v[250:251], v[250:251], v[10:11] op_sel_hi:[1,0]
    v_pk_mul_f32 v[252:253], v[252:253], v[10:11] op_sel_hi:[1,0]
    v_pk_mul_f32 v[254:255], v[254:255], v[10:11] op_sel_hi:[1,0]
    v_pk_fma_f32 v[128:129], v[128:129], v[222:223], v[240:241] op_sel_hi:[1,0,1] neg_lo:[0,0,1] neg_hi:[0,0,1]
    v_pk_fma_f32 v[130:131], v[130:131], v[222:223], v[242:243] op_sel_hi:[1,0,1] neg_lo:[0,0,1] neg_hi:[0,0,1]
    v_pk_fma_f32 v[132:133], v[132:133], v[222:223], v[244:245] op_sel_hi:[1,0,1] neg_lo:[0,0,1] neg_hi:[0,0,1]
    v_pk_fma_f32 v[134:135], v[134:135], v[222:223], v[246:247] op_sel_hi:[1,0,1] neg_lo:[0,0,1] neg_hi:[0,0,1]
    v_pk_fma_f32 v[136:137], v[136:137], v[222:223], v[248:249] op_sel_hi:[1,0,1] neg_lo:[0,0,1] neg_hi:[0,0,1]
    v_pk_fma_f32 v[138:139], v[138:139], v[222:223], v[250:251] op_sel_hi:[1,0,1] neg_lo:[0,0,1] neg_hi:[0,0,1]
    v_pk_fma_f32 v[140:141], v[140:141], v[222:223], v[252:253] op_sel_hi:[1,0,1] neg_lo:[0,0,1] neg_hi:[0,0,1]
    v_pk_fma_f32 v[142:143], v[142:143], v[222:223], v[254:255] op_sel_hi:[1,0,1] neg_lo:[0,0,1] neg_hi:[0,0,1]
    v_pk_mul_f32 v[240:241], v[128:129], v[128:129]
    v_pk_mul_f32 v[242:243], v[130:131], v[130:131]
    v_pk_mul_f32 v[244:245], v[132:133], v[132:133]
    v_pk_mul_f32 v[246:247], v[134:135], v[134:135]
    v_pk_mul_f32 v[248:249], v[136:137], v[136:137]
    v_pk_mul_f32 v[250:251], v[138:139], v[138:139]
    v_pk_mul_f32 v[252:253], v[140:141], v[140:141]
    v_pk_mul_f32 v[254:255], v[142:143], v[142:143]
    v_pk_fma_f32 v[240:241], v[240:241], v[12:13], v[4:5] op_sel_hi:[1,0,0]
    v_pk_fma_f32 v[242:243], v[242:243], v[12:13], v[4:5] op_sel_hi:[1,0,0]
    v_pk_fma_f32 v[244:245], v[244:245], v[12:13], v[4:5] op_sel_hi:[1,0,0]
    v_pk_fma_f32 v[246:247], v[246:247], v[12:13], v[4:5] op_sel_hi:[1,0,0]
    v_pk_fma_f32 v[248:249], v[248:249], v[12:13], v[4:5] op_sel_hi:[1,0,0]
    v_pk_fma_f32 v[250:251], v[250:251], v[12:13], v[4:5] op_sel_hi:[1,0,0]
    v_pk_fma_f32 v[252:253], v[252:253], v[12:13], v[4:5] op_sel_hi:[1,0,0]
    v_pk_fma_f32 v[254:255], v[254:255], v[12:13], v[4:5] op_sel_hi:[1,0,0]
    v_pk_mul_f32 v[240:241], v[128:129], v[240:241]
    v_pk_mul_f32 v[242:243], v[130:131], v[242:243]
    v_pk_mul_f32 v[244:245], v[132:133], v[244:245]
    v_pk_mul_f32 v[246:247], v[134:135], v[246:247]
    v_pk_mul_f32 v[248:249], v[136:137], v[248:249]
    v_pk_mul_f32 v[250:251], v[138:139], v[250:251]
    v_pk_mul_f32 v[252:253], v[140:141], v[252:253]
    v_pk_mul_f32 v[254:255], v[142:143], v[254:255]
    v_exp_f32 v240, v240
    v_exp_f32 v241, v241
    v_exp_f32 v242, v242
    v_exp_f32 v243, v243
    v_exp_f32 v244, v244
    v_exp_f32 v245, v245
    v_exp_f32 v246, v246
    v_exp_f32 v247, v247
    v_exp_f32 v248, v248
    v_exp_f32 v249, v249
    v_exp_f32 v250, v250
    v_exp_f32 v251, v251
    v_exp_f32 v252, v252
    v_exp_f32 v253, v253
    v_exp_f32 v254, v254
    v_exp_f32 v255, v255
    v_pk_add_f32 v[240:241], v[240:241], v[14:15] op_sel_hi:[1,0]
    v_pk_add_f32 v[242:243], v[242:243], v[14:15] op_sel_hi:[1,0]
    v_pk_add_f32 v[244:245], v[244:245], v[14:15] op_sel_hi:[1,0]
    v_pk_add_f32 v[246:247], v[246:247], v[14:15] op_sel_hi:[1,0]
    v_pk_add_f32 v[248:249], v[248:249], v[14:15] op_sel_hi:[1,0]
    v_pk_add_f32 v[250:251], v[250:251], v[14:15] op_sel_hi:[1,0]
    v_pk_add_f32 v[252:253], v[252:253], v[14:15] op_sel_hi:[1,0]
    v_pk_add_f32 v[254:255], v[254:255], v[14:15] op_sel_hi:[1,0]
    v_rcp_f32 v240, v240
    v_rcp_f32 v241, v241
    v_rcp_f32 v242, v242
    v_rcp_f32 v243, v243
    v_rcp_f32 v244, v244
    v_rcp_f32 v245, v245
    v_rcp_f32 v246, v246
    v_rcp_f32 v247, v247
    v_rcp_f32 v248, v248
    v_rcp_f32 v249, v249
    v_rcp_f32 v250, v250
    v_rcp_f32 v251, v251
    v_rcp_f32 v252, v252
    v_rcp_f32 v253, v253
    v_rcp_f32 v254, v254
    v_rcp_f32 v255, v255
    v_pk_mul_f32 v[128:129], v[128:129], v[240:241]
    v_pk_mul_f32 v[130:131], v[130:131], v[242:243]
    v_pk_mul_f32 v[132:133], v[132:133], v[244:245]
    v_pk_mul_f32 v[134:135], v[134:135], v[246:247]
    v_pk_mul_f32 v[136:137], v[136:137], v[248:249]
    v_pk_mul_f32 v[138:139], v[138:139], v[250:251]
    v_pk_mul_f32 v[140:141], v[140:141], v[252:253]
    v_pk_mul_f32 v[142:143], v[142:143], v[254:255]
    s_waitcnt lgkmcnt(0)
    v_pk_mul_f32 v[192:193], v[192:193], v[10:11] op_sel_hi:[1,0]
    v_pk_mul_f32 v[194:195], v[194:195], v[10:11] op_sel_hi:[1,0]
    v_pk_mul_f32 v[196:197], v[196:197], v[10:11] op_sel_hi:[1,0]
    v_pk_mul_f32 v[198:199], v[198:199], v[10:11] op_sel_hi:[1,0]
    v_pk_mul_f32 v[200:201], v[200:201], v[10:11] op_sel_hi:[1,0]
    v_pk_mul_f32 v[202:203], v[202:203], v[10:11] op_sel_hi:[1,0]
    v_pk_mul_f32 v[204:205], v[204:205], v[10:11] op_sel_hi:[1,0]
    v_pk_mul_f32 v[206:207], v[206:207], v[10:11] op_sel_hi:[1,0]
    v_pk_fma_f32 v[144:145], v[144:145], v[222:223], v[192:193] op_sel_hi:[1,0,1] neg_lo:[0,0,1] neg_hi:[0,0,1]
    v_pk_fma_f32 v[146:147], v[146:147], v[222:223], v[194:195] op_sel_hi:[1,0,1] neg_lo:[0,0,1] neg_hi:[0,0,1]
    v_pk_fma_f32 v[148:149], v[148:149], v[222:223], v[196:197] op_sel_hi:[1,0,1] neg_lo:[0,0,1] neg_hi:[0,0,1]
    v_pk_fma_f32 v[150:151], v[150:151], v[222:223], v[198:199] op_sel_hi:[1,0,1] neg_lo:[0,0,1] neg_hi:[0,0,1]
    v_pk_fma_f32 v[152:153], v[152:153], v[222:223], v[200:201] op_sel_hi:[1,0,1] neg_lo:[0,0,1] neg_hi:[0,0,1]
    v_pk_fma_f32 v[154:155], v[154:155], v[222:223], v[202:203] op_sel_hi:[1,0,1] neg_lo:[0,0,1] neg_hi:[0,0,1]
    v_pk_fma_f32 v[156:157], v[156:157], v[222:223], v[204:205] op_sel_hi:[1,0,1] neg_lo:[0,0,1] neg_hi:[0,0,1]
    v_pk_fma_f32 v[158:159], v[158:159], v[222:223], v[206:207] op_sel_hi:[1,0,1] neg_lo:[0,0,1] neg_hi:[0,0,1]
    v_pk_mul_f32 v[192:193], v[144:145], v[144:145]
    v_pk_mul_f32 v[194:195], v[146:147], v[146:147]
    v_pk_mul_f32 v[196:197], v[148:149], v[148:149]
    v_pk_mul_f32 v[198:199], v[150:151], v[150:151]
    v_pk_mul_f32 v[200:201], v[152:153], v[152:153]
    v_pk_mul_f32 v[202:203], v[154:155], v[154:155]
    v_pk_mul_f32 v[204:205], v[156:157], v[156:157]
    v_pk_mul_f32 v[206:207], v[158:159], v[158:159]
    v_pk_fma_f32 v[192:193], v[192:193], v[12:13], v[4:5] op_sel_hi:[1,0,0]
    v_pk_fma_f32 v[194:195], v[194:195], v[12:13], v[4:5] op_sel_hi:[1,0,0]
    v_pk_fma_f32 v[196:197], v[196:197], v[12:13], v[4:5] op_sel_hi:[1,0,0]
    v_pk_fma_f32 v[198:199], v[198:199], v[12:13], v[4:5] op_sel_hi:[1,0,0]
    v_pk_fma_f32 v[200:201], v[200:201], v[12:13], v[4:5] op_sel_hi:[1,0,0]
    v_pk_fma_f32 v[202:203], v[202:203], v[12:13], v[4:5] op_sel_hi:[1,0,0]
    v_pk_fma_f32 v[204:205], v[204:205], v[12:13], v[4:5] op_sel_hi:[1,0,0]
    v_pk_fma_f32 v[206:207], v[206:207], v[12:13], v[4:5] op_sel_hi:[1,0,0]
    v_pk_mul_f32 v[192:193], v[144:145], v[192:193]
    v_pk_mul_f32 v[194:195], v[146:147], v[194:195]
    v_pk_mul_f32 v[196:197], v[148:149], v[196:197]
    v_pk_mul_f32 v[198:199], v[150:151], v[198:199]
    v_pk_mul_f32 v[200:201], v[152:153], v[200:201]
    v_pk_mul_f32 v[202:203], v[154:155], v[202:203]
    v_pk_mul_f32 v[204:205], v[156:157], v[204:205]
    v_pk_mul_f32 v[206:207], v[158:159], v[206:207]
    v_exp_f32 v192, v192
    v_exp_f32 v193, v193
    v_exp_f32 v194, v194
    v_exp_f32 v195, v195
    v_exp_f32 v196, v196
    v_exp_f32 v197, v197
    v_exp_f32 v198, v198
    v_exp_f32 v199, v199
    v_exp_f32 v200, v200
    v_exp_f32 v201, v201
    v_exp_f32 v202, v202
    v_exp_f32 v203, v203
    v_exp_f32 v204, v204
    v_exp_f32 v205, v205
    v_exp_f32 v206, v206
    v_exp_f32 v207, v207
    v_pk_add_f32 v[192:193], v[192:193], v[14:15] op_sel_hi:[1,0]
    v_pk_add_f32 v[194:195], v[194:195], v[14:15] op_sel_hi:[1,0]
    v_pk_add_f32 v[196:197], v[196:197], v[14:15] op_sel_hi:[1,0]
    v_pk_add_f32 v[198:199], v[198:199], v[14:15] op_sel_hi:[1,0]
    v_pk_add_f32 v[200:201], v[200:201], v[14:15] op_sel_hi:[1,0]
    v_pk_add_f32 v[202:203], v[202:203], v[14:15] op_sel_hi:[1,0]
    v_pk_add_f32 v[204:205], v[204:205], v[14:15] op_sel_hi:[1,0]
    v_pk_add_f32 v[206:207], v[206:207], v[14:15] op_sel_hi:[1,0]
    v_rcp_f32 v192, v192
    v_rcp_f32 v193, v193
    v_rcp_f32 v194, v194
    v_rcp_f32 v195, v195
    v_rcp_f32 v196, v196
    v_rcp_f32 v197, v197
    v_rcp_f32 v198, v198
    v_rcp_f32 v199, v199
    v_rcp_f32 v200, v200
    v_rcp_f32 v201, v201
    v_rcp_f32 v202, v202
    v_rcp_f32 v203, v203
    v_rcp_f32 v204, v204
    v_rcp_f32 v205, v205
    v_rcp_f32 v206, v206
    v_rcp_f32 v207, v207
    v_pk_mul_f32 v[144:145], v[144:145], v[192:193]
    v_pk_mul_f32 v[146:147], v[146:147], v[194:195]
    v_pk_mul_f32 v[148:149], v[148:149], v[196:197]
    v_pk_mul_f32 v[150:151], v[150:151], v[198:199]
    v_pk_mul_f32 v[152:153], v[152:153], v[200:201]
    v_pk_mul_f32 v[154:155], v[154:155], v[202:203]
    v_pk_mul_f32 v[156:157], v[156:157], v[204:205]
    v_pk_mul_f32 v[158:159], v[158:159], v[206:207]
    v_pk_add_f32 v[218:219], v[128:129], v[130:131]
    v_pk_mul_f32 v[220:221], v[128:129], v[128:129]
    v_pk_fma_f32 v[220:221], v[130:131], v[130:131], v[220:221]
    v_pk_fma_f32 v[220:221], v[132:133], v[132:133], v[220:221]
    v_pk_add_f32 v[218:219], v[218:219], v[132:133]
    v_pk_fma_f32 v[220:221], v[134:135], v[134:135], v[220:221]
    v_pk_add_f32 v[218:219], v[218:219], v[134:135]
    v_pk_fma_f32 v[220:221], v[136:137], v[136:137], v[220:221]
    v_pk_add_f32 v[218:219], v[218:219], v[136:137]
    v_pk_fma_f32 v[220:221], v[138:139], v[138:139], v[220:221]
    v_pk_add_f32 v[218:219], v[218:219], v[138:139]
    v_pk_fma_f32 v[220:221], v[140:141], v[140:141], v[220:221]
    v_pk_add_f32 v[218:219], v[218:219], v[140:141]
    v_pk_fma_f32 v[220:221], v[142:143], v[142:143], v[220:221]
    v_pk_add_f32 v[218:219], v[218:219], v[142:143]
    v_pk_fma_f32 v[220:221], v[144:145], v[144:145], v[220:221]
    v_pk_add_f32 v[218:219], v[218:219], v[144:145]
    v_pk_fma_f32 v[220:221], v[146:147], v[146:147], v[220:221]
    v_pk_add_f32 v[218:219], v[218:219], v[146:147]
    v_pk_fma_f32 v[220:221], v[148:149], v[148:149], v[220:221]
    v_pk_add_f32 v[218:219], v[218:219], v[148:149]
    v_pk_fma_f32 v[220:221], v[150:151], v[150:151], v[220:221]
    v_pk_add_f32 v[218:219], v[218:219], v[150:151]
    v_pk_fma_f32 v[220:221], v[152:153], v[152:153], v[220:221]
    v_pk_add_f32 v[218:219], v[218:219], v[152:153]
    v_pk_fma_f32 v[220:221], v[154:155], v[154:155], v[220:221]
    v_pk_add_f32 v[218:219], v[218:219], v[154:155]
    v_pk_fma_f32 v[220:221], v[156:157], v[156:157], v[220:221]
    v_pk_add_f32 v[218:219], v[218:219], v[156:157]
    v_pk_fma_f32 v[220:221], v[158:159], v[158:159], v[220:221]
    v_pk_add_f32 v[218:219], v[218:219], v[158:159]
    v_add_f32 v218, v218, v219
    v_add_f32 v219, v220, v221
    v_mov_b32 v208, v218
    v_mov_b32 v209, v219
    s_nop 0
    v_permlane32_swap_b32 v218, v208
    v_permlane32_swap_b32 v219, v209
    s_nop 0
    v_add_f32 v218, v218, v208
    v_add_f32 v219, v219, v209
    s_mul_i32 s40, s19, 262144
    s_add_u32 s40, s40, 38797312
    s_mul_i32 s41, s16, 14
    s_add_u32 s41, s41, s17
    s_lshl_b32 s41, s41, 10
    s_add_u32 s40, s40, s41
    s_lshl_b32 s41, s3, 8
    s_add_u32 s40, s40, s41
    v_lshlrev_b32 v2, 3, v1
    v_mov_b32 v6, v218
    v_or_b32 v7, 0x80000000, v219
    s_mov_b32 exec_hi, 0
    s_cmp_eq_u32 s39, 1
    s_cbranch_scc0 L_wt_46
    buffer_store_dwordx2 v[6:7], v2, s[8:11], s40 offen
    s_branch L_wtd_47
L_wt_46:
    buffer_store_dwordx2 v[6:7], v2, s[8:11], s40 offen sc1
L_wtd_47:
    s_mov_b64 exec, -1
    s_barrier
    v_add_u32 v224, 57344, v224
    v_add_u32 v225, 57344, v225
    ds_read_b64_tr_b16 v[192:193], v224 offset:0
    ds_read_b64_tr_b16 v[194:195], v224 offset:1024
    ds_read_b64_tr_b16 v[196:197], v225 offset:0
    ds_read_b64_tr_b16 v[198:199], v225 offset:1024
    ds_read_b64_tr_b16 v[200:201], v224 offset:2048
    ds_read_b64_tr_b16 v[202:203], v224 offset:3072
    ds_read_b64_tr_b16 v[204:205], v225 offset:2048
    ds_read_b64_tr_b16 v[206:207], v225 offset:3072
    s_waitcnt lgkmcnt(4)
    v_mfma_f32_32x32x16_bf16 v[160:175], v[192:195], v[16:19], 0
    ds_read_b64_tr_b16 v[208:209], v224 offset:4096
    ds_read_b64_tr_b16 v[210:211], v224 offset:5120
    v_mfma_f32_32x32x16_bf16 v[176:191], v[196:199], v[16:19], 0
    ds_read_b64_tr_b16 v[212:213], v225 offset:4096
    ds_read_b64_tr_b16 v[214:215], v225 offset:5120
    s_waitcnt lgkmcnt(4)
    v_mfma_f32_32x32x16_bf16 v[160:175], v[200:203], v[20:23], v[160:175]
    ds_read_b64_tr_b16 v[192:193], v224 offset:6144
    ds_read_b64_tr_b16 v[194:195], v224 offset:7168
    v_mfma_f32_32x32x16_bf16 v[176:191], v[204:207], v[20:23], v[176:191]
    ds_read_b64_tr_b16 v[196:197], v225 offset:6144
    ds_read_b64_tr_b16 v[198:199], v225 offset:7168
    s_waitcnt lgkmcnt(4)
    v_mfma_f32_32x32x16_bf16 v[160:175], v[208:211], v[24:27], v[160:175]
    ds_read_b64_tr_b16 v[200:201], v224 offset:8192
    ds_read_b64_tr_b16 v[202:203], v224 offset:9216
    v_mfma_f32_32x32x16_bf16 v[176:191], v[212:215], v[24:27], v[176:191]
    ds_read_b64_tr_b16 v[204:205], v225 offset:8192
    ds_read_b64_tr_b16 v[206:207], v225 offset:9216
    s_waitcnt lgkmcnt(4)
    v_mfma_f32_32x32x16_bf16 v[160:175], v[192:195], v[28:31], v[160:175]
    ds_read_b64_tr_b16 v[208:209], v224 offset:10240
    ds_read_b64_tr_b16 v[210:211], v224 offset:11264
    v_mfma_f32_32x32x16_bf16 v[176:191], v[196:199], v[28:31], v[176:191]
    ds_read_b64_tr_b16 v[212:213], v225 offset:10240
    ds_read_b64_tr_b16 v[214:215], v225 offset:11264
    s_waitcnt lgkmcnt(4)
    v_mfma_f32_32x32x16_bf16 v[160:175], v[200:203], v[32:35], v[160:175]
    ds_read_b64_tr_b16 v[192:193], v224 offset:12288
    ds_read_b64_tr_b16 v[194:195], v224 offset:13312
    v_mfma_f32_32x32x16_bf16 v[176:191], v[204:207], v[32:35], v[176:191]
    ds_read_b64_tr_b16 v[196:197], v225 offset:12288
    ds_read_b64_tr_b16 v[198:199], v225 offset:13312
    s_waitcnt lgkmcnt(4)
    v_mfma_f32_32x32x16_bf16 v[160:175], v[208:211], v[36:39], v[160:175]
    ds_read_b64_tr_b16 v[200:201], v224 offset:14336
    ds_read_b64_tr_b16 v[202:203], v224 offset:15360
    v_mfma_f32_32x32x16_bf16 v[176:191], v[212:215], v[36:39], v[176:191]
    ds_read_b64_tr_b16 v[204:205], v225 offset:14336
    ds_read_b64_tr_b16 v[206:207], v225 offset:15360
    s_waitcnt lgkmcnt(4)
    v_mfma_f32_32x32x16_bf16 v[160:175], v[192:195], v[40:43], v[160:175]
    ds_read_b64_tr_b16 v[208:209], v224 offset:16384
    ds_read_b64_tr_b16 v[210:211], v224 offset:17408
    v_mfma_f32_32x32x16_bf16 v[176:191], v[196:199], v[40:43], v[176:191]
    ds_read_b64_tr_b16 v[212:213], v225 offset:16384
    ds_read_b64_tr_b16 v[214:215], v225 offset:17408
    s_waitcnt lgkmcnt(4)
    v_mfma_f32_32x32x16_bf16 v[160:175], v[200:203], v[44:47], v[160:175]
    ds_read_b64_tr_b16 v[192:193], v224 offset:18432
    ds_read_b64_tr_b16 v[194:195], v224 offset:19456
    v_mfma_f32_32x32x16_bf16 v[176:191], v[204:207], v[44:47], v[176:191]
    ds_read_b64_tr_b16 v[196:197], v225 offset:18432
    ds_read_b64_tr_b16 v[198:199], v225 offset:19456
    s_waitcnt lgkmcnt(4)
    v_mfma_f32_32x32x16_bf16 v[160:175], v[208:211], v[48:51], v[160:175]
    ds_read_b64_tr_b16 v[200:201], v224 offset:20480
    ds_read_b64_tr_b16 v[202:203], v224 offset:21504
    v_mfma_f32_32x32x16_bf16 v[176:191], v[212:215], v[48:51], v[176:191]
    ds_read_b64_tr_b16 v[204:205], v225 offset:20480
    ds_read_b64_tr_b16 v[206:207], v225 offset:21504
    s_waitcnt lgkmcnt(4)
    v_mfma_f32_32x32x16_bf16 v[160:175], v[192:195], v[52:55], v[160:175]
    ds_read_b64_tr_b16 v[208:209], v224 offset:22528
    ds_read_b64_tr_b16 v[210:211], v224 offset:23552
    v_mfma_f32_32x32x16_bf16 v[176:191], v[196:199], v[52:55], v[176:191]
    ds_read_b64_tr_b16 v[212:213], v225 offset:22528
    ds_read_b64_tr_b16 v[214:215], v225 offset:23552
    s_waitcnt lgkmcnt(4)
    v_mfma_f32_32x32x16_bf16 v[160:175], v[200:203], v[56:59], v[160:175]
    ds_read_b64_tr_b16 v[192:193], v224 offset:24576
    ds_read_b64_tr_b16 v[194:195], v224 offset:25600
    v_mfma_f32_32x32x16_bf16 v[176:191], v[204:207], v[56:59], v[176:191]
    ds_read_b64_tr_b16 v[196:197], v225 offset:24576
    ds_read_b64_tr_b16 v[198:199], v225 offset:25600
    s_waitcnt lgkmcnt(4)
    v_mfma_f32_32x32x16_bf16 v[160:175], v[208:211], v[60:63], v[160:175]
    ds_read_b64_tr_b16 v[200:201], v224 offset:26624
    ds_read_b64_tr_b16 v[202:203], v224 offset:27648
    v_mfma_f32_32x32x16_bf16 v[176:191], v[212:215], v[60:63], v[176:191]
    ds_read_b64_tr_b16 v[204:205], v225 offset:26624
    ds_read_b64_tr_b16 v[206:207], v225 offset:27648
    s_waitcnt lgkmcnt(4)
    v_mfma_f32_32x32x16_bf16 v[160:175], v[192:195], v[64:67], v[160:175]
    ds_read_b64_tr_b16 v[208:209], v224 offset:28672
    ds_read_b64_tr_b16 v[210:211], v224 offset:29696
    v_mfma_f32_32x32x16_bf16 v[176:191], v[196:199], v[64:67], v[176:191]
    ds_read_b64_tr_b16 v[212:213], v225 offset:28672
    ds_read_b64_tr_b16 v[214:215], v225 offset:29696
    s_waitcnt lgkmcnt(4)
    v_mfma_f32_32x32x16_bf16 v[160:175], v[200:203], v[68:71], v[160:175]
    ds_read_b64_tr_b16 v[192:193], v224 offset:30720
    ds_read_b64_tr_b16 v[194:195], v224 offset:31744
    v_mfma_f32_32x32x16_bf16 v[176:191], v[204:207], v[68:71], v[176:191]
    ds_read_b64_tr_b16 v[196:197], v225 offset:30720
    ds_read_b64_tr_b16 v[198:199], v225 offset:31744
    s_waitcnt lgkmcnt(4)
    v_mfma_f32_32x32x16_bf16 v[160:175], v[208:211], v[72:75], v[160:175]
    ds_read_b64_tr_b16 v[200:201], v224 offset:32768
    ds_read_b64_tr_b16 v[202:203], v224 offset:33792
    v_mfma_f32_32x32x16_bf16 v[176:191], v[212:215], v[72:75], v[176:191]
    ds_read_b64_tr_b16 v[204:205], v225 offset:32768
    ds_read_b64_tr_b16 v[206:207], v225 offset:33792
    s_waitcnt lgkmcnt(4)
    v_mfma_f32_32x32x16_bf16 v[160:175], v[192:195], v[76:79], v[160:175]
    ds_read_b64_tr_b16 v[208:209], v224 offset:34816
    ds_read_b64_tr_b16 v[210:211], v224 offset:35840
    v_mfma_f32_32x32x16_bf16 v[176:191], v[196:199], v[76:79], v[176:191]
    ds_read_b64_tr_b16 v[212:213], v225 offset:34816
    ds_read_b64_tr_b16 v[214:215], v225 offset:35840
    s_waitcnt lgkmcnt(4)
    v_mfma_f32_32x32x16_bf16 v[160:175], v[200:203], v[80:83], v[160:175]
    ds_read_b64_tr_b16 v[192:193], v224 offset:36864
    ds_read_b64_tr_b16 v[194:195], v224 offset:37888
    v_mfma_f32_32x32x16_bf16 v[176:191], v[204:207], v[80:83], v[176:191]
    ds_read_b64_tr_b16 v[196:197], v225 offset:36864
    ds_read_b64_tr_b16 v[198:199], v225 offset:37888
    s_waitcnt lgkmcnt(4)
    v_mfma_f32_32x32x16_bf16 v[160:175], v[208:211], v[84:87], v[160:175]
    ds_read_b64_tr_b16 v[200:201], v224 offset:38912
    ds_read_b64_tr_b16 v[202:203], v224 offset:39936
    v_mfma_f32_32x32x16_bf16 v[176:191], v[212:215], v[84:87], v[176:191]
    ds_read_b64_tr_b16 v[204:205], v225 offset:38912
    ds_read_b64_tr_b16 v[206:207], v225 offset:39936
    s_waitcnt lgkmcnt(4)
    v_mfma_f32_32x32x16_bf16 v[160:175], v[192:195], v[88:91], v[160:175]
    ds_read_b64_tr_b16 v[208:209], v224 offset:40960
    ds_read_b64_tr_b16 v[210:211], v224 offset:41984
    v_mfma_f32_32x32x16_bf16 v[176:191], v[196:199], v[88:91], v[176:191]
    ds_read_b64_tr_b16 v[212:213], v225 offset:40960
    ds_read_b64_tr_b16 v[214:215], v225 offset:41984
    s_waitcnt lgkmcnt(4)
    v_mfma_f32_32x32x16_bf16 v[160:175], v[200:203], v[92:95], v[160:175]
    ds_read_b64_tr_b16 v[192:193], v224 offset:43008
    ds_read_b64_tr_b16 v[194:195], v224 offset:44032
    v_mfma_f32_32x32x16_bf16 v[176:191], v[204:207], v[92:95], v[176:191]
    ds_read_b64_tr_b16 v[196:197], v225 offset:43008
    ds_read_b64_tr_b16 v[198:199], v225 offset:44032
    s_waitcnt lgkmcnt(4)
    v_mfma_f32_32x32x16_bf16 v[160:175], v[208:211], v[96:99], v[160:175]
    ds_read_b64_tr_b16 v[200:201], v224 offset:45056
    ds_read_b64_tr_b16 v[202:203], v224 offset:46080
    v_mfma_f32_32x32x16_bf16 v[176:191], v[212:215], v[96:99], v[176:191]
    ds_read_b64_tr_b16 v[204:205], v225 offset:45056
    ds_read_b64_tr_b16 v[206:207], v225 offset:46080
    s_waitcnt lgkmcnt(4)
    v_mfma_f32_32x32x16_bf16 v[160:175], v[192:195], v[100:103], v[160:175]
    ds_read_b64_tr_b16 v[208:209], v224 offset:47104
    ds_read_b64_tr_b16 v[210:211], v224 offset:48128
    v_mfma_f32_32x32x16_bf16 v[176:191], v[196:199], v[100:103], v[176:191]
    ds_read_b64_tr_b16 v[212:213], v225 offset:47104
    ds_read_b64_tr_b16 v[214:215], v225 offset:48128
    s_waitcnt lgkmcnt(4)
    v_mfma_f32_32x32x16_bf16 v[160:175], v[200:203], v[104:107], v[160:175]
    ds_read_b64_tr_b16 v[192:193], v224 offset:49152
    ds_read_b64_tr_b16 v[194:195], v224 offset:50176
    v_mfma_f32_32x32x16_bf16 v[176:191], v[204:207], v[104:107], v[176:191]
    ds_read_b64_tr_b16 v[196:197], v225 offset:49152
    ds_read_b64_tr_b16 v[198:199], v225 offset:50176
    s_waitcnt lgkmcnt(4)
    v_mfma_f32_32x32x16_bf16 v[160:175], v[208:211], v[108:111], v[160:175]
    ds_read_b64_tr_b16 v[200:201], v224 offset:51200
    ds_read_b64_tr_b16 v[202:203], v224 offset:52224
    v_mfma_f32_32x32x16_bf16 v[176:191], v[212:215], v[108:111], v[176:191]
    ds_read_b64_tr_b16 v[204:205], v225 offset:51200
    ds_read_b64_tr_b16 v[206:207], v225 offset:52224
    s_waitcnt lgkmcnt(4)
    v_mfma_f32_32x32x16_bf16 v[160:175], v[192:195], v[112:115], v[160:175]
    ds_read_b64_tr_b16 v[208:209], v224 offset:53248
    ds_read_b64_tr_b16 v[210:211], v224 offset:54272
    v_mfma_f32_32x32x16_bf16 v[176:191], v[196:199], v[112:115], v[176:191]
    ds_read_b64_tr_b16 v[212:213], v225 offset:53248
    ds_read_b64_tr_b16 v[214:215], v225 offset:54272
    s_waitcnt lgkmcnt(4)
    v_mfma_f32_32x32x16_bf16 v[160:175], v[200:203], v[116:119], v[160:175]
    ds_read_b64_tr_b16 v[192:193], v224 offset:55296
    ds_read_b64_tr_b16 v[194:195], v224 offset:56320
    v_mfma_f32_32x32x16_bf16 v[176:191], v[204:207], v[116:119], v[176:191]
    ds_read_b64_tr_b16 v[196:197], v225 offset:55296
    ds_read_b64_tr_b16 v[198:199], v225 offset:56320
    s_waitcnt lgkmcnt(4)
    v_mfma_f32_32x32x16_bf16 v[160:175], v[208:211], v[120:123], v[160:175]
    v_mfma_f32_32x32x16_bf16 v[176:191], v[212:215], v[120:123], v[176:191]
    s_waitcnt lgkmcnt(0)
    v_mfma_f32_32x32x16_bf16 v[160:175], v[192:195], v[124:127], v[160:175]
    v_mfma_f32_32x32x16_bf16 v[176:191], v[196:199], v[124:127], v[176:191]
    s_mul_i32 s40, s19, 262144
    s_add_u32 s40, s40, 38797312
    s_mul_i32 s41, s16, 14336
    s_add_u32 s40, s40, s41
    s_lshl_b32 s41, s3, 8
    s_add_u32 s40, s40, s41
    s_add_u32 s41, s40, 4096
    v_lshrrev_b32 v2, 5, v1
    v_mul_u32_u24 v2, 7168, v2
    v_and_b32 v3, 31, v1
    v_lshlrev_b32 v3, 3, v3
    v_add_u32 v2, v2, v3
    buffer_load_dwordx2 v[48:49], v2, s[8:11], s40 offen offset:0 sc1
    buffer_load_dwordx2 v[50:51], v2, s[8:11], s40 offen offset:1024 sc1
    buffer_load_dwordx2 v[52:53], v2, s[8:11], s40 offen offset:2048 sc1
    buffer_load_dwordx2 v[54:55], v2, s[8:11], s40 offen offset:3072 sc1
    buffer_load_dwordx2 v[56:57], v2, s[8:11], s41 offen offset:0 sc1
    buffer_load_dwordx2 v[58:59], v2, s[8:11], s41 offen offset:1024 sc1
    buffer_load_dwordx2 v[60:61], v2, s[8:11], s41 offen offset:2048 sc1
    s_barrier
    ds_read_b128 v[16:19], v216 offset:256
    ds_read_b128 v[20:23], v216 offset:288
    ds_read_b128 v[24:27], v216 offset:320
    ds_read_b128 v[28:31], v216 offset:352
    ds_read_b128 v[32:35], v216 offset:384
    ds_read_b128 v[36:39], v216 offset:416
    ds_read_b128 v[40:43], v216 offset:448
    ds_read_b128 v[44:47], v216 offset:480
    s_waitcnt lgkmcnt(4)
    v_pk_mul_f32 v[16:17], v[16:17], v[10:11] op_sel_hi:[1,0]
    v_pk_mul_f32 v[18:19], v[18:19], v[10:11] op_sel_hi:[1,0]
    v_pk_mul_f32 v[20:21], v[20:21], v[10:11] op_sel_hi:[1,0]
    v_pk_mul_f32 v[22:23], v[22:23], v[10:11] op_sel_hi:[1,0]
    v_pk_mul_f32 v[24:25], v[24:25], v[10:11] op_sel_hi:[1,0]
    v_pk_mul_f32 v[26:27], v[26:27], v[10:11] op_sel_hi:[1,0]
    v_pk_mul_f32 v[28:29], v[28:29], v[10:11] op_sel_hi:[1,0]
    v_pk_mul_f32 v[30:31], v[30:31], v[10:11] op_sel_hi:[1,0]
    v_pk_fma_f32 v[160:161], v[160:161], v[222:223], v[16:17] op_sel_hi:[1,0,1] neg_lo:[0,0,1] neg_hi:[0,0,1]
    v_pk_fma_f32 v[162:163], v[162:163], v[222:223], v[18:19] op_sel_hi:[1,0,1] neg_lo:[0,0,1] neg_hi:[0,0,1]
    v_pk_fma_f32 v[164:165], v[164:165], v[222:223], v[20:21] op_sel_hi:[1,0,1] neg_lo:[0,0,1] neg_hi:[0,0,1]
    v_pk_fma_f32 v[166:167], v[166:167], v[222:223], v[22:23] op_sel_hi:[1,0,1] neg_lo:[0,0,1] neg_hi:[0,0,1]
    v_pk_fma_f32 v[168:169], v[168:169], v[222:223], v[24:25] op_sel_hi:[1,0,1] neg_lo:[0,0,1] neg_hi:[0,0,1]
    v_pk_fma_f32 v[170:171], v[170:171], v[222:223], v[26:27] op_sel_hi:[1,0,1] neg_lo:[0,0,1] neg_hi:[0,0,1]
    v_pk_fma_f32 v[172:173], v[172:173], v[222:223], v[28:29] op_sel_hi:[1,0,1] neg_lo:[0,0,1] neg_hi:[0,0,1]
    v_pk_fma_f32 v[174:175], v[174:175], v[222:223], v[30:31] op_sel_hi:[1,0,1] neg_lo:[0,0,1] neg_hi:[0,0,1]
    v_pk_mul_f32 v[16:17], v[160:161], v[160:161]
    v_pk_mul_f32 v[18:19], v[162:163], v[162:163]
    v_pk_mul_f32 v[20:21], v[164:165], v[164:165]
    v_pk_mul_f32 v[22:23], v[166:167], v[166:167]
    v_pk_mul_f32 v[24:25], v[168:169], v[168:169]
    v_pk_mul_f32 v[26:27], v[170:171], v[170:171]
    v_pk_mul_f32 v[28:29], v[172:173], v[172:173]
    v_pk_mul_f32 v[30:31], v[174:175], v[174:175]
    v_pk_fma_f32 v[16:17], v[16:17], v[12:13], v[4:5] op_sel_hi:[1,0,0]
    v_pk_fma_f32 v[18:19], v[18:19], v[12:13], v[4:5] op_sel_hi:[1,0,0]
    v_pk_fma_f32 v[20:21], v[20:21], v[12:13], v[4:5] op_sel_hi:[1,0,0]
    v_pk_fma_f32 v[22:23], v[22:23], v[12:13], v[4:5] op_sel_hi:[1,0,0]
    v_pk_fma_f32 v[24:25], v[24:25], v[12:13], v[4:5] op_sel_hi:[1,0,0]
    v_pk_fma_f32 v[26:27], v[26:27], v[12:13], v[4:5] op_sel_hi:[1,0,0]
    v_pk_fma_f32 v[28:29], v[28:29], v[12:13], v[4:5] op_sel_hi:[1,0,0]
    v_pk_fma_f32 v[30:31], v[30:31], v[12:13], v[4:5] op_sel_hi:[1,0,0]
    v_pk_mul_f32 v[16:17], v[160:161], v[16:17]
    v_pk_mul_f32 v[18:19], v[162:163], v[18:19]
    v_pk_mul_f32 v[20:21], v[164:165], v[20:21]
    v_pk_mul_f32 v[22:23], v[166:167], v[22:23]
    v_pk_mul_f32 v[24:25], v[168:169], v[24:25]
    v_pk_mul_f32 v[26:27], v[170:171], v[26:27]
    v_pk_mul_f32 v[28:29], v[172:173], v[28:29]
    v_pk_mul_f32 v[30:31], v[174:175], v[30:31]
    v_exp_f32 v16, v16
    v_exp_f32 v17, v17
    v_exp_f32 v18, v18
    v_exp_f32 v19, v19
    v_exp_f32 v20, v20
    v_exp_f32 v21, v21
    v_exp_f32 v22, v22
    v_exp_f32 v23, v23
    v_exp_f32 v24, v24
    v_exp_f32 v25, v25
    v_exp_f32 v26, v26
    v_exp_f32 v27, v27
    v_exp_f32 v28, v28
    v_exp_f32 v29, v29
    v_exp_f32 v30, v30
    v_exp_f32 v31, v31
    v_pk_add_f32 v[16:17], v[16:17], v[14:15] op_sel_hi:[1,0]
    v_pk_add_f32 v[18:19], v[18:19], v[14:15] op_sel_hi:[1,0]
    v_pk_add_f32 v[20:21], v[20:21], v[14:15] op_sel_hi:[1,0]
    v_pk_add_f32 v[22:23], v[22:23], v[14:15] op_sel_hi:[1,0]
    v_pk_add_f32 v[24:25], v[24:25], v[14:15] op_sel_hi:[1,0]
    v_pk_add_f32 v[26:27], v[26:27], v[14:15] op_sel_hi:[1,0]
    v_pk_add_f32 v[28:29], v[28:29], v[14:15] op_sel_hi:[1,0]
    v_pk_add_f32 v[30:31], v[30:31], v[14:15] op_sel_hi:[1,0]
    v_rcp_f32 v16, v16
    v_rcp_f32 v17, v17
    v_rcp_f32 v18, v18
    v_rcp_f32 v19, v19
    v_rcp_f32 v20, v20
    v_rcp_f32 v21, v21
    v_rcp_f32 v22, v22
    v_rcp_f32 v23, v23
    v_rcp_f32 v24, v24
    v_rcp_f32 v25, v25
    v_rcp_f32 v26, v26
    v_rcp_f32 v27, v27
    v_rcp_f32 v28, v28
    v_rcp_f32 v29, v29
    v_rcp_f32 v30, v30
    v_rcp_f32 v31, v31
    v_pk_mul_f32 v[160:161], v[160:161], v[16:17]
    v_pk_mul_f32 v[162:163], v[162:163], v[18:19]
    v_pk_mul_f32 v[164:165], v[164:165], v[20:21]
    v_pk_mul_f32 v[166:167], v[166:167], v[22:23]
    v_pk_mul_f32 v[168:169], v[168:169], v[24:25]
    v_pk_mul_f32 v[170:171], v[170:171], v[26:27]
    v_pk_mul_f32 v[172:173], v[172:173], v[28:29]
    v_pk_mul_f32 v[174:175], v[174:175], v[30:31]
    v_cvt_pk_bf16_f32 v240, v160, v161
    v_cvt_pk_bf16_f32 v241, v162, v163
    v_cvt_pk_bf16_f32 v242, v164, v165
    v_cvt_pk_bf16_f32 v243, v166, v167
    v_cvt_pk_bf16_f32 v244, v168, v169
    v_cvt_pk_bf16_f32 v245, v170, v171
    v_cvt_pk_bf16_f32 v246, v172, v173
    v_cvt_pk_bf16_f32 v247, v174, v175
    s_waitcnt lgkmcnt(0)
    v_pk_mul_f32 v[32:33], v[32:33], v[10:11] op_sel_hi:[1,0]
    v_pk_mul_f32 v[34:35], v[34:35], v[10:11] op_sel_hi:[1,0]
    v_pk_mul_f32 v[36:37], v[36:37], v[10:11] op_sel_hi:[1,0]
    v_pk_mul_f32 v[38:39], v[38:39], v[10:11] op_sel_hi:[1,0]
    v_pk_mul_f32 v[40:41], v[40:41], v[10:11] op_sel_hi:[1,0]
    v_pk_mul_f32 v[42:43], v[42:43], v[10:11] op_sel_hi:[1,0]
    v_pk_mul_f32 v[44:45], v[44:45], v[10:11] op_sel_hi:[1,0]
    v_pk_mul_f32 v[46:47], v[46:47], v[10:11] op_sel_hi:[1,0]
    v_pk_fma_f32 v[176:177], v[176:177], v[222:223], v[32:33] op_sel_hi:[1,0,1] neg_lo:[0,0,1] neg_hi:[0,0,1]
    v_pk_fma_f32 v[178:179], v[178:179], v[222:223], v[34:35] op_sel_hi:[1,0,1] neg_lo:[0,0,1] neg_hi:[0,0,1]
    v_pk_fma_f32 v[180:181], v[180:181], v[222:223], v[36:37] op_sel_hi:[1,0,1] neg_lo:[0,0,1] neg_hi:[0,0,1]
    v_pk_fma_f32 v[182:183], v[182:183], v[222:223], v[38:39] op_sel_hi:[1,0,1] neg_lo:[0,0,1] neg_hi:[0,0,1]
    v_pk_fma_f32 v[184:185], v[184:185], v[222:223], v[40:41] op_sel_hi:[1,0,1] neg_lo:[0,0,1] neg_hi:[0,0,1]
    v_pk_fma_f32 v[186:187], v[186:187], v[222:223], v[42:43] op_sel_hi:[1,0,1] neg_lo:[0,0,1] neg_hi:[0,0,1]
    v_pk_fma_f32 v[188:189], v[188:189], v[222:223], v[44:45] op_sel_hi:[1,0,1] neg_lo:[0,0,1] neg_hi:[0,0,1]
    v_pk_fma_f32 v[190:191], v[190:191], v[222:223], v[46:47] op_sel_hi:[1,0,1] neg_lo:[0,0,1] neg_hi:[0,0,1]
    v_pk_mul_f32 v[32:33], v[176:177], v[176:177]
    v_pk_mul_f32 v[34:35], v[178:179], v[178:179]
    v_pk_mul_f32 v[36:37], v[180:181], v[180:181]
    v_pk_mul_f32 v[38:39], v[182:183], v[182:183]
    v_pk_mul_f32 v[40:41], v[184:185], v[184:185]
    v_pk_mul_f32 v[42:43], v[186:187], v[186:187]
    v_pk_mul_f32 v[44:45], v[188:189], v[188:189]
    v_pk_mul_f32 v[46:47], v[190:191], v[190:191]
    v_pk_fma_f32 v[32:33], v[32:33], v[12:13], v[4:5] op_sel_hi:[1,0,0]
    v_pk_fma_f32 v[34:35], v[34:35], v[12:13], v[4:5] op_sel_hi:[1,0,0]
    v_pk_fma_f32 v[36:37], v[36:37], v[12:13], v[4:5] op_sel_hi:[1,0,0]
    v_pk_fma_f32 v[38:39], v[38:39], v[12:13], v[4:5] op_sel_hi:[1,0,0]
    v_pk_fma_f32 v[40:41], v[40:41], v[12:13], v[4:5] op_sel_hi:[1,0,0]
    v_pk_fma_f32 v[42:43], v[42:43], v[12:13], v[4:5] op_sel_hi:[1,0,0]
    v_pk_fma_f32 v[44:45], v[44:45], v[12:13], v[4:5] op_sel_hi:[1,0,0]
    v_pk_fma_f32 v[46:47], v[46:47], v[12:13], v[4:5] op_sel_hi:[1,0,0]
    v_pk_mul_f32 v[32:33], v[176:177], v[32:33]
    v_pk_mul_f32 v[34:35], v[178:179], v[34:35]
    v_pk_mul_f32 v[36:37], v[180:181], v[36:37]
    v_pk_mul_f32 v[38:39], v[182:183], v[38:39]
    v_pk_mul_f32 v[40:41], v[184:185], v[40:41]
    v_pk_mul_f32 v[42:43], v[186:187], v[42:43]
    v_pk_mul_f32 v[44:45], v[188:189], v[44:45]
    v_pk_mul_f32 v[46:47], v[190:191], v[46:47]
    v_exp_f32 v32, v32
    v_exp_f32 v33, v33
    v_exp_f32 v34, v34
    v_exp_f32 v35, v35
    v_exp_f32 v36, v36
    v_exp_f32 v37, v37
    v_exp_f32 v38, v38
    v_exp_f32 v39, v39
    v_exp_f32 v40, v40
    v_exp_f32 v41, v41
    v_exp_f32 v42, v42
    v_exp_f32 v43, v43
    v_exp_f32 v44, v44
    v_exp_f32 v45, v45
    v_exp_f32 v46, v46
    v_exp_f32 v47, v47
    v_pk_add_f32 v[32:33], v[32:33], v[14:15] op_sel_hi:[1,0]
    v_pk_add_f32 v[34:35], v[34:35], v[14:15] op_sel_hi:[1,0]
    v_pk_add_f32 v[36:37], v[36:37], v[14:15] op_sel_hi:[1,0]
    v_pk_add_f32 v[38:39], v[38:39], v[14:15] op_sel_hi:[1,0]
    v_pk_add_f32 v[40:41], v[40:41], v[14:15] op_sel_hi:[1,0]
    v_pk_add_f32 v[42:43], v[42:43], v[14:15] op_sel_hi:[1,0]
    v_pk_add_f32 v[44:45], v[44:45], v[14:15] op_sel_hi:[1,0]
    v_pk_add_f32 v[46:47], v[46:47], v[14:15] op_sel_hi:[1,0]
    v_rcp_f32 v32, v32
    v_rcp_f32 v33, v33
    v_rcp_f32 v34, v34
    v_rcp_f32 v35, v35
    v_rcp_f32 v36, v36
    v_rcp_f32 v37, v37
    v_rcp_f32 v38, v38
    v_rcp_f32 v39, v39
    v_rcp_f32 v40, v40
    v_rcp_f32 v41, v41
    v_rcp_f32 v42, v42
    v_rcp_f32 v43, v43
    v_rcp_f32 v44, v44
    v_rcp_f32 v45, v45
    v_rcp_f32 v46, v46
    v_rcp_f32 v47, v47
    v_pk_mul_f32 v[176:177], v[176:177], v[32:33]
    v_pk_mul_f32 v[178:179], v[178:179], v[34:35]
    v_pk_mul_f32 v[180:181], v[180:181], v[36:37]
    v_pk_mul_f32 v[182:183], v[182:183], v[38:39]
    v_pk_mul_f32 v[184:185], v[184:185], v[40:41]
    v_pk_mul_f32 v[186:187], v[186:187], v[42:43]
    v_pk_mul_f32 v[188:189], v[188:189], v[44:45]
    v_pk_mul_f32 v[190:191], v[190:191], v[46:47]
    v_cvt_pk_bf16_f32 v248, v176, v177
    v_cvt_pk_bf16_f32 v249, v178, v179
    v_cvt_pk_bf16_f32 v250, v180, v181
    v_cvt_pk_bf16_f32 v251, v182, v183
    v_cvt_pk_bf16_f32 v252, v184, v185
    v_cvt_pk_bf16_f32 v253, v186, v187
    v_cvt_pk_bf16_f32 v254, v188, v189
    v_cvt_pk_bf16_f32 v255, v190, v191
    v_add_u32 v3, 143360, v0
    ds_read_b128 v[228:231], v3
    ds_read_b128 v[232:235], v3 offset:1024
    s_mov_b32 s59, s36
L_stpoll_48:
    s_waitcnt vmcnt(0)
    v_and_b32 v3, v49, v51
    v_and_b32 v3, v3, v53
    v_and_b32 v3, v3, v55
    v_and_b32 v3, v3, v57
    v_and_b32 v3, v3, v59
    v_and_b32 v3, v3, v61
    v_cmp_le_i32 vcc, 0, v3
    s_cbranch_vccz L_stpolld_49
    buffer_load_dwordx2 v[48:49], v2, s[8:11], s40 offen offset:0 sc1
    buffer_load_dwordx2 v[50:51], v2, s[8:11], s40 offen offset:1024 sc1
    buffer_load_dwordx2 v[52:53], v2, s[8:11], s40 offen offset:2048 sc1
    buffer_load_dwordx2 v[54:55], v2, s[8:11], s40 offen offset:3072 sc1
    buffer_load_dwordx2 v[56:57], v2, s[8:11], s41 offen offset:0 sc1
    buffer_load_dwordx2 v[58:59], v2, s[8:11], s41 offen offset:1024 sc1
    buffer_load_dwordx2 v[60:61], v2, s[8:11], s41 offen offset:2048 sc1
    s_sub_u32 s59, s59, 1
    s_cmp_lg_u32 s59, 0
    s_cbranch_scc1 L_stpoll_48
    s_mov_b32 s36, 1
    s_waitcnt vmcnt(0)
L_stpolld_49:
    v_and_b32 v49, 0x7fffffff, v49
    v_and_b32 v51, 0x7fffffff, v51
    v_and_b32 v53, 0x7fffffff, v53
    v_and_b32 v55, 0x7fffffff, v55
    v_and_b32 v57, 0x7fffffff, v57
    v_and_b32 v59, 0x7fffffff, v59
    v_and_b32 v61, 0x7fffffff, v61
    v_add_f32 v48, v48, v50
    v_add_f32 v49, v49, v51
    v_add_f32 v48, v48, v52
    v_add_f32 v49, v49, v53
    v_add_f32 v48, v48, v54
    v_add_f32 v49, v49, v55
    v_add_f32 v48, v48, v56
    v_add_f32 v49, v49, v57
    v_add_f32 v48, v48, v58
    v_add_f32 v49, v49, v59
    v_add_f32 v48, v48, v60
    v_add_f32 v49, v49, v61
    v_mov_b32 v50, v48
    v_mov_b32 v51, v49
    s_nop 0
    v_permlane32_swap_b32 v48, v50
    v_permlane32_swap_b32 v49, v51
    s_nop 0
    v_add_f32 v48, v48, v50
    v_add_f32 v49, v49, v51
    v_mul_f32 v48, 0x3a924925, v48
    v_mul_f32 v49, 0x3a924925, v49
    v_fma_f32 v49, -v48, v48, v49
    v_max_f32 v49, 0, v49
    v_add_f32 v49, 0x3727c5ac, v49
    v_rsq_f32 v222, v49
    s_nop 0
    v_mul_f32 v10, v48, v222
    v_pk_fma_f32 v[128:129], v[128:129], v[222:223], v[10:11] op_sel_hi:[1,0,0] neg_lo:[0,0,1] neg_hi:[0,0,1]
    v_pk_fma_f32 v[130:131], v[130:131], v[222:223], v[10:11] op_sel_hi:[1,0,0] neg_lo:[0,0,1] neg_hi:[0,0,1]
    v_pk_fma_f32 v[132:133], v[132:133], v[222:223], v[10:11] op_sel_hi:[1,0,0] neg_lo:[0,0,1] neg_hi:[0,0,1]
    v_pk_fma_f32 v[134:135], v[134:135], v[222:223], v[10:11] op_sel_hi:[1,0,0] neg_lo:[0,0,1] neg_hi:[0,0,1]
    v_pk_fma_f32 v[136:137], v[136:137], v[222:223], v[10:11] op_sel_hi:[1,0,0] neg_lo:[0,0,1] neg_hi:[0,0,1]
    v_pk_fma_f32 v[138:139], v[138:139], v[222:223], v[10:11] op_sel_hi:[1,0,0] neg_lo:[0,0,1] neg_hi:[0,0,1]
    v_pk_fma_f32 v[140:141], v[140:141], v[222:223], v[10:11] op_sel_hi:[1,0,0] neg_lo:[0,0,1] neg_hi:[0,0,1]
    v_pk_fma_f32 v[142:143], v[142:143], v[222:223], v[10:11] op_sel_hi:[1,0,0] neg_lo:[0,0,1] neg_hi:[0,0,1]
    v_pk_fma_f32 v[144:145], v[144:145], v[222:223], v[10:11] op_sel_hi:[1,0,0] neg_lo:[0,0,1] neg_hi:[0,0,1]
    v_pk_fma_f32 v[146:147], v[146:147], v[222:223], v[10:11] op_sel_hi:[1,0,0] neg_lo:[0,0,1] neg_hi:[0,0,1]
    v_pk_fma_f32 v[148:149], v[148:149], v[222:223], v[10:11] op_sel_hi:[1,0,0] neg_lo:[0,0,1] neg_hi:[0,0,1]
    v_pk_fma_f32 v[150:151], v[150:151], v[222:223], v[10:11] op_sel_hi:[1,0,0] neg_lo:[0,0,1] neg_hi:[0,0,1]
    v_pk_fma_f32 v[152:153], v[152:153], v[222:223], v[10:11] op_sel_hi:[1,0,0] neg_lo:[0,0,1] neg_hi:[0,0,1]
    v_pk_fma_f32 v[154:155], v[154:155], v[222:223], v[10:11] op_sel_hi:[1,0,0] neg_lo:[0,0,1] neg_hi:[0,0,1]
    v_pk_fma_f32 v[156:157], v[156:157], v[222:223], v[10:11] op_sel_hi:[1,0,0] neg_lo:[0,0,1] neg_hi:[0,0,1]
    v_pk_fma_f32 v[158:159], v[158:159], v[222:223], v[10:11] op_sel_hi:[1,0,0] neg_lo:[0,0,1] neg_hi:[0,0,1]
    v_cvt_pk_bf16_f32 v160, v128, v129
    v_cvt_pk_bf16_f32 v161, v130, v131
    v_cvt_pk_bf16_f32 v162, v132, v133
    v_cvt_pk_bf16_f32 v163, v134, v135
    v_cvt_pk_bf16_f32 v164, v136, v137
    v_cvt_pk_bf16_f32 v165, v138, v139
    v_cvt_pk_bf16_f32 v166, v140, v141
    v_cvt_pk_bf16_f32 v167, v142, v143
    v_cvt_pk_bf16_f32 v168, v144, v145
    v_cvt_pk_bf16_f32 v169, v146, v147
    v_cvt_pk_bf16_f32 v170, v148, v149
    v_cvt_pk_bf16_f32 v171, v150, v151
    v_cvt_pk_bf16_f32 v172, v152, v153
    v_cvt_pk_bf16_f32 v173, v154, v155
    v_cvt_pk_bf16_f32 v174, v156, v157
    v_cvt_pk_bf16_f32 v175, v158, v159
    s_waitcnt lgkmcnt(0)
    s_nop 0
    v_mfma_f32_32x32x16_bf16 v[128:143], v[160:163], v[228:231], 0
    v_mfma_f32_32x32x16_bf16 v[128:143], v[164:167], v[232:235], v[128:143]
    v_mfma_f32_32x32x16_bf16 v[144:159], v[168:171], v[228:231], 0
    v_mfma_f32_32x32x16_bf16 v[144:159], v[172:175], v[232:235], v[144:159]
    s_mul_i32 s40, s19, 4194304
    s_add_u32 s40, s40, 22020096
    s_lshl_b32 s41, s17, 18
    s_add_u32 s40, s40, s41
    s_lshl_b32 s41, s50, 11
    s_add_u32 s40, s40, s41
    s_nop 4
    v_cvt_pk_bf16_f32 v176, v128, v129
    v_cvt_pk_bf16_f32 v177, v130, v131
    v_cvt_pk_bf16_f32 v178, v132, v133
    v_cvt_pk_bf16_f32 v179, v134, v135
    v_cvt_pk_bf16_f32 v180, v136, v137
    v_cvt_pk_bf16_f32 v181, v138, v139
    v_cvt_pk_bf16_f32 v182, v140, v141
    v_cvt_pk_bf16_f32 v183, v142, v143
    buffer_store_dwordx4 v[176:179], v0, s[8:11], s40 offen offset:0 sc1
    buffer_store_dwordx4 v[180:183], v0, s[8:11], s40 offen offset:1024 sc1
    v_cvt_pk_bf16_f32 v184, v144, v145
    v_cvt_pk_bf16_f32 v185, v146, v147
    v_cvt_pk_bf16_f32 v186, v148, v149
    v_cvt_pk_bf16_f32 v187, v150, v151
    v_cvt_pk_bf16_f32 v188, v152, v153
    v_cvt_pk_bf16_f32 v189, v154, v155
    v_cvt_pk_bf16_f32 v190, v156, v157
    v_cvt_pk_bf16_f32 v191, v158, v159
    s_add_u32 s40, s40, 131072
    buffer_store_dwordx4 v[184:187], v0, s[8:11], s40 offen offset:0 sc1
    buffer_store_dwordx4 v[188:191], v0, s[8:11], s40 offen offset:1024 sc1
    s_mul_i32 s57, s19, 32768
    s_add_u32 s57, s57, 262144
    s_lshl_b32 s58, s16, 11
    s_add_u32 s57, s57, s58
    s_lshl_b32 s58, s17, 7
    s_add_u32 s57, s57, s58
    s_lshl_b32 s58, s19, 2
    s_add_u32 s58, s58, 162888
    v_mov_b32 v4, 1
    v_mov_b32 v5, s58
    s_waitcnt vmcnt(0)
    s_mov_b64 exec, 1
    ds_add_rtn_u32 v6, v5, v4
    v_mov_b32 v7, 0
    s_waitcnt lgkmcnt(0)
    v_readfirstlane_b32 s58, v6
    s_nop 0
    s_cmp_eq_u32 s58, 3
    s_cbranch_scc0 L_nosig_50
    buffer_store_dword v4, v7, s[8:11], s57 offen sc1
L_nosig_50:
    s_mov_b64 exec, -1
    s_branch L_win_join_43
L_win_helper_42:
    s_waitcnt lgkmcnt(0)
    s_barrier
    s_cmp_eq_u32 s19, 0
    s_cbranch_scc0 L_win_nocs_51
    s_cmp_lt_u32 s3, 2
    s_cbranch_scc0 L_win_nocs_51
    s_and_b32 s41, s3, 1
    v_lshrrev_b32 v2, 5, v1
    v_lshlrev_b32 v2, 2, v2
    v_bfe_u32 v3, v1, 2, 2
    v_add_u32 v2, v2, v3
    v_mul_u32_u24 v12, 128, v2
    v_bfe_u32 v3, v1, 4, 1
    v_lshlrev_b32 v3, 5, v3
    v_add_u32 v12, v12, v3
    v_and_b32 v3, 3, v1
    v_lshlrev_b32 v3, 3, v3
    v_add_u32 v12, v12, v3
    v_bfe_u32 v3, v1, 3, 1
    v_xor_b32 v3, s41, v3
    v_lshlrev_b32 v3, 6, v3
    v_add_u32 v12, v12, v3
    s_lshr_b32 s41, s3, 1
    s_mul_i32 s41, s41, 57344
    v_add_u32 v12, s41, v12
    s_lshl_b32 s42, s3, 7
    s_add_u32 s42, s42, 162304
    v_mov_b32 v32, 0x3f803f80
    v_mov_b32 v33, 0x3f803f80
    v_mov_b32 v34, 0x3f803f80
    v_mov_b32 v35, 0x3f803f80
    ds_read_b64_tr_b16 v[36:37], v12 offset:0
    ds_read_b64_tr_b16 v[38:39], v12 offset:1024
    ds_read_b64_tr_b16 v[40:41], v12 offset:2048
    ds_read_b64_tr_b16 v[42:43], v12 offset:3072
    ds_read_b64_tr_b16 v[44:45], v12 offset:4096
    ds_read_b64_tr_b16 v[46:47], v12 offset:5120
    s_waitcnt lgkmcnt(4)
    v_mfma_f32_32x32x16_bf16 v[16:31], v[36:39], v[32:35], 0
    ds_read_b64_tr_b16 v[36:37], v12 offset:6144
    ds_read_b64_tr_b16 v[38:39], v12 offset:7168
    s_waitcnt lgkmcnt(4)
    v_mfma_f32_32x32x16_bf16 v[16:31], v[40:43], v[32:35], v[16:31]
    ds_read_b64_tr_b16 v[40:41], v12 offset:8192
    ds_read_b64_tr_b16 v[42:43], v12 offset:9216
    s_waitcnt lgkmcnt(4)
    v_mfma_f32_32x32x16_bf16 v[16:31], v[44:47], v[32:35], v[16:31]
    ds_read_b64_tr_b16 v[44:45], v12 offset:10240
    ds_read_b64_tr_b16 v[46:47], v12 offset:11264
    s_waitcnt lgkmcnt(4)
    v_mfma_f32_32x32x16_bf16 v[16:31], v[36:39], v[32:35], v[16:31]
    ds_read_b64_tr_b16 v[36:37], v12 offset:12288
    ds_read_b64_tr_b16 v[38:39], v12 offset:13312
    s_waitcnt lgkmcnt(4)
    v_mfma_f32_32x32x16_bf16 v[16:31], v[40:43], v[32:35], v[16:31]
    ds_read_b64_tr_b16 v[40:41], v12 offset:14336
    ds_read_b64_tr_b16 v[42:43], v12 offset:15360
    s_waitcnt lgkmcnt(4)
    v_mfma_f32_32x32x16_bf16 v[16:31], v[44:47], v[32:35], v[16:31]
    ds_read_b64_tr_b16 v[44:45], v12 offset:16384
    ds_read_b64_tr_b16 v[46:47], v12 offset:17408
    s_waitcnt lgkmcnt(4)
    v_mfma_f32_32x32x16_bf16 v[16:31], v[36:39], v[32:35], v[16:31]
    ds_read_b64_tr_b16 v[36:37], v12 offset:18432
    ds_read_b64_tr_b16 v[38:39], v12 offset:19456
    s_waitcnt lgkmcnt(4)
    v_mfma_f32_32x32x16_bf16 v[16:31], v[40:43], v[32:35], v[16:31]
    ds_read_b64_tr_b16 v[40:41], v12 offset:20480
    ds_read_b64_tr_b16 v[42:43], v12 offset:21504
    s_waitcnt lgkmcnt(4)
    v_mfma_f32_32x32x16_bf16 v[16:31], v[44:47], v[32:35], v[16:31]
    ds_read_b64_tr_b16 v[44:45], v12 offset:22528
    ds_read_b64_tr_b16 v[46:47], v12 offset:23552
    s_waitcnt lgkmcnt(4)
    v_mfma_f32_32x32x16_bf16 v[16:31], v[36:39], v[32:35], v[16:31]
    ds_read_b64_tr_b16 v[36:37], v12 offset:24576
    ds_read_b64_tr_b16 v[38:39], v12 offset:25600
    s_waitcnt lgkmcnt(4)
    v_mfma_f32_32x32x16_bf16 v[16:31], v[40:43], v[32:35], v[16:31]
    ds_read_b64_tr_b16 v[40:41], v12 offset:26624
    ds_read_b64_tr_b16 v[42:43], v12 offset:27648
    s_waitcnt lgkmcnt(4)
    v_mfma_f32_32x32x16_bf16 v[16:31], v[44:47], v[32:35], v[16:31]
    ds_read_b64_tr_b16 v[44:45], v12 offset:28672
    ds_read_b64_tr_b16 v[46:47], v12 offset:29696
    s_waitcnt lgkmcnt(4)
    v_mfma_f32_32x32x16_bf16 v[16:31], v[36:39], v[32:35], v[16:31]
    ds_read_b64_tr_b16 v[36:37], v12 offset:30720
    ds_read_b64_tr_b16 v[38:39], v12 offset:31744
    s_waitcnt lgkmcnt(4)
    v_mfma_f32_32x32x16_bf16 v[16:31], v[40:43], v[32:35], v[16:31]
    ds_read_b64_tr_b16 v[40:41], v12 offset:32768
    ds_read_b64_tr_b16 v[42:43], v12 offset:33792
    s_waitcnt lgkmcnt(4)
    v_mfma_f32_32x32x16_bf16 v[16:31], v[44:47], v[32:35], v[16:31]
    ds_read_b64_tr_b16 v[44:45], v12 offset:34816
    ds_read_b64_tr_b16 v[46:47], v12 offset:35840
    s_waitcnt lgkmcnt(4)
    v_mfma_f32_32x32x16_bf16 v[16:31], v[36:39], v[32:35], v[16:31]
    ds_read_b64_tr_b16 v[36:37], v12 offset:36864
    ds_read_b64_tr_b16 v[38:39], v12 offset:37888
    s_waitcnt lgkmcnt(4)
    v_mfma_f32_32x32x16_bf16 v[16:31], v[40:43], v[32:35], v[16:31]
    ds_read_b64_tr_b16 v[40:41], v12 offset:38912
    ds_read_b64_tr_b16 v[42:43], v12 offset:39936
    s_waitcnt lgkmcnt(4)
    v_mfma_f32_32x32x16_bf16 v[16:31], v[44:47], v[32:35], v[16:31]
    ds_read_b64_tr_b16 v[44:45], v12 offset:40960
    ds_read_b64_tr_b16 v[46:47], v12 offset:41984
    s_waitcnt lgkmcnt(4)
    v_mfma_f32_32x32x16_bf16 v[16:31], v[36:39], v[32:35], v[16:31]
    ds_read_b64_tr_b16 v[36:37], v12 offset:43008
    ds_read_b64_tr_b16 v[38:39], v12 offset:44032
    s_waitcnt lgkmcnt(4)
    v_mfma_f32_32x32x16_bf16 v[16:31], v[40:43], v[32:35], v[16:31]
    ds_read_b64_tr_b16 v[40:41], v12 offset:45056
    ds_read_b64_tr_b16 v[42:43], v12 offset:46080
    s_waitcnt lgkmcnt(4)
    v_mfma_f32_32x32x16_bf16 v[16:31], v[44:47], v[32:35], v[16:31]
    ds_read_b64_tr_b16 v[44:45], v12 offset:47104
    ds_read_b64_tr_b16 v[46:47], v12 offset:48128
    s_waitcnt lgkmcnt(4)
    v_mfma_f32_32x32x16_bf16 v[16:31], v[36:39], v[32:35], v[16:31]
    ds_read_b64_tr_b16 v[36:37], v12 offset:49152
    ds_read_b64_tr_b16 v[38:39], v12 offset:50176
    s_waitcnt lgkmcnt(4)
    v_mfma_f32_32x32x16_bf16 v[16:31], v[40:43], v[32:35], v[16:31]
    ds_read_b64_tr_b16 v[40:41], v12 offset:51200
    ds_read_b64_tr_b16 v[42:43], v12 offset:52224
    s_waitcnt lgkmcnt(4)
    v_mfma_f32_32x32x16_bf16 v[16:31], v[44:47], v[32:35], v[16:31]
    ds_read_b64_tr_b16 v[44:45], v12 offset:53248
    ds_read_b64_tr_b16 v[46:47], v12 offset:54272
    s_waitcnt lgkmcnt(4)
    v_mfma_f32_32x32x16_bf16 v[16:31], v[36:39], v[32:35], v[16:31]
    ds_read_b64_tr_b16 v[36:37], v12 offset:55296
    ds_read_b64_tr_b16 v[38:39], v12 offset:56320
    s_waitcnt lgkmcnt(4)
    v_mfma_f32_32x32x16_bf16 v[16:31], v[40:43], v[32:35], v[16:31]
    s_waitcnt lgkmcnt(2)
    v_mfma_f32_32x32x16_bf16 v[16:31], v[44:47], v[32:35], v[16:31]
    s_waitcnt lgkmcnt(0)
    v_mfma_f32_32x32x16_bf16 v[16:31], v[36:39], v[32:35], v[16:31]
    v_lshrrev_b32 v11, 5, v1
    v_lshlrev_b32 v11, 4, v11
    v_add_u32 v11, s42, v11
    s_mov_b32 exec_lo, 1
    s_mov_b32 exec_hi, 1
    s_nop 7
    ds_write_b128 v11, v[16:19] offset:0
    ds_write_b128 v11, v[20:23] offset:32
    ds_write_b128 v11, v[24:27] offset:64
    ds_write_b128 v11, v[28:31] offset:96
    s_mov_b64 exec, -1
    s_waitcnt lgkmcnt(0)
L_win_nocs_51:
    s_barrier
    s_lshl_b32 s43, s17, 7
    s_mov_b32 s4, s24
    s_mov_b32 s5, s25
    s_mov_b32 s6, 1605632
    s_mov_b32 s7, 0x20000
    v_lshrrev_b32 v3, 3, v1
    v_mul_u32_u24 v2, 3584, v3
    v_bfe_u32 v3, v1, 4, 1
    v_lshlrev_b32 v3, 2, v3
    v_and_b32 v4, 7, v1
    v_xor_b32 v3, v3, v4
    v_lshlrev_b32 v3, 4, v3
    v_add_u32 v2, v2, v3
    s_mov_b32 s41, s3
    s_mul_i32 s40, s41, 28672
    s_add_u32 s40, s40, s43
    s_lshl_b32 s41, s41, 10
    s_add_u32 m0, s41, 57344
    s_nop 0
    buffer_load_dwordx4 v2, s[4:7], s40 offen lds
    s_add_u32 m0, m0, 4096
    s_add_u32 s40, s40, 114688
    buffer_load_dwordx4 v2, s[4:7], s40 offen lds
    s_add_u32 m0, m0, 4096
    s_add_u32 s40, s40, 114688
    buffer_load_dwordx4 v2, s[4:7], s40 offen lds
    s_add_u32 m0, m0, 4096
    s_add_u32 s40, s40, 114688
    buffer_load_dwordx4 v2, s[4:7], s40 offen lds
    s_add_u32 m0, m0, 4096
    s_add_u32 s40, s40, 114688
    buffer_load_dwordx4 v2, s[4:7], s40 offen lds
    s_add_u32 m0, m0, 4096
    s_add_u32 s40, s40, 114688
    buffer_load_dwordx4 v2, s[4:7], s40 offen lds
    s_add_u32 m0, m0, 4096
    s_add_u32 s40, s40, 114688
    buffer_load_dwordx4 v2, s[4:7], s40 offen lds
    s_add_u32 m0, m0, 4096
    s_add_u32 s40, s40, 114688
    buffer_load_dwordx4 v2, s[4:7], s40 offen lds
    s_add_u32 m0, m0, 4096
    s_add_u32 s40, s40, 114688
    buffer_load_dwordx4 v2, s[4:7], s40 offen lds
    s_add_u32 m0, m0, 4096
    s_add_u32 s40, s40, 114688
    buffer_load_dwordx4 v2, s[4:7], s40 offen lds
    s_add_u32 m0, m0, 4096
    s_add_u32 s40, s40, 114688
    buffer_load_dwordx4 v2, s[4:7], s40 offen lds
    s_add_u32 m0, m0, 4096
    s_add_u32 s40, s40, 114688
    buffer_load_dwordx4 v2, s[4:7], s40 offen lds
    s_add_u32 m0, m0, 4096
    s_add_u32 s40, s40, 114688
    buffer_load_dwordx4 v2, s[4:7], s40 offen lds
    s_add_u32 m0, m0, 4096
    s_add_u32 s40, s40, 114688
    buffer_load_dwordx4 v2, s[4:7], s40 offen lds
    s_mov_b32 s4, s30
    s_mov_b32 s5, s31
    s_mov_b32 s6, 802816
    s_mov_b32 s7, 0x20000
    v_lshrrev_b32 v3, 3, v1
    v_mul_u32_u24 v2, 896, v3
    v_bfe_u32 v3, v1, 4, 1
    v_lshlrev_b32 v3, 2, v3
    v_and_b32 v4, 7, v1
    v_xor_b32 v3, v3, v4
    v_lshlrev_b32 v3, 4, v3
    v_add_u32 v2, v2, v3
    s_mov_b32 s41, s3
    s_mul_i32 s40, s41, 7168
    s_lshl_b32 s43, s38, 7
    s_add_u32 s40, s40, s43
    v_mov_b32 v13, v2
    s_mov_b32 s54, s40
    buffer_load_dwordx4 v[16:19], v13, s[4:7], s54 offen
    s_add_u32 s54, s54, 28672
    buffer_load_dwordx4 v[20:23], v13, s[4:7], s54 offen
    s_add_u32 s54, s54, 28672
    buffer_load_dwordx4 v[24:27], v13, s[4:7], s54 offen
    s_add_u32 s54, s54, 28672
    buffer_load_dwordx4 v[28:31], v13, s[4:7], s54 offen
    s_waitcnt vmcnt(4)
    s_barrier
    s_cmp_eq_u32 s19, 0
    s_cbranch_scc0 L_win_nocs1_52
    s_cmp_ge_u32 s3, 2
    s_cbranch_scc0 L_win_nocs1_52
    s_and_b32 s41, s3, 1
    v_lshrrev_b32 v2, 5, v1
    v_lshlrev_b32 v2, 2, v2
    v_bfe_u32 v3, v1, 2, 2
    v_add_u32 v2, v2, v3
    v_mul_u32_u24 v12, 128, v2
    v_bfe_u32 v3, v1, 4, 1
    v_lshlrev_b32 v3, 5, v3
    v_add_u32 v12, v12, v3
    v_and_b32 v3, 3, v1
    v_lshlrev_b32 v3, 3, v3
    v_add_u32 v12, v12, v3
    v_bfe_u32 v3, v1, 3, 1
    v_xor_b32 v3, s41, v3
    v_lshlrev_b32 v3, 6, v3
    v_add_u32 v12, v12, v3
    s_lshr_b32 s41, s3, 1
    s_mul_i32 s41, s41, 57344
    v_add_u32 v12, s41, v12
    s_lshl_b32 s42, s3, 7
    s_add_u32 s42, s42, 162304
    v_mov_b32 v144, 0x3f803f80
    v_mov_b32 v145, 0x3f803f80
    v_mov_b32 v146, 0x3f803f80
    v_mov_b32 v147, 0x3f803f80
    ds_read_b64_tr_b16 v[148:149], v12 offset:0
    ds_read_b64_tr_b16 v[150:151], v12 offset:1024
    ds_read_b64_tr_b16 v[152:153], v12 offset:2048
    ds_read_b64_tr_b16 v[154:155], v12 offset:3072
    ds_read_b64_tr_b16 v[156:157], v12 offset:4096
    ds_read_b64_tr_b16 v[158:159], v12 offset:5120
    s_waitcnt lgkmcnt(4)
    v_mfma_f32_32x32x16_bf16 v[128:143], v[148:151], v[144:147], 0
    ds_read_b64_tr_b16 v[148:149], v12 offset:6144
    ds_read_b64_tr_b16 v[150:151], v12 offset:7168
    s_waitcnt lgkmcnt(4)
    v_mfma_f32_32x32x16_bf16 v[128:143], v[152:155], v[144:147], v[128:143]
    ds_read_b64_tr_b16 v[152:153], v12 offset:8192
    ds_read_b64_tr_b16 v[154:155], v12 offset:9216
    s_waitcnt lgkmcnt(4)
    v_mfma_f32_32x32x16_bf16 v[128:143], v[156:159], v[144:147], v[128:143]
    ds_read_b64_tr_b16 v[156:157], v12 offset:10240
    ds_read_b64_tr_b16 v[158:159], v12 offset:11264
    s_waitcnt lgkmcnt(4)
    v_mfma_f32_32x32x16_bf16 v[128:143], v[148:151], v[144:147], v[128:143]
    ds_read_b64_tr_b16 v[148:149], v12 offset:12288
    ds_read_b64_tr_b16 v[150:151], v12 offset:13312
    s_waitcnt lgkmcnt(4)
    v_mfma_f32_32x32x16_bf16 v[128:143], v[152:155], v[144:147], v[128:143]
    ds_read_b64_tr_b16 v[152:153], v12 offset:14336
    ds_read_b64_tr_b16 v[154:155], v12 offset:15360
    s_waitcnt lgkmcnt(4)
    v_mfma_f32_32x32x16_bf16 v[128:143], v[156:159], v[144:147], v[128:143]
    ds_read_b64_tr_b16 v[156:157], v12 offset:16384
    ds_read_b64_tr_b16 v[158:159], v12 offset:17408
    s_waitcnt lgkmcnt(4)
    v_mfma_f32_32x32x16_bf16 v[128:143], v[148:151], v[144:147], v[128:143]
    ds_read_b64_tr_b16 v[148:149], v12 offset:18432
    ds_read_b64_tr_b16 v[150:151], v12 offset:19456
    s_waitcnt lgkmcnt(4)
    v_mfma_f32_32x32x16_bf16 v[128:143], v[152:155], v[144:147], v[128:143]
    ds_read_b64_tr_b16 v[152:153], v12 offset:20480
    ds_read_b64_tr_b16 v[154:155], v12 offset:21504
    s_waitcnt lgkmcnt(4)
    v_mfma_f32_32x32x16_bf16 v[128:143], v[156:159], v[144:147], v[128:143]
    ds_read_b64_tr_b16 v[156:157], v12 offset:22528
    ds_read_b64_tr_b16 v[158:159], v12 offset:23552
    s_waitcnt lgkmcnt(4)
    v_mfma_f32_32x32x16_bf16 v[128:143], v[148:151], v[144:147], v[128:143]
    ds_read_b64_tr_b16 v[148:149], v12 offset:24576
    ds_read_b64_tr_b16 v[150:151], v12 offset:25600
    s_waitcnt lgkmcnt(4)
    v_mfma_f32_32x32x16_bf16 v[128:143], v[152:155], v[144:147], v[128:143]
    ds_read_b64_tr_b16 v[152:153], v12 offset:26624
    ds_read_b64_tr_b16 v[154:155], v12 offset:27648
    s_waitcnt lgkmcnt(4)
    v_mfma_f32_32x32x16_bf16 v[128:143], v[156:159], v[144:147], v[128:143]
    ds_read_b64_tr_b16 v[156:157], v12 offset:28672
    ds_read_b64_tr_b16 v[158:159], v12 offset:29696
    s_waitcnt lgkmcnt(4)
    v_mfma_f32_32x32x16_bf16 v[128:143], v[148:151], v[144:147], v[128:143]
    ds_read_b64_tr_b16 v[148:149], v12 offset:30720
    ds_read_b64_tr_b16 v[150:151], v12 offset:31744
    s_waitcnt lgkmcnt(4)
    v_mfma_f32_32x32x16_bf16 v[128:143], v[152:155], v[144:147], v[128:143]
    ds_read_b64_tr_b16 v[152:153], v12 offset:32768
    ds_read_b64_tr_b16 v[154:155], v12 offset:33792
    s_waitcnt lgkmcnt(4)
    v_mfma_f32_32x32x16_bf16 v[128:143], v[156:159], v[144:147], v[128:143]
    ds_read_b64_tr_b16 v[156:157], v12 offset:34816
    ds_read_b64_tr_b16 v[158:159], v12 offset:35840
    s_waitcnt lgkmcnt(4)
    v_mfma_f32_32x32x16_bf16 v[128:143], v[148:151], v[144:147], v[128:143]
    ds_read_b64_tr_b16 v[148:149], v12 offset:36864
    ds_read_b64_tr_b16 v[150:151], v12 offset:37888
    s_waitcnt lgkmcnt(4)
    v_mfma_f32_32x32x16_bf16 v[128:143], v[152:155], v[144:147], v[128:143]
    ds_read_b64_tr_b16 v[152:153], v12 offset:38912
    ds_read_b64_tr_b16 v[154:155], v12 offset:39936
    s_waitcnt lgkmcnt(4)
    v_mfma_f32_32x32x16_bf16 v[128:143], v[156:159], v[144:147], v[128:143]
    ds_read_b64_tr_b16 v[156:157], v12 offset:40960
    ds_read_b64_tr_b16 v[158:159], v12 offset:41984
    s_waitcnt lgkmcnt(4)
    v_mfma_f32_32x32x16_bf16 v[128:143], v[148:151], v[144:147], v[128:143]
    ds_read_b64_tr_b16 v[148:149], v12 offset:43008
    ds_read_b64_tr_b16 v[150:151], v12 offset:44032
    s_waitcnt lgkmcnt(4)
    v_mfma_f32_32x32x16_bf16 v[128:143], v[152:155], v[144:147], v[128:143]
    ds_read_b64_tr_b16 v[152:153], v12 offset:45056
    ds_read_b64_tr_b16 v[154:155], v12 offset:46080
    s_waitcnt lgkmcnt(4)
    v_mfma_f32_32x32x16_bf16 v[128:143], v[156:159], v[144:147], v[128:143]
    ds_read_b64_tr_b16 v[156:157], v12 offset:47104
    ds_read_b64_tr_b16 v[158:159], v12 offset:48128
    s_waitcnt lgkmcnt(4)
    v_mfma_f32_32x32x16_bf16 v[128:143], v[148:151], v[144:147], v[128:143]
    ds_read_b64_tr_b16 v[148:149], v12 offset:49152
    ds_read_b64_tr_b16 v[150:151], v12 offset:50176
    s_waitcnt lgkmcnt(4)
    v_mfma_f32_32x32x16_bf16 v[128:143], v[152:155], v[144:147], v[128:143]
    ds_read_b64_tr_b16 v[152:153], v12 offset:51200
    ds_read_b64_tr_b16 v[154:155], v12 offset:52224
    s_waitcnt lgkmcnt(4)
    v_mfma_f32_32x32x16_bf16 v[128:143], v[156:159], v[144:147], v[128:143]
    ds_read_b64_tr_b16 v[156:157], v12 offset:53248
    ds_read_b64_tr_b16 v[158:159], v12 offset:54272
    s_waitcnt lgkmcnt(4)
    v_mfma_f32_32x32x16_bf16 v[128:143], v[148:151], v[144:147], v[128:143]
    ds_read_b64_tr_b16 v[148:149], v12 offset:55296
    ds_read_b64_tr_b16 v[150:151], v12 offset:56320
    s_waitcnt lgkmcnt(4)
    v_mfma_f32_32x32x16_bf16 v[128:143], v[152:155], v[144:147], v[128:143]
    s_waitcnt lgkmcnt(2)
    v_mfma_f32_32x32x16_bf16 v[128:143], v[156:159], v[144:147], v[128:143]
    s_waitcnt lgkmcnt(0)
    v_mfma_f32_32x32x16_bf16 v[128:143], v[148:151], v[144:147], v[128:143]
    v_lshrrev_b32 v11, 5, v1
    v_lshlrev_b32 v11, 4, v11
    v_add_u32 v11, s42, v11
    s_mov_b32 exec_lo, 1
    s_mov_b32 exec_hi, 1
    s_nop 7
    ds_write_b128 v11, v[128:131] offset:0
    ds_write_b128 v11, v[132:135] offset:32
    ds_write_b128 v11, v[136:139] offset:64
    ds_write_b128 v11, v[140:143] offset:96
    s_mov_b64 exec, -1
    s_waitcnt lgkmcnt(0)
L_win_nocs1_52:
    s_add_u32 s54, s54, 28672
    buffer_load_dwordx4 v[32:35], v13, s[4:7], s54 offen
    s_waitcnt vmcnt(11)
    s_add_u32 s54, s54, 28672
    buffer_load_dwordx4 v[36:39], v13, s[4:7], s54 offen
    s_waitcnt vmcnt(11)
    s_add_u32 s54, s54, 28672
    buffer_load_dwordx4 v[40:43], v13, s[4:7], s54 offen
    s_waitcnt vmcnt(11)
    s_add_u32 s54, s54, 28672
    buffer_load_dwordx4 v[44:47], v13, s[4:7], s54 offen
    s_waitcnt vmcnt(11)
    s_add_u32 s54, s54, 28672
    buffer_load_dwordx4 v[48:51], v13, s[4:7], s54 offen
    s_waitcnt vmcnt(11)
    s_add_u32 s54, s54, 28672
    buffer_load_dwordx4 v[52:55], v13, s[4:7], s54 offen
    s_waitcnt vmcnt(11)
    s_add_u32 s54, s54, 28672
    buffer_load_dwordx4 v[56:59], v13, s[4:7], s54 offen
    s_waitcnt vmcnt(11)
    s_add_u32 s54, s54, 28672
    buffer_load_dwordx4 v[60:63], v13, s[4:7], s54 offen
    s_waitcnt vmcnt(11)
    s_add_u32 s54, s54, 28672
    buffer_load_dwordx4 v[64:67], v13, s[4:7], s54 offen
    s_waitcnt vmcnt(11)
    s_add_u32 s54, s54, 28672
    buffer_load_dwordx4 v[68:71], v13, s[4:7], s54 offen
    s_waitcnt vmcnt(11)
    s_add_u32 s54, s54, 28672
    buffer_load_dwordx4 v[72:75], v13, s[4:7], s54 offen
    s_waitcnt vmcnt(11)
    s_add_u32 s54, s54, 28672
    buffer_load_dwordx4 v[76:79], v13, s[4:7], s54 offen
    s_waitcnt vmcnt(11)
    s_add_u32 s54, s54, 28672
    buffer_load_dwordx4 v[80:83], v13, s[4:7], s54 offen
    s_waitcnt vmcnt(11)
    s_add_u32 s54, s54, 28672
    buffer_load_dwordx4 v[84:87], v13, s[4:7], s54 offen
    s_waitcnt vmcnt(11)
    s_add_u32 s54, s54, 28672
    buffer_load_dwordx4 v[88:91], v13, s[4:7], s54 offen
    s_waitcnt vmcnt(11)
    s_add_u32 s54, s54, 28672
    buffer_load_dwordx4 v[92:95], v13, s[4:7], s54 offen
    s_waitcnt vmcnt(11)
    s_add_u32 s54, s54, 28672
    buffer_load_dwordx4 v[96:99], v13, s[4:7], s54 offen
    s_waitcnt vmcnt(11)
    s_add_u32 s54, s54, 28672
    buffer_load_dwordx4 v[100:103], v13, s[4:7], s54 offen
    s_waitcnt vmcnt(11)
    s_add_u32 s54, s54, 28672
    buffer_load_dwordx4 v[104:107], v13, s[4:7], s54 offen
    s_waitcnt vmcnt(11)
    s_add_u32 s54, s54, 28672
    buffer_load_dwordx4 v[108:111], v13, s[4:7], s54 offen
    s_waitcnt vmcnt(11)
    s_add_u32 s54, s54, 28672
    buffer_load_dwordx4 v[112:115], v13, s[4:7], s54 offen
    s_waitcnt vmcnt(11)
    s_add_u32 s54, s54, 28672
    buffer_load_dwordx4 v[116:119], v13, s[4:7], s54 offen
    s_waitcnt vmcnt(11)
    s_add_u32 s54, s54, 28672
    buffer_load_dwordx4 v[120:123], v13, s[4:7], s54 offen
    s_waitcnt vmcnt(11)
    s_add_u32 s54, s54, 28672
    buffer_load_dwordx4 v[124:127], v13, s[4:7], s54 offen
    s_waitcnt vmcnt(11)
    s_barrier
    s_mov_b32 s12, s26
    s_mov_b32 s13, s27
    s_mov_b32 s14, 8388608
    s_mov_b32 s15, 0x20000
    s_mov_b32 s45, s3
    v_lshrrev_b32 v2, 3, v1
    v_and_b32 v3, 3, v2
    v_bfe_u32 v4, v1, 5, 1
    v_lshlrev_b32 v4, 3, v4
    v_add_u32 v3, v3, v4
    v_lshlrev_b32 v3, 12, v3
    v_bfe_u32 v4, v1, 4, 2
    v_and_b32 v5, 7, v1
    v_xor_b32 v4, v4, v5
    v_lshlrev_b32 v4, 4, v4
    v_add_u32 v6, v3, v4
    v_xor_b32 v4, 64, v4
    v_add_u32 v7, v3, v4
    s_lshr_b32 s52, s16, 1
    s_lshl_b32 s52, s52, 2
    s_mov_b32 s52, 0
    s_lshl_b32 s44, s16, 2
    s_add_u32 s44, s44, s45
    s_lshl_b32 s44, s44, 17
    s_add_u32 s53, s52, 0
    s_and_b32 s53, s53, 31
    s_lshl_b32 s51, s53, 7
    s_add_u32 s51, s51, s44
    s_lshl_b32 s46, s45, 12
    s_add_u32 m0, s46, 0
    s_add_u32 s47, s51, 0
    buffer_load_dwordx4 v6, s[12:15], s47 offen lds
    s_add_u32 m0, m0, 1024
    s_add_u32 s47, s51, 16384
    buffer_load_dwordx4 v7, s[12:15], s47 offen lds
    s_add_u32 m0, m0, 1024
    s_add_u32 s47, s51, 65536
    buffer_load_dwordx4 v6, s[12:15], s47 offen lds
    s_add_u32 m0, m0, 1024
    s_add_u32 s47, s51, 81920
    buffer_load_dwordx4 v7, s[12:15], s47 offen lds
    s_waitcnt vmcnt(11)
    s_add_u32 s53, s52, 1
    s_and_b32 s53, s53, 31
    s_lshl_b32 s51, s53, 7
    s_add_u32 s51, s51, s44
    s_lshl_b32 s46, s45, 12
    s_add_u32 m0, s46, 16384
    s_add_u32 s47, s51, 0
    buffer_load_dwordx4 v6, s[12:15], s47 offen lds
    s_add_u32 m0, m0, 1024
    s_add_u32 s47, s51, 16384
    buffer_load_dwordx4 v7, s[12:15], s47 offen lds
    s_add_u32 m0, m0, 1024
    s_add_u32 s47, s51, 65536
    buffer_load_dwordx4 v6, s[12:15], s47 offen lds
    s_add_u32 m0, m0, 1024
    s_add_u32 s47, s51, 81920
    buffer_load_dwordx4 v7, s[12:15], s47 offen lds
    s_waitcnt vmcnt(11)
    s_add_u32 s53, s52, 2
    s_and_b32 s53, s53, 31
    s_lshl_b32 s51, s53, 7
    s_add_u32 s51, s51, s44
    s_lshl_b32 s46, s45, 12
    s_add_u32 m0, s46, 32768
    s_add_u32 s47, s51, 0
    buffer_load_dwordx4 v6, s[12:15], s47 offen lds
    s_add_u32 m0, m0, 1024
    s_add_u32 s47, s51, 16384
    buffer_load_dwordx4 v7, s[12:15], s47 offen lds
    s_add_u32 m0, m0, 1024
    s_add_u32 s47, s51, 65536
    buffer_load_dwordx4 v6, s[12:15], s47 offen lds
    s_add_u32 m0, m0, 1024
    s_add_u32 s47, s51, 81920
    buffer_load_dwordx4 v7, s[12:15], s47 offen lds
    s_waitcnt vmcnt(11)
    s_add_u32 s53, s52, 3
    s_and_b32 s53, s53, 31
    s_lshl_b32 s51, s53, 7
    s_add_u32 s51, s51, s44
    s_lshl_b32 s46, s45, 12
    s_add_u32 m0, s46, 49152
    s_add_u32 s47, s51, 0
    buffer_load_dwordx4 v6, s[12:15], s47 offen lds
    s_add_u32 m0, m0, 1024
    s_add_u32 s47, s51, 16384
    buffer_load_dwordx4 v7, s[12:15], s47 offen lds
    s_add_u32 m0, m0, 1024
    s_add_u32 s47, s51, 65536
    buffer_load_dwordx4 v6, s[12:15], s47 offen lds
    s_add_u32 m0, m0, 1024
    s_add_u32 s47, s51, 81920
    buffer_load_dwordx4 v7, s[12:15], s47 offen lds
    s_waitcnt vmcnt(11)
    s_add_u32 s53, s52, 4
    s_and_b32 s53, s53, 31
    s_lshl_b32 s51, s53, 7
    s_add_u32 s51, s51, s44
    s_lshl_b32 s46, s45, 12
    s_add_u32 m0, s46, 65536
    s_add_u32 s47, s51, 0
    buffer_load_dwordx4 v6, s[12:15], s47 offen lds
    s_add_u32 m0, m0, 1024
    s_add_u32 s47, s51, 16384
    buffer_load_dwordx4 v7, s[12:15], s47 offen lds
    s_add_u32 m0, m0, 1024
    s_add_u32 s47, s51, 65536
    buffer_load_dwordx4 v6, s[12:15], s47 offen lds
    s_add_u32 m0, m0, 1024
    s_add_u32 s47, s51, 81920
    buffer_load_dwordx4 v7, s[12:15], s47 offen lds
    s_waitcnt vmcnt(11)
L_win_join_43:
    s_cmp_ge_u32 s18, 4
    s_cbranch_scc0 L_sp_helper_53
    s_lshl_b32 s50, s16, 2
    s_add_u32 s50, s50, s3
    s_mov_b32 s4, s28
    s_mov_b32 s5, s29
    s_mov_b32 s6, 4096
    s_mov_b32 s7, 0x20000
    v_and_b32 v2, 0x13, v1
    v_bfe_u32 v3, v1, 2, 1
    v_lshlrev_b32 v3, 3, v3
    v_or_b32 v2, v2, v3
    v_bfe_u32 v3, v1, 3, 1
    v_lshlrev_b32 v3, 2, v3
    v_or_b32 v2, v2, v3
    s_lshl_b32 s41, s50, 5
    v_add_u32 v2, s41, v2
    v_lshlrev_b32 v2, 1, v2
    buffer_load_ushort v105, v2, s[4:7], 0 offen
    s_waitcnt vmcnt(0)
    v_lshlrev_b32 v105, 16, v105
    s_mul_i32 s40, s2, 4194304
    s_add_u32 s40, s40, 30408704
    s_mul_i32 s41, s50, 57344
    s_add_u32 s40, s40, s41
    s_lshl_b32 s41, s17, 12
    s_add_u32 s40, s40, s41
    buffer_load_dwordx4 v[116:119], v0, s[8:11], s40 offen offset:0
    buffer_load_dwordx4 v[120:123], v0, s[8:11], s40 offen offset:1024
    buffer_load_dwordx4 v[124:127], v0, s[8:11], s40 offen offset:2048
    buffer_load_dwordx4 v[128:131], v0, s[8:11], s40 offen offset:3072
    s_cmp_eq_u32 s19, 0
    s_cbranch_scc0 L_sp_nox2_55
    s_lshl_b32 s45, s16, 2
    s_lshl_b32 s41, s37, 1
    s_add_u32 s45, s45, s41
    s_and_b32 s41, s3, 1
    s_add_u32 s45, s45, s41
    s_mul_i32 s45, s45, 14
    s_lshl_b32 s41, s38, 1
    s_add_u32 s45, s45, s41
    s_lshr_b32 s41, s3, 1
    s_add_u32 s45, s45, s41
    s_lshl_b32 s40, s45, 11
    s_add_u32 s40, s40, 5242880
    buffer_load_dwordx4 v[132:135], v0, s[8:11], s40 offen offset:0
    buffer_load_dwordx4 v[136:139], v0, s[8:11], s40 offen offset:1024
    s_lshl_b32 s40, s45, 8
    s_add_u32 s40, s40, 39845888
    v_lshlrev_b32 v141, 2, v1
    buffer_load_dword v140, v141, s[8:11], s40 offen
L_sp_nox2_55:
    v_and_b32 v2, 31, v1
    v_bfe_u32 v3, v1, 1, 3
    v_lshrrev_b32 v4, 5, v1
    v_xor_b32 v3, v3, v4
    v_lshlrev_b32 v3, 4, v3
    v_lshlrev_b32 v2, 7, v2
    s_lshl_b32 s41, s3, 12
    v_add_u32 v2, s41, v2
    v_xor_b32 v4, 0, v3
    v_add_u32 v100, v2, v4
    v_xor_b32 v4, 32, v3
    v_add_u32 v101, v2, v4
    v_xor_b32 v4, 64, v3
    v_add_u32 v102, v2, v4
    v_xor_b32 v4, 96, v3
    v_add_u32 v103, v2, v4
    v_add_u32 v104, 98304, v0
    v_lshlrev_b32 v192, 16, v240
    v_and_b32 v193, 0xffff0000, v240
    v_lshlrev_b32 v194, 16, v241
    v_and_b32 v195, 0xffff0000, v241
    v_lshlrev_b32 v196, 16, v242
    v_and_b32 v197, 0xffff0000, v242
    v_lshlrev_b32 v198, 16, v243
    v_and_b32 v199, 0xffff0000, v243
    v_lshlrev_b32 v200, 16, v244
    v_and_b32 v201, 0xffff0000, v244
    v_lshlrev_b32 v202, 16, v245
    v_and_b32 v203, 0xffff0000, v245
    v_lshlrev_b32 v204, 16, v246
    v_and_b32 v205, 0xffff0000, v246
    v_lshlrev_b32 v206, 16, v247
    v_and_b32 v207, 0xffff0000, v247
    v_lshlrev_b32 v208, 16, v248
    v_and_b32 v209, 0xffff0000, v248
    v_lshlrev_b32 v210, 16, v249
    v_and_b32 v211, 0xffff0000, v249
    v_lshlrev_b32 v212, 16, v250
    v_and_b32 v213, 0xffff0000, v250
    v_lshlrev_b32 v214, 16, v251
    v_and_b32 v215, 0xffff0000, v251
    v_lshlrev_b32 v216, 16, v252
    v_and_b32 v217, 0xffff0000, v252
    v_lshlrev_b32 v218, 16, v253
    v_and_b32 v219, 0xffff0000, v253
    v_lshlrev_b32 v220, 16, v254
    v_and_b32 v221, 0xffff0000, v254
    v_lshlrev_b32 v222, 16, v255
    v_and_b32 v223, 0xffff0000, v255
    v_mov_b32 v16, v105
    v_mov_b32 v17, v105
    v_mov_b32 v18, v105
    v_mov_b32 v19, v105
    v_mov_b32 v20, v105
    v_mov_b32 v21, v105
    v_mov_b32 v22, v105
    v_mov_b32 v23, v105
    v_mov_b32 v24, v105
    v_mov_b32 v25, v105
    v_mov_b32 v26, v105
    v_mov_b32 v27, v105
    v_mov_b32 v28, v105
    v_mov_b32 v29, v105
    v_mov_b32 v30, v105
    v_mov_b32 v31, v105
    v_mov_b32 v32, v105
    v_mov_b32 v33, v105
    v_mov_b32 v34, v105
    v_mov_b32 v35, v105
    v_mov_b32 v36, v105
    v_mov_b32 v37, v105
    v_mov_b32 v38, v105
    v_mov_b32 v39, v105
    v_mov_b32 v40, v105
    v_mov_b32 v41, v105
    v_mov_b32 v42, v105
    v_mov_b32 v43, v105
    v_mov_b32 v44, v105
    v_mov_b32 v45, v105
    v_mov_b32 v46, v105
    v_mov_b32 v47, v105
    s_mov_b32 s42, 0
    s_mov_b32 s43, 0
    s_barrier
    s_barrier
    v_add_u32 v108, s42, v100
    v_add_u32 v109, s42, v101
    v_add_u32 v110, s42, v102
    v_add_u32 v111, s42, v103
    v_add_u32 v112, s43, v104
    s_add_u32 s42, s42, 16384
    s_add_u32 s43, s43, 8192
    s_cmp_eq_u32 s42, 98304
    s_cselect_b32 s42, 0, s42
    s_cselect_b32 s43, 0, s43
    ds_read_b128 v[48:51], v108
    ds_read_b128 v[64:67], v112 offset:0
    ds_read_b128 v[68:71], v112 offset:4096
    ds_read_b128 v[52:55], v109
    ds_read_b128 v[72:75], v112 offset:1024
    ds_read_b128 v[76:79], v112 offset:5120
    ds_read_b128 v[56:59], v110
    ds_read_b128 v[80:83], v112 offset:2048
    ds_read_b128 v[84:87], v112 offset:6144
    ds_read_b128 v[60:63], v111
    ds_read_b128 v[88:91], v112 offset:3072
    ds_read_b128 v[92:95], v112 offset:7168
    s_waitcnt lgkmcnt(0)
    s_mov_b32 s44, 15
L_sp_loop_56:
    s_barrier
    v_add_u32 v108, s42, v100
    v_add_u32 v109, s42, v101
    v_add_u32 v110, s42, v102
    v_add_u32 v111, s42, v103
    v_add_u32 v112, s43, v104
    s_add_u32 s42, s42, 16384
    s_add_u32 s43, s43, 8192
    s_cmp_eq_u32 s42, 98304
    s_cselect_b32 s42, 0, s42
    s_cselect_b32 s43, 0, s43
    ds_read_b128 v[144:147], v108
    ds_read_b128 v[160:163], v112 offset:0
    ds_read_b128 v[164:167], v112 offset:4096
    v_mfma_f32_32x32x16_bf16 v[16:31], v[64:67], v[48:51], v[16:31]
    v_mfma_f32_32x32x16_bf16 v[32:47], v[68:71], v[48:51], v[32:47]
    ds_read_b128 v[148:151], v109
    ds_read_b128 v[168:171], v112 offset:1024
    ds_read_b128 v[172:175], v112 offset:5120
    v_mfma_f32_32x32x16_bf16 v[16:31], v[72:75], v[52:55], v[16:31]
    v_mfma_f32_32x32x16_bf16 v[32:47], v[76:79], v[52:55], v[32:47]
    ds_read_b128 v[152:155], v110
    ds_read_b128 v[176:179], v112 offset:2048
    ds_read_b128 v[180:183], v112 offset:6144
    v_mfma_f32_32x32x16_bf16 v[16:31], v[80:83], v[56:59], v[16:31]
    v_mfma_f32_32x32x16_bf16 v[32:47], v[84:87], v[56:59], v[32:47]
    ds_read_b128 v[156:159], v111
    ds_read_b128 v[184:187], v112 offset:3072
    ds_read_b128 v[188:191], v112 offset:7168
    v_mfma_f32_32x32x16_bf16 v[16:31], v[88:91], v[60:63], v[16:31]
    v_mfma_f32_32x32x16_bf16 v[32:47], v[92:95], v[60:63], v[32:47]
    s_waitcnt lgkmcnt(0)
    s_barrier
    v_add_u32 v108, s42, v100
    v_add_u32 v109, s42, v101
    v_add_u32 v110, s42, v102
    v_add_u32 v111, s42, v103
    v_add_u32 v112, s43, v104
    s_add_u32 s42, s42, 16384
    s_add_u32 s43, s43, 8192
    s_cmp_eq_u32 s42, 98304
    s_cselect_b32 s42, 0, s42
    s_cselect_b32 s43, 0, s43
    ds_read_b128 v[48:51], v108
    ds_read_b128 v[64:67], v112 offset:0
    ds_read_b128 v[68:71], v112 offset:4096
    v_mfma_f32_32x32x16_bf16 v[16:31], v[160:163], v[144:147], v[16:31]
    v_mfma_f32_32x32x16_bf16 v[32:47], v[164:167], v[144:147], v[32:47]
    ds_read_b128 v[52:55], v109
    ds_read_b128 v[72:75], v112 offset:1024
    ds_read_b128 v[76:79], v112 offset:5120
    v_mfma_f32_32x32x16_bf16 v[16:31], v[168:171], v[148:151], v[16:31]
    v_mfma_f32_32x32x16_bf16 v[32:47], v[172:175], v[148:151], v[32:47]
    ds_read_b128 v[56:59], v110
    ds_read_b128 v[80:83], v112 offset:2048
    ds_read_b128 v[84:87], v112 offset:6144
    v_mfma_f32_32x32x16_bf16 v[16:31], v[176:179], v[152:155], v[16:31]
    v_mfma_f32_32x32x16_bf16 v[32:47], v[180:183], v[152:155], v[32:47]
    ds_read_b128 v[60:63], v111
    ds_read_b128 v[88:91], v112 offset:3072
    ds_read_b128 v[92:95], v112 offset:7168
    v_mfma_f32_32x32x16_bf16 v[16:31], v[184:187], v[156:159], v[16:31]
    v_mfma_f32_32x32x16_bf16 v[32:47], v[188:191], v[156:159], v[32:47]
    s_waitcnt lgkmcnt(0)
    s_sub_u32 s44, s44, 1
    s_cmp_lg_u32 s44, 0
    s_cbranch_scc1 L_sp_loop_56
    s_barrier
    v_add_u32 v108, s42, v100
    v_add_u32 v109, s42, v101
    v_add_u32 v110, s42, v102
    v_add_u32 v111, s42, v103
    v_add_u32 v112, s43, v104
    s_add_u32 s42, s42, 16384
    s_add_u32 s43, s43, 8192
    s_cmp_eq_u32 s42, 98304
    s_cselect_b32 s42, 0, s42
    s_cselect_b32 s43, 0, s43
    ds_read_b128 v[144:147], v108
    ds_read_b128 v[160:163], v112 offset:0
    ds_read_b128 v[164:167], v112 offset:4096
    v_mfma_f32_32x32x16_bf16 v[16:31], v[64:67], v[48:51], v[16:31]
    v_mfma_f32_32x32x16_bf16 v[32:47], v[68:71], v[48:51], v[32:47]
    ds_read_b128 v[148:151], v109
    ds_read_b128 v[168:171], v112 offset:1024
    ds_read_b128 v[172:175], v112 offset:5120
    v_mfma_f32_32x32x16_bf16 v[16:31], v[72:75], v[52:55], v[16:31]
    v_mfma_f32_32x32x16_bf16 v[32:47], v[76:79], v[52:55], v[32:47]
    ds_read_b128 v[152:155], v110
    ds_read_b128 v[176:179], v112 offset:2048
    ds_read_b128 v[180:183], v112 offset:6144
    v_mfma_f32_32x32x16_bf16 v[16:31], v[80:83], v[56:59], v[16:31]
    v_mfma_f32_32x32x16_bf16 v[32:47], v[84:87], v[56:59], v[32:47]
    ds_read_b128 v[156:159], v111
    ds_read_b128 v[184:187], v112 offset:3072
    ds_read_b128 v[188:191], v112 offset:7168
    v_mfma_f32_32x32x16_bf16 v[16:31], v[88:91], v[60:63], v[16:31]
    v_mfma_f32_32x32x16_bf16 v[32:47], v[92:95], v[60:63], v[32:47]
    s_waitcnt lgkmcnt(0)
    s_barrier
    v_mfma_f32_32x32x16_bf16 v[16:31], v[160:163], v[144:147], v[16:31]
    v_mfma_f32_32x32x16_bf16 v[32:47], v[164:167], v[144:147], v[32:47]
    v_mfma_f32_32x32x16_bf16 v[16:31], v[168:171], v[148:151], v[16:31]
    v_mfma_f32_32x32x16_bf16 v[32:47], v[172:175], v[148:151], v[32:47]
    v_mfma_f32_32x32x16_bf16 v[16:31], v[176:179], v[152:155], v[16:31]
    v_mfma_f32_32x32x16_bf16 v[32:47], v[180:183], v[152:155], v[32:47]
    v_mfma_f32_32x32x16_bf16 v[16:31], v[184:187], v[156:159], v[16:31]
    v_mfma_f32_32x32x16_bf16 v[32:47], v[188:191], v[156:159], v[32:47]
    s_nop 11
    v_pk_mul_f32 v[16:17], v[16:17], v[192:193]
    v_pk_mul_f32 v[18:19], v[18:19], v[194:195]
    v_pk_mul_f32 v[20:21], v[20:21], v[196:197]
    v_pk_mul_f32 v[22:23], v[22:23], v[198:199]
    v_pk_mul_f32 v[24:25], v[24:25], v[200:201]
    v_pk_mul_f32 v[26:27], v[26:27], v[202:203]
    v_pk_mul_f32 v[28:29], v[28:29], v[204:205]
    v_pk_mul_f32 v[30:31], v[30:31], v[206:207]
    v_pk_mul_f32 v[32:33], v[32:33], v[208:209]
    v_pk_mul_f32 v[34:35], v[34:35], v[210:211]
    v_pk_mul_f32 v[36:37], v[36:37], v[212:213]
    v_pk_mul_f32 v[38:39], v[38:39], v[214:215]
    v_pk_mul_f32 v[40:41], v[40:41], v[216:217]
    v_pk_mul_f32 v[42:43], v[42:43], v[218:219]
    v_pk_mul_f32 v[44:45], v[44:45], v[220:221]
    v_pk_mul_f32 v[46:47], v[46:47], v[222:223]
    v_cvt_pk_bf16_f32 v80, v16, v17
    v_cvt_pk_bf16_f32 v81, v18, v19
    v_cvt_pk_bf16_f32 v82, v20, v21
    v_cvt_pk_bf16_f32 v83, v22, v23
    v_cvt_pk_bf16_f32 v84, v24, v25
    v_cvt_pk_bf16_f32 v85, v26, v27
    v_cvt_pk_bf16_f32 v86, v28, v29
    v_cvt_pk_bf16_f32 v87, v30, v31
    v_cvt_pk_bf16_f32 v88, v32, v33
    v_cvt_pk_bf16_f32 v89, v34, v35
    v_cvt_pk_bf16_f32 v90, v36, v37
    v_cvt_pk_bf16_f32 v91, v38, v39
    v_cvt_pk_bf16_f32 v92, v40, v41
    v_cvt_pk_bf16_f32 v93, v42, v43
    v_cvt_pk_bf16_f32 v94, v44, v45
    v_cvt_pk_bf16_f32 v95, v46, v47
    s_mul_i32 s40, s2, 4194304
    s_add_u32 s40, s40, 30408704
    s_mul_i32 s41, s50, 57344
    s_add_u32 s40, s40, s41
    s_lshl_b32 s41, s17, 12
    s_add_u32 s40, s40, s41
    s_cmp_eq_u32 s39, 1
    s_cbranch_scc0 L_wt_57
    buffer_store_dwordx4 v[80:83], v0, s[8:11], s40 offen offset:0
    buffer_store_dwordx4 v[84:87], v0, s[8:11], s40 offen offset:1024
    buffer_store_dwordx4 v[88:91], v0, s[8:11], s40 offen offset:2048
    buffer_store_dwordx4 v[92:95], v0, s[8:11], s40 offen offset:3072
    s_branch L_wtd_58
L_wt_57:
    buffer_store_dwordx4 v[80:83], v0, s[8:11], s40 offen offset:0 sc1
    buffer_store_dwordx4 v[84:87], v0, s[8:11], s40 offen offset:1024 sc1
    buffer_store_dwordx4 v[88:91], v0, s[8:11], s40 offen offset:2048 sc1
    buffer_store_dwordx4 v[92:95], v0, s[8:11], s40 offen offset:3072 sc1
L_wtd_58:
    s_mul_i32 s57, s19, 32768
    s_add_u32 s57, s57, 327680
    s_lshl_b32 s58, s16, 11
    s_add_u32 s57, s57, s58
    s_lshl_b32 s58, s17, 7
    s_add_u32 s57, s57, s58
    s_lshl_b32 s58, s3, 2
    s_add_u32 s57, s57, s58
    v_mov_b32 v4, 1
    v_mov_b32 v5, 0
    s_waitcnt vmcnt(0)
    s_mov_b64 exec, 1
    s_cmp_eq_u32 s39, 1
    s_cbranch_scc0 L_wt_59
    buffer_store_dword v4, v5, s[8:11], s57 offen
    s_branch L_wtd_60
L_wt_59:
    buffer_store_dword v4, v5, s[8:11], s57 offen sc1
L_wtd_60:
    s_mov_b64 exec, -1
    s_branch L_sp_join_54
L_sp_helper_53:
    s_mul_i32 s48, s19, 4194304
    s_add_u32 s48, s48, 22020096
    s_lshl_b32 s41, s17, 18
    s_add_u32 s48, s48, s41
    s_lshr_b32 s41, s45, 1
    s_lshl_b32 s49, s41, 12
    s_lshl_b32 s41, s41, 17
    s_add_u32 s48, s48, s41
    s_and_b32 s41, s45, 1
    s_lshl_b32 s41, s41, 11
    s_add_u32 s48, s48, s41
    s_add_u32 s49, s49, s41
    s_cmp_eq_u32 s18, 0
    s_cbranch_scc0 L_nopoll_61
    s_mul_i32 s54, s19, 32768
    s_add_u32 s54, s54, 262144
    s_lshl_b32 s55, s17, 7
    s_add_u32 s54, s54, s55
    v_and_b32 v5, 15, v1
    v_lshlrev_b32 v5, 11, v5
    s_mov_b32 s59, s36
L_poll_62:
    buffer_load_dword v10, v5, s[8:11], s54 offen sc1
    s_waitcnt vmcnt(0)
    v_cmp_eq_u32 vcc, 0, v10
    s_cbranch_vccz L_polld_63
    s_sub_u32 s59, s59, 1
    s_cmp_lg_u32 s59, 0
    s_cbranch_scc1 L_poll_62
    s_mov_b32 s36, 1
L_polld_63:
L_nopoll_61:
    s_barrier
    s_add_u32 s53, s52, 0
    s_and_b32 s53, s53, 31
    s_lshl_b32 s47, s53, 12
    s_add_u32 m0, s49, 98304
    s_add_u32 s47, s47, s48
    buffer_load_dwordx4 v0, s[8:11], s47 offen sc1 lds
    buffer_load_dwordx4 v0, s[8:11], s47 offen offset:1024 sc1 lds
    s_add_u32 s53, s52, 1
    s_and_b32 s53, s53, 31
    s_lshl_b32 s47, s53, 12
    s_add_u32 m0, s49, 106496
    s_add_u32 s47, s47, s48
    buffer_load_dwordx4 v0, s[8:11], s47 offen sc1 lds
    buffer_load_dwordx4 v0, s[8:11], s47 offen offset:1024 sc1 lds
    s_add_u32 s53, s52, 2
    s_and_b32 s53, s53, 31
    s_lshl_b32 s47, s53, 12
    s_add_u32 m0, s49, 114688
    s_add_u32 s47, s47, s48
    buffer_load_dwordx4 v0, s[8:11], s47 offen sc1 lds
    buffer_load_dwordx4 v0, s[8:11], s47 offen offset:1024 sc1 lds
    s_add_u32 s53, s52, 3
    s_and_b32 s53, s53, 31
    s_lshl_b32 s47, s53, 12
    s_add_u32 m0, s49, 122880
    s_add_u32 s47, s47, s48
    buffer_load_dwordx4 v0, s[8:11], s47 offen sc1 lds
    buffer_load_dwordx4 v0, s[8:11], s47 offen offset:1024 sc1 lds
    s_add_u32 s53, s52, 4
    s_and_b32 s53, s53, 31
    s_lshl_b32 s47, s53, 12
    s_add_u32 m0, s49, 131072
    s_add_u32 s47, s47, s48
    buffer_load_dwordx4 v0, s[8:11], s47 offen sc1 lds
    buffer_load_dwordx4 v0, s[8:11], s47 offen offset:1024 sc1 lds
    s_waitcnt vmcnt(8)
    s_barrier
    s_add_u32 s53, s52, 5
    s_and_b32 s53, s53, 31
    s_lshl_b32 s51, s53, 7
    s_add_u32 s51, s51, s44
    s_lshl_b32 s46, s45, 12
    s_add_u32 m0, s46, 81920
    s_add_u32 s47, s51, 0
    buffer_load_dwordx4 v6, s[12:15], s47 offen lds
    s_add_u32 m0, m0, 1024
    s_add_u32 s47, s51, 16384
    buffer_load_dwordx4 v7, s[12:15], s47 offen lds
    s_add_u32 m0, m0, 1024
    s_add_u32 s47, s51, 65536
    buffer_load_dwordx4 v6, s[12:15], s47 offen lds
    s_add_u32 m0, m0, 1024
    s_add_u32 s47, s51, 81920
    buffer_load_dwordx4 v7, s[12:15], s47 offen lds
    s_add_u32 s53, s52, 5
    s_and_b32 s53, s53, 31
    s_lshl_b32 s47, s53, 12
    s_add_u32 m0, s49, 139264
    s_add_u32 s47, s47, s48
    buffer_load_dwordx4 v0, s[8:11], s47 offen sc1 lds
    buffer_load_dwordx4 v0, s[8:11], s47 offen offset:1024 sc1 lds
    s_waitcnt vmcnt(12)
    s_barrier
    s_add_u32 s53, s52, 6
    s_and_b32 s53, s53, 31
    s_lshl_b32 s51, s53, 7
    s_add_u32 s51, s51, s44
    s_lshl_b32 s46, s45, 12
    s_add_u32 m0, s46, 0
    s_add_u32 s47, s51, 0
    buffer_load_dwordx4 v6, s[12:15], s47 offen lds
    s_add_u32 m0, m0, 1024
    s_add_u32 s47, s51, 16384
    buffer_load_dwordx4 v7, s[12:15], s47 offen lds
    s_add_u32 m0, m0, 1024
    s_add_u32 s47, s51, 65536
    buffer_load_dwordx4 v6, s[12:15], s47 offen lds
    s_add_u32 m0, m0, 1024
    s_add_u32 s47, s51, 81920
    buffer_load_dwordx4 v7, s[12:15], s47 offen lds
    s_add_u32 s53, s52, 6
    s_and_b32 s53, s53, 31
    s_lshl_b32 s47, s53, 12
    s_add_u32 m0, s49, 98304
    s_add_u32 s47, s47, s48
    buffer_load_dwordx4 v0, s[8:11], s47 offen sc1 lds
    buffer_load_dwordx4 v0, s[8:11], s47 offen offset:1024 sc1 lds
    s_waitcnt vmcnt(16)
    s_barrier
    s_add_u32 s53, s52, 7
    s_and_b32 s53, s53, 31
    s_lshl_b32 s51, s53, 7
    s_add_u32 s51, s51, s44
    s_lshl_b32 s46, s45, 12
    s_add_u32 m0, s46, 16384
    s_add_u32 s47, s51, 0
    buffer_load_dwordx4 v6, s[12:15], s47 offen lds
    s_add_u32 m0, m0, 1024
    s_add_u32 s47, s51, 16384
    buffer_load_dwordx4 v7, s[12:15], s47 offen lds
    s_add_u32 m0, m0, 1024
    s_add_u32 s47, s51, 65536
    buffer_load_dwordx4 v6, s[12:15], s47 offen lds
    s_add_u32 m0, m0, 1024
    s_add_u32 s47, s51, 81920
    buffer_load_dwordx4 v7, s[12:15], s47 offen lds
    s_add_u32 s53, s52, 7
    s_and_b32 s53, s53, 31
    s_lshl_b32 s47, s53, 12
    s_add_u32 m0, s49, 106496
    s_add_u32 s47, s47, s48
    buffer_load_dwordx4 v0, s[8:11], s47 offen sc1 lds
    buffer_load_dwordx4 v0, s[8:11], s47 offen offset:1024 sc1 lds
    s_waitcnt vmcnt(20)
    s_barrier
    s_add_u32 s53, s52, 8
    s_and_b32 s53, s53, 31
    s_lshl_b32 s51, s53, 7
    s_add_u32 s51, s51, s44
    s_lshl_b32 s46, s45, 12
    s_add_u32 m0, s46, 32768
    s_add_u32 s47, s51, 0
    buffer_load_dwordx4 v6, s[12:15], s47 offen lds
    s_add_u32 m0, m0, 1024
    s_add_u32 s47, s51, 16384
    buffer_load_dwordx4 v7, s[12:15], s47 offen lds
    s_add_u32 m0, m0, 1024
    s_add_u32 s47, s51, 65536
    buffer_load_dwordx4 v6, s[12:15], s47 offen lds
    s_add_u32 m0, m0, 1024
    s_add_u32 s47, s51, 81920
    buffer_load_dwordx4 v7, s[12:15], s47 offen lds
    s_add_u32 s53, s52, 8
    s_and_b32 s53, s53, 31
    s_lshl_b32 s47, s53, 12
    s_add_u32 m0, s49, 114688
    s_add_u32 s47, s47, s48
    buffer_load_dwordx4 v0, s[8:11], s47 offen sc1 lds
    buffer_load_dwordx4 v0, s[8:11], s47 offen offset:1024 sc1 lds
    s_waitcnt vmcnt(24)
    s_barrier
    s_add_u32 s53, s52, 9
    s_and_b32 s53, s53, 31
    s_lshl_b32 s51, s53, 7
    s_add_u32 s51, s51, s44
    s_lshl_b32 s46, s45, 12
    s_add_u32 m0, s46, 49152
    s_add_u32 s47, s51, 0
    buffer_load_dwordx4 v6, s[12:15], s47 offen lds
    s_add_u32 m0, m0, 1024
    s_add_u32 s47, s51, 16384
    buffer_load_dwordx4 v7, s[12:15], s47 offen lds
    s_add_u32 m0, m0, 1024
    s_add_u32 s47, s51, 65536
    buffer_load_dwordx4 v6, s[12:15], s47 offen lds
    s_add_u32 m0, m0, 1024
    s_add_u32 s47, s51, 81920
    buffer_load_dwordx4 v7, s[12:15], s47 offen lds
    s_add_u32 s53, s52, 9
    s_and_b32 s53, s53, 31
    s_lshl_b32 s47, s53, 12
    s_add_u32 m0, s49, 122880
    s_add_u32 s47, s47, s48
    buffer_load_dwordx4 v0, s[8:11], s47 offen sc1 lds
    buffer_load_dwordx4 v0, s[8:11], s47 offen offset:1024 sc1 lds
    s_waitcnt vmcnt(24)
    s_barrier
    s_add_u32 s53, s52, 10
    s_and_b32 s53, s53, 31
    s_lshl_b32 s51, s53, 7
    s_add_u32 s51, s51, s44
    s_lshl_b32 s46, s45, 12
    s_add_u32 m0, s46, 65536
    s_add_u32 s47, s51, 0
    buffer_load_dwordx4 v6, s[12:15], s47 offen lds
    s_add_u32 m0, m0, 1024
    s_add_u32 s47, s51, 16384
    buffer_load_dwordx4 v7, s[12:15], s47 offen lds
    s_add_u32 m0, m0, 1024
    s_add_u32 s47, s51, 65536
    buffer_load_dwordx4 v6, s[12:15], s47 offen lds
    s_add_u32 m0, m0, 1024
    s_add_u32 s47, s51, 81920
    buffer_load_dwordx4 v7, s[12:15], s47 offen lds
    s_add_u32 s53, s52, 10
    s_and_b32 s53, s53, 31
    s_lshl_b32 s47, s53, 12
    s_add_u32 m0, s49, 131072
    s_add_u32 s47, s47, s48
    buffer_load_dwordx4 v0, s[8:11], s47 offen sc1 lds
    buffer_load_dwordx4 v0, s[8:11], s47 offen offset:1024 sc1 lds
    s_waitcnt vmcnt(24)
    s_barrier
    s_add_u32 s53, s52, 11
    s_and_b32 s53, s53, 31
    s_lshl_b32 s51, s53, 7
    s_add_u32 s51, s51, s44
    s_lshl_b32 s46, s45, 12
    s_add_u32 m0, s46, 81920
    s_add_u32 s47, s51, 0
    buffer_load_dwordx4 v6, s[12:15], s47 offen lds
    s_add_u32 m0, m0, 1024
    s_add_u32 s47, s51, 16384
    buffer_load_dwordx4 v7, s[12:15], s47 offen lds
    s_add_u32 m0, m0, 1024
    s_add_u32 s47, s51, 65536
    buffer_load_dwordx4 v6, s[12:15], s47 offen lds
    s_add_u32 m0, m0, 1024
    s_add_u32 s47, s51, 81920
    buffer_load_dwordx4 v7, s[12:15], s47 offen lds
    s_add_u32 s53, s52, 11
    s_and_b32 s53, s53, 31
    s_lshl_b32 s47, s53, 12
    s_add_u32 m0, s49, 139264
    s_add_u32 s47, s47, s48
    buffer_load_dwordx4 v0, s[8:11], s47 offen sc1 lds
    buffer_load_dwordx4 v0, s[8:11], s47 offen offset:1024 sc1 lds
    s_waitcnt vmcnt(24)
    s_barrier
    s_add_u32 s53, s52, 12
    s_and_b32 s53, s53, 31
    s_lshl_b32 s51, s53, 7
    s_add_u32 s51, s51, s44
    s_lshl_b32 s46, s45, 12
    s_add_u32 m0, s46, 0
    s_add_u32 s47, s51, 0
    buffer_load_dwordx4 v6, s[12:15], s47 offen lds
    s_add_u32 m0, m0, 1024
    s_add_u32 s47, s51, 16384
    buffer_load_dwordx4 v7, s[12:15], s47 offen lds
    s_add_u32 m0, m0, 1024
    s_add_u32 s47, s51, 65536
    buffer_load_dwordx4 v6, s[12:15], s47 offen lds
    s_add_u32 m0, m0, 1024
    s_add_u32 s47, s51, 81920
    buffer_load_dwordx4 v7, s[12:15], s47 offen lds
    s_add_u32 s53, s52, 12
    s_and_b32 s53, s53, 31
    s_lshl_b32 s47, s53, 12
    s_add_u32 m0, s49, 98304
    s_add_u32 s47, s47, s48
    buffer_load_dwordx4 v0, s[8:11], s47 offen sc1 lds
    buffer_load_dwordx4 v0, s[8:11], s47 offen offset:1024 sc1 lds
    s_waitcnt vmcnt(24)
    s_barrier
    s_add_u32 s53, s52, 13
    s_and_b32 s53, s53, 31
    s_lshl_b32 s51, s53, 7
    s_add_u32 s51, s51, s44
    s_lshl_b32 s46, s45, 12
    s_add_u32 m0, s46, 16384
    s_add_u32 s47, s51, 0
    buffer_load_dwordx4 v6, s[12:15], s47 offen lds
    s_add_u32 m0, m0, 1024
    s_add_u32 s47, s51, 16384
    buffer_load_dwordx4 v7, s[12:15], s47 offen lds
    s_add_u32 m0, m0, 1024
    s_add_u32 s47, s51, 65536
    buffer_load_dwordx4 v6, s[12:15], s47 offen lds
    s_add_u32 m0, m0, 1024
    s_add_u32 s47, s51, 81920
    buffer_load_dwordx4 v7, s[12:15], s47 offen lds
    s_add_u32 s53, s52, 13
    s_and_b32 s53, s53, 31
    s_lshl_b32 s47, s53, 12
    s_add_u32 m0, s49, 106496
    s_add_u32 s47, s47, s48
    buffer_load_dwordx4 v0, s[8:11], s47 offen sc1 lds
    buffer_load_dwordx4 v0, s[8:11], s47 offen offset:1024 sc1 lds
    s_waitcnt vmcnt(24)
    s_barrier
    s_add_u32 s53, s52, 14
    s_and_b32 s53, s53, 31
    s_lshl_b32 s51, s53, 7
    s_add_u32 s51, s51, s44
    s_lshl_b32 s46, s45, 12
    s_add_u32 m0, s46, 32768
    s_add_u32 s47, s51, 0
    buffer_load_dwordx4 v6, s[12:15], s47 offen lds
    s_add_u32 m0, m0, 1024
    s_add_u32 s47, s51, 16384
    buffer_load_dwordx4 v7, s[12:15], s47 offen lds
    s_add_u32 m0, m0, 1024
    s_add_u32 s47, s51, 65536
    buffer_load_dwordx4 v6, s[12:15], s47 offen lds
    s_add_u32 m0, m0, 1024
    s_add_u32 s47, s51, 81920
    buffer_load_dwordx4 v7, s[12:15], s47 offen lds
    s_add_u32 s53, s52, 14
    s_and_b32 s53, s53, 31
    s_lshl_b32 s47, s53, 12
    s_add_u32 m0, s49, 114688
    s_add_u32 s47, s47, s48
    buffer_load_dwordx4 v0, s[8:11], s47 offen sc1 lds
    buffer_load_dwordx4 v0, s[8:11], s47 offen offset:1024 sc1 lds
    s_waitcnt vmcnt(24)
    s_barrier
    s_add_u32 s53, s52, 15
    s_and_b32 s53, s53, 31
    s_lshl_b32 s51, s53, 7
    s_add_u32 s51, s51, s44
    s_lshl_b32 s46, s45, 12
    s_add_u32 m0, s46, 49152
    s_add_u32 s47, s51, 0
    buffer_load_dwordx4 v6, s[12:15], s47 offen lds
    s_add_u32 m0, m0, 1024
    s_add_u32 s47, s51, 16384
    buffer_load_dwordx4 v7, s[12:15], s47 offen lds
    s_add_u32 m0, m0, 1024
    s_add_u32 s47, s51, 65536
    buffer_load_dwordx4 v6, s[12:15], s47 offen lds
    s_add_u32 m0, m0, 1024
    s_add_u32 s47, s51, 81920
    buffer_load_dwordx4 v7, s[12:15], s47 offen lds
    s_add_u32 s53, s52, 15
    s_and_b32 s53, s53, 31
    s_lshl_b32 s47, s53, 12
    s_add_u32 m0, s49, 122880
    s_add_u32 s47, s47, s48
    buffer_load_dwordx4 v0, s[8:11], s47 offen sc1 lds
    buffer_load_dwordx4 v0, s[8:11], s47 offen offset:1024 sc1 lds
    s_waitcnt vmcnt(24)
    s_barrier
    s_add_u32 s53, s52, 16
    s_and_b32 s53, s53, 31
    s_lshl_b32 s51, s53, 7
    s_add_u32 s51, s51, s44
    s_lshl_b32 s46, s45, 12
    s_add_u32 m0, s46, 65536
    s_add_u32 s47, s51, 0
    buffer_load_dwordx4 v6, s[12:15], s47 offen lds
    s_add_u32 m0, m0, 1024
    s_add_u32 s47, s51, 16384
    buffer_load_dwordx4 v7, s[12:15], s47 offen lds
    s_add_u32 m0, m0, 1024
    s_add_u32 s47, s51, 65536
    buffer_load_dwordx4 v6, s[12:15], s47 offen lds
    s_add_u32 m0, m0, 1024
    s_add_u32 s47, s51, 81920
    buffer_load_dwordx4 v7, s[12:15], s47 offen lds
    s_add_u32 s53, s52, 16
    s_and_b32 s53, s53, 31
    s_lshl_b32 s47, s53, 12
    s_add_u32 m0, s49, 131072
    s_add_u32 s47, s47, s48
    buffer_load_dwordx4 v0, s[8:11], s47 offen sc1 lds
    buffer_load_dwordx4 v0, s[8:11], s47 offen offset:1024 sc1 lds
    s_waitcnt vmcnt(24)
    s_barrier
    s_add_u32 s53, s52, 17
    s_and_b32 s53, s53, 31
    s_lshl_b32 s51, s53, 7
    s_add_u32 s51, s51, s44
    s_lshl_b32 s46, s45, 12
    s_add_u32 m0, s46, 81920
    s_add_u32 s47, s51, 0
    buffer_load_dwordx4 v6, s[12:15], s47 offen lds
    s_add_u32 m0, m0, 1024
    s_add_u32 s47, s51, 16384
    buffer_load_dwordx4 v7, s[12:15], s47 offen lds
    s_add_u32 m0, m0, 1024
    s_add_u32 s47, s51, 65536
    buffer_load_dwordx4 v6, s[12:15], s47 offen lds
    s_add_u32 m0, m0, 1024
    s_add_u32 s47, s51, 81920
    buffer_load_dwordx4 v7, s[12:15], s47 offen lds
    s_add_u32 s53, s52, 17
    s_and_b32 s53, s53, 31
    s_lshl_b32 s47, s53, 12
    s_add_u32 m0, s49, 139264
    s_add_u32 s47, s47, s48
    buffer_load_dwordx4 v0, s[8:11], s47 offen sc1 lds
    buffer_load_dwordx4 v0, s[8:11], s47 offen offset:1024 sc1 lds
    s_waitcnt vmcnt(24)
    s_barrier
    s_add_u32 s53, s52, 18
    s_and_b32 s53, s53, 31
    s_lshl_b32 s51, s53, 7
    s_add_u32 s51, s51, s44
    s_lshl_b32 s46, s45, 12
    s_add_u32 m0, s46, 0
    s_add_u32 s47, s51, 0
    buffer_load_dwordx4 v6, s[12:15], s47 offen lds
    s_add_u32 m0, m0, 1024
    s_add_u32 s47, s51, 16384
    buffer_load_dwordx4 v7, s[12:15], s47 offen lds
    s_add_u32 m0, m0, 1024
    s_add_u32 s47, s51, 65536
    buffer_load_dwordx4 v6, s[12:15], s47 offen lds
    s_add_u32 m0, m0, 1024
    s_add_u32 s47, s51, 81920
    buffer_load_dwordx4 v7, s[12:15], s47 offen lds
    s_add_u32 s53, s52, 18
    s_and_b32 s53, s53, 31
    s_lshl_b32 s47, s53, 12
    s_add_u32 m0, s49, 98304
    s_add_u32 s47, s47, s48
    buffer_load_dwordx4 v0, s[8:11], s47 offen sc1 lds
    buffer_load_dwordx4 v0, s[8:11], s47 offen offset:1024 sc1 lds
    s_waitcnt vmcnt(24)
    s_barrier
    s_add_u32 s53, s52, 19
    s_and_b32 s53, s53, 31
    s_lshl_b32 s51, s53, 7
    s_add_u32 s51, s51, s44
    s_lshl_b32 s46, s45, 12
    s_add_u32 m0, s46, 16384
    s_add_u32 s47, s51, 0
    buffer_load_dwordx4 v6, s[12:15], s47 offen lds
    s_add_u32 m0, m0, 1024
    s_add_u32 s47, s51, 16384
    buffer_load_dwordx4 v7, s[12:15], s47 offen lds
    s_add_u32 m0, m0, 1024
    s_add_u32 s47, s51, 65536
    buffer_load_dwordx4 v6, s[12:15], s47 offen lds
    s_add_u32 m0, m0, 1024
    s_add_u32 s47, s51, 81920
    buffer_load_dwordx4 v7, s[12:15], s47 offen lds
    s_add_u32 s53, s52, 19
    s_and_b32 s53, s53, 31
    s_lshl_b32 s47, s53, 12
    s_add_u32 m0, s49, 106496
    s_add_u32 s47, s47, s48
    buffer_load_dwordx4 v0, s[8:11], s47 offen sc1 lds
    buffer_load_dwordx4 v0, s[8:11], s47 offen offset:1024 sc1 lds
    s_waitcnt vmcnt(24)
    s_barrier
    s_add_u32 s53, s52, 20
    s_and_b32 s53, s53, 31
    s_lshl_b32 s51, s53, 7
    s_add_u32 s51, s51, s44
    s_lshl_b32 s46, s45, 12
    s_add_u32 m0, s46, 32768
    s_add_u32 s47, s51, 0
    buffer_load_dwordx4 v6, s[12:15], s47 offen lds
    s_add_u32 m0, m0, 1024
    s_add_u32 s47, s51, 16384
    buffer_load_dwordx4 v7, s[12:15], s47 offen lds
    s_add_u32 m0, m0, 1024
    s_add_u32 s47, s51, 65536
    buffer_load_dwordx4 v6, s[12:15], s47 offen lds
    s_add_u32 m0, m0, 1024
    s_add_u32 s47, s51, 81920
    buffer_load_dwordx4 v7, s[12:15], s47 offen lds
    s_add_u32 s53, s52, 20
    s_and_b32 s53, s53, 31
    s_lshl_b32 s47, s53, 12
    s_add_u32 m0, s49, 114688
    s_add_u32 s47, s47, s48
    buffer_load_dwordx4 v0, s[8:11], s47 offen sc1 lds
    buffer_load_dwordx4 v0, s[8:11], s47 offen offset:1024 sc1 lds
    s_waitcnt vmcnt(24)
    s_barrier
    s_add_u32 s53, s52, 21
    s_and_b32 s53, s53, 31
    s_lshl_b32 s51, s53, 7
    s_add_u32 s51, s51, s44
    s_lshl_b32 s46, s45, 12
    s_add_u32 m0, s46, 49152
    s_add_u32 s47, s51, 0
    buffer_load_dwordx4 v6, s[12:15], s47 offen lds
    s_add_u32 m0, m0, 1024
    s_add_u32 s47, s51, 16384
    buffer_load_dwordx4 v7, s[12:15], s47 offen lds
    s_add_u32 m0, m0, 1024
    s_add_u32 s47, s51, 65536
    buffer_load_dwordx4 v6, s[12:15], s47 offen lds
    s_add_u32 m0, m0, 1024
    s_add_u32 s47, s51, 81920
    buffer_load_dwordx4 v7, s[12:15], s47 offen lds
    s_add_u32 s53, s52, 21
    s_and_b32 s53, s53, 31
    s_lshl_b32 s47, s53, 12
    s_add_u32 m0, s49, 122880
    s_add_u32 s47, s47, s48
    buffer_load_dwordx4 v0, s[8:11], s47 offen sc1 lds
    buffer_load_dwordx4 v0, s[8:11], s47 offen offset:1024 sc1 lds
    s_waitcnt vmcnt(24)
    s_barrier
    s_add_u32 s53, s52, 22
    s_and_b32 s53, s53, 31
    s_lshl_b32 s51, s53, 7
    s_add_u32 s51, s51, s44
    s_lshl_b32 s46, s45, 12
    s_add_u32 m0, s46, 65536
    s_add_u32 s47, s51, 0
    buffer_load_dwordx4 v6, s[12:15], s47 offen lds
    s_add_u32 m0, m0, 1024
    s_add_u32 s47, s51, 16384
    buffer_load_dwordx4 v7, s[12:15], s47 offen lds
    s_add_u32 m0, m0, 1024
    s_add_u32 s47, s51, 65536
    buffer_load_dwordx4 v6, s[12:15], s47 offen lds
    s_add_u32 m0, m0, 1024
    s_add_u32 s47, s51, 81920
    buffer_load_dwordx4 v7, s[12:15], s47 offen lds
    s_add_u32 s53, s52, 22
    s_and_b32 s53, s53, 31
    s_lshl_b32 s47, s53, 12
    s_add_u32 m0, s49, 131072
    s_add_u32 s47, s47, s48
    buffer_load_dwordx4 v0, s[8:11], s47 offen sc1 lds
    buffer_load_dwordx4 v0, s[8:11], s47 offen offset:1024 sc1 lds
    s_waitcnt vmcnt(24)
    s_barrier
    s_add_u32 s53, s52, 23
    s_and_b32 s53, s53, 31
    s_lshl_b32 s51, s53, 7
    s_add_u32 s51, s51, s44
    s_lshl_b32 s46, s45, 12
    s_add_u32 m0, s46, 81920
    s_add_u32 s47, s51, 0
    buffer_load_dwordx4 v6, s[12:15], s47 offen lds
    s_add_u32 m0, m0, 1024
    s_add_u32 s47, s51, 16384
    buffer_load_dwordx4 v7, s[12:15], s47 offen lds
    s_add_u32 m0, m0, 1024
    s_add_u32 s47, s51, 65536
    buffer_load_dwordx4 v6, s[12:15], s47 offen lds
    s_add_u32 m0, m0, 1024
    s_add_u32 s47, s51, 81920
    buffer_load_dwordx4 v7, s[12:15], s47 offen lds
    s_add_u32 s53, s52, 23
    s_and_b32 s53, s53, 31
    s_lshl_b32 s47, s53, 12
    s_add_u32 m0, s49, 139264
    s_add_u32 s47, s47, s48
    buffer_load_dwordx4 v0, s[8:11], s47 offen sc1 lds
    buffer_load_dwordx4 v0, s[8:11], s47 offen offset:1024 sc1 lds
    s_waitcnt vmcnt(24)
    s_barrier
    s_add_u32 s53, s52, 24
    s_and_b32 s53, s53, 31
    s_lshl_b32 s51, s53, 7
    s_add_u32 s51, s51, s44
    s_lshl_b32 s46, s45, 12
    s_add_u32 m0, s46, 0
    s_add_u32 s47, s51, 0
    buffer_load_dwordx4 v6, s[12:15], s47 offen lds
    s_add_u32 m0, m0, 1024
    s_add_u32 s47, s51, 16384
    buffer_load_dwordx4 v7, s[12:15], s47 offen lds
    s_add_u32 m0, m0, 1024
    s_add_u32 s47, s51, 65536
    buffer_load_dwordx4 v6, s[12:15], s47 offen lds
    s_add_u32 m0, m0, 1024
    s_add_u32 s47, s51, 81920
    buffer_load_dwordx4 v7, s[12:15], s47 offen lds
    s_add_u32 s53, s52, 24
    s_and_b32 s53, s53, 31
    s_lshl_b32 s47, s53, 12
    s_add_u32 m0, s49, 98304
    s_add_u32 s47, s47, s48
    buffer_load_dwordx4 v0, s[8:11], s47 offen sc1 lds
    buffer_load_dwordx4 v0, s[8:11], s47 offen offset:1024 sc1 lds
    s_waitcnt vmcnt(24)
    s_barrier
    s_add_u32 s53, s52, 25
    s_and_b32 s53, s53, 31
    s_lshl_b32 s51, s53, 7
    s_add_u32 s51, s51, s44
    s_lshl_b32 s46, s45, 12
    s_add_u32 m0, s46, 16384
    s_add_u32 s47, s51, 0
    buffer_load_dwordx4 v6, s[12:15], s47 offen lds
    s_add_u32 m0, m0, 1024
    s_add_u32 s47, s51, 16384
    buffer_load_dwordx4 v7, s[12:15], s47 offen lds
    s_add_u32 m0, m0, 1024
    s_add_u32 s47, s51, 65536
    buffer_load_dwordx4 v6, s[12:15], s47 offen lds
    s_add_u32 m0, m0, 1024
    s_add_u32 s47, s51, 81920
    buffer_load_dwordx4 v7, s[12:15], s47 offen lds
    s_add_u32 s53, s52, 25
    s_and_b32 s53, s53, 31
    s_lshl_b32 s47, s53, 12
    s_add_u32 m0, s49, 106496
    s_add_u32 s47, s47, s48
    buffer_load_dwordx4 v0, s[8:11], s47 offen sc1 lds
    buffer_load_dwordx4 v0, s[8:11], s47 offen offset:1024 sc1 lds
    s_waitcnt vmcnt(24)
    s_barrier
    s_add_u32 s53, s52, 26
    s_and_b32 s53, s53, 31
    s_lshl_b32 s51, s53, 7
    s_add_u32 s51, s51, s44
    s_lshl_b32 s46, s45, 12
    s_add_u32 m0, s46, 32768
    s_add_u32 s47, s51, 0
    buffer_load_dwordx4 v6, s[12:15], s47 offen lds
    s_add_u32 m0, m0, 1024
    s_add_u32 s47, s51, 16384
    buffer_load_dwordx4 v7, s[12:15], s47 offen lds
    s_add_u32 m0, m0, 1024
    s_add_u32 s47, s51, 65536
    buffer_load_dwordx4 v6, s[12:15], s47 offen lds
    s_add_u32 m0, m0, 1024
    s_add_u32 s47, s51, 81920
    buffer_load_dwordx4 v7, s[12:15], s47 offen lds
    s_add_u32 s53, s52, 26
    s_and_b32 s53, s53, 31
    s_lshl_b32 s47, s53, 12
    s_add_u32 m0, s49, 114688
    s_add_u32 s47, s47, s48
    buffer_load_dwordx4 v0, s[8:11], s47 offen sc1 lds
    buffer_load_dwordx4 v0, s[8:11], s47 offen offset:1024 sc1 lds
    s_waitcnt vmcnt(24)
    s_barrier
    s_add_u32 s53, s52, 27
    s_and_b32 s53, s53, 31
    s_lshl_b32 s51, s53, 7
    s_add_u32 s51, s51, s44
    s_lshl_b32 s46, s45, 12
    s_add_u32 m0, s46, 49152
    s_add_u32 s47, s51, 0
    buffer_load_dwordx4 v6, s[12:15], s47 offen lds
    s_add_u32 m0, m0, 1024
    s_add_u32 s47, s51, 16384
    buffer_load_dwordx4 v7, s[12:15], s47 offen lds
    s_add_u32 m0, m0, 1024
    s_add_u32 s47, s51, 65536
    buffer_load_dwordx4 v6, s[12:15], s47 offen lds
    s_add_u32 m0, m0, 1024
    s_add_u32 s47, s51, 81920
    buffer_load_dwordx4 v7, s[12:15], s47 offen lds
    s_add_u32 s53, s52, 27
    s_and_b32 s53, s53, 31
    s_lshl_b32 s47, s53, 12
    s_add_u32 m0, s49, 122880
    s_add_u32 s47, s47, s48
    buffer_load_dwordx4 v0, s[8:11], s47 offen sc1 lds
    buffer_load_dwordx4 v0, s[8:11], s47 offen offset:1024 sc1 lds
    s_waitcnt vmcnt(24)
    s_barrier
    s_add_u32 s53, s52, 28
    s_and_b32 s53, s53, 31
    s_lshl_b32 s51, s53, 7
    s_add_u32 s51, s51, s44
    s_lshl_b32 s46, s45, 12
    s_add_u32 m0, s46, 65536
    s_add_u32 s47, s51, 0
    buffer_load_dwordx4 v6, s[12:15], s47 offen lds
    s_add_u32 m0, m0, 1024
    s_add_u32 s47, s51, 16384
    buffer_load_dwordx4 v7, s[12:15], s47 offen lds
    s_add_u32 m0, m0, 1024
    s_add_u32 s47, s51, 65536
    buffer_load_dwordx4 v6, s[12:15], s47 offen lds
    s_add_u32 m0, m0, 1024
    s_add_u32 s47, s51, 81920
    buffer_load_dwordx4 v7, s[12:15], s47 offen lds
    s_add_u32 s53, s52, 28
    s_and_b32 s53, s53, 31
    s_lshl_b32 s47, s53, 12
    s_add_u32 m0, s49, 131072
    s_add_u32 s47, s47, s48
    buffer_load_dwordx4 v0, s[8:11], s47 offen sc1 lds
    buffer_load_dwordx4 v0, s[8:11], s47 offen offset:1024 sc1 lds
    s_waitcnt vmcnt(24)
    s_barrier
    s_add_u32 s53, s52, 29
    s_and_b32 s53, s53, 31
    s_lshl_b32 s51, s53, 7
    s_add_u32 s51, s51, s44
    s_lshl_b32 s46, s45, 12
    s_add_u32 m0, s46, 81920
    s_add_u32 s47, s51, 0
    buffer_load_dwordx4 v6, s[12:15], s47 offen lds
    s_add_u32 m0, m0, 1024
    s_add_u32 s47, s51, 16384
    buffer_load_dwordx4 v7, s[12:15], s47 offen lds
    s_add_u32 m0, m0, 1024
    s_add_u32 s47, s51, 65536
    buffer_load_dwordx4 v6, s[12:15], s47 offen lds
    s_add_u32 m0, m0, 1024
    s_add_u32 s47, s51, 81920
    buffer_load_dwordx4 v7, s[12:15], s47 offen lds
    s_add_u32 s53, s52, 29
    s_and_b32 s53, s53, 31
    s_lshl_b32 s47, s53, 12
    s_add_u32 m0, s49, 139264
    s_add_u32 s47, s47, s48
    buffer_load_dwordx4 v0, s[8:11], s47 offen sc1 lds
    buffer_load_dwordx4 v0, s[8:11], s47 offen offset:1024 sc1 lds
    s_waitcnt vmcnt(24)
    s_barrier
    s_add_u32 s53, s52, 30
    s_and_b32 s53, s53, 31
    s_lshl_b32 s51, s53, 7
    s_add_u32 s51, s51, s44
    s_lshl_b32 s46, s45, 12
    s_add_u32 m0, s46, 0
    s_add_u32 s47, s51, 0
    buffer_load_dwordx4 v6, s[12:15], s47 offen lds
    s_add_u32 m0, m0, 1024
    s_add_u32 s47, s51, 16384
    buffer_load_dwordx4 v7, s[12:15], s47 offen lds
    s_add_u32 m0, m0, 1024
    s_add_u32 s47, s51, 65536
    buffer_load_dwordx4 v6, s[12:15], s47 offen lds
    s_add_u32 m0, m0, 1024
    s_add_u32 s47, s51, 81920
    buffer_load_dwordx4 v7, s[12:15], s47 offen lds
    s_add_u32 s53, s52, 30
    s_and_b32 s53, s53, 31
    s_lshl_b32 s47, s53, 12
    s_add_u32 m0, s49, 98304
    s_add_u32 s47, s47, s48
    buffer_load_dwordx4 v0, s[8:11], s47 offen sc1 lds
    buffer_load_dwordx4 v0, s[8:11], s47 offen offset:1024 sc1 lds
    s_waitcnt vmcnt(24)
    s_barrier
    s_add_u32 s53, s52, 31
    s_and_b32 s53, s53, 31
    s_lshl_b32 s51, s53, 7
    s_add_u32 s51, s51, s44
    s_lshl_b32 s46, s45, 12
    s_add_u32 m0, s46, 16384
    s_add_u32 s47, s51, 0
    buffer_load_dwordx4 v6, s[12:15], s47 offen lds
    s_add_u32 m0, m0, 1024
    s_add_u32 s47, s51, 16384
    buffer_load_dwordx4 v7, s[12:15], s47 offen lds
    s_add_u32 m0, m0, 1024
    s_add_u32 s47, s51, 65536
    buffer_load_dwordx4 v6, s[12:15], s47 offen lds
    s_add_u32 m0, m0, 1024
    s_add_u32 s47, s51, 81920
    buffer_load_dwordx4 v7, s[12:15], s47 offen lds
    s_add_u32 s53, s52, 31
    s_and_b32 s53, s53, 31
    s_lshl_b32 s47, s53, 12
    s_add_u32 m0, s49, 106496
    s_add_u32 s47, s47, s48
    buffer_load_dwordx4 v0, s[8:11], s47 offen sc1 lds
    buffer_load_dwordx4 v0, s[8:11], s47 offen offset:1024 sc1 lds
    s_waitcnt vmcnt(24)
    s_barrier
    s_waitcnt vmcnt(18)
    s_barrier
    s_waitcnt vmcnt(12)
    s_barrier
    s_waitcnt vmcnt(6)
    s_barrier
    s_waitcnt vmcnt(0)
    s_barrier
    s_barrier
    s_lshl_b32 s40, s45, 10
    v_add_u32 v2, s40, v0
    v_add_u32 v3, 0x10000, v2
    ds_write_b128 v2, v[16:19] offset:0
    ds_write_b128 v2, v[20:23] offset:4096
    ds_write_b128 v2, v[24:27] offset:8192
    ds_write_b128 v2, v[28:31] offset:12288
    ds_write_b128 v2, v[32:35] offset:16384
    ds_write_b128 v2, v[36:39] offset:20480
    ds_write_b128 v2, v[40:43] offset:24576
    ds_write_b128 v2, v[44:47] offset:28672
    ds_write_b128 v2, v[48:51] offset:32768
    ds_write_b128 v2, v[52:55] offset:36864
    ds_write_b128 v2, v[56:59] offset:40960
    ds_write_b128 v2, v[60:63] offset:45056
    ds_write_b128 v2, v[64:67] offset:49152
    ds_write_b128 v2, v[68:71] offset:53248
    ds_write_b128 v2, v[72:75] offset:57344
    ds_write_b128 v2, v[76:79] offset:61440
    ds_write_b128 v3, v[80:83] offset:0
    ds_write_b128 v3, v[84:87] offset:4096
    ds_write_b128 v3, v[88:91] offset:8192
    ds_write_b128 v3, v[92:95] offset:12288
    ds_write_b128 v3, v[96:99] offset:16384
    ds_write_b128 v3, v[100:103] offset:20480
    ds_write_b128 v3, v[104:107] offset:24576
    ds_write_b128 v3, v[108:111] offset:28672
    ds_write_b128 v3, v[112:115] offset:32768
    ds_write_b128 v3, v[116:119] offset:36864
    ds_write_b128 v3, v[120:123] offset:40960
    ds_write_b128 v3, v[124:127] offset:45056
L_sp_join_54:
    s_cmp_ge_u32 s18, 4
    s_cbranch_scc0 L_out_helper_64
    s_and_b32 s48, s3, 1
    s_lshr_b32 s49, s3, 1
    s_lshl_b32 s50, s37, 1
    s_add_u32 s50, s50, s48
    s_mov_b32 s51, s50
    s_lshl_b32 s45, s16, 2
    s_add_u32 s50, s50, s45
    s_mul_i32 s53, s50, 14
    s_lshl_b32 s45, s38, 1
    s_add_u32 s53, s53, s45
    s_add_u32 s53, s53, s49
    s_lshl_b32 s52, s53, 11
    s_mul_i32 s44, s2, 4194304
    s_add_u32 s44, s44, 3145728
    s_add_u32 s44, s44, s52
    buffer_load_dwordx4 v[200:203], v0, s[8:11], s44 offen sc1
    buffer_load_dwordx4 v[204:207], v0, s[8:11], s44 offen offset:1024 sc1
    v_lshrrev_b32 v2, 5, v1
    v_lshlrev_b32 v2, 2, v2
    v_bfe_u32 v3, v1, 2, 2
    v_add_u32 v2, v2, v3
    v_mul_u32_u24 v220, 128, v2
    v_bfe_u32 v3, v1, 4, 1
    v_lshlrev_b32 v3, 5, v3
    v_add_u32 v220, v220, v3
    v_and_b32 v3, 3, v1
    v_lshlrev_b32 v3, 3, v3
    v_add_u32 v220, v220, v3
    v_bfe_u32 v3, v1, 3, 1
    v_xor_b32 v3, s49, v3
    v_lshlrev_b32 v3, 6, v3
    v_add_u32 v220, v220, v3
    v_xor_b32 v221, 64, v220
    s_mul_i32 s45, s49, 57344
    v_add_u32 v220, s45, v220
    v_add_u32 v221, s45, v221
    s_mul_i32 s46, s2, 4194304
    s_add_u32 s46, s46, 30408704
    s_mul_i32 s45, s50, 57344
    s_add_u32 s46, s46, s45
    s_mul_i32 s45, s49, 28672
    s_add_u32 s46, s46, s45
    s_mul_i32 s44, s19, 32768
    s_add_u32 s44, s44, 327680
    s_lshl_b32 s45, s16, 11
    s_add_u32 s44, s44, s45
    s_mul_i32 s45, s49, 896
    s_add_u32 s44, s44, s45
    s_lshl_b32 s45, s51, 2
    s_add_u32 s44, s44, s45
    v_min_u32 v2, 6, v1
    v_lshlrev_b32 v2, 7, v2
    s_mov_b32 s59, s36
L_poll_66:
    buffer_load_dword v3, v2, s[8:11], s44 offen sc1
    s_waitcnt vmcnt(0)
    v_cmp_eq_u32 vcc, 0, v3
    s_cbranch_vccz L_polld_67
    s_sub_u32 s59, s59, 1
    s_cmp_lg_u32 s59, 0
    s_cbranch_scc1 L_poll_66
    s_mov_b32 s36, 1
L_polld_67:
    buffer_load_dwordx4 v[16:19], v0, s[8:11], s46 offen offset:0 sc1
    buffer_load_dwordx4 v[20:23], v0, s[8:11], s46 offen offset:1024 sc1
    buffer_load_dwordx4 v[24:27], v0, s[8:11], s46 offen offset:2048 sc1
    buffer_load_dwordx4 v[28:31], v0, s[8:11], s46 offen offset:3072 sc1
    s_add_u32 s46, s46, 4096
    buffer_load_dwordx4 v[32:35], v0, s[8:11], s46 offen offset:0 sc1
    buffer_load_dwordx4 v[36:39], v0, s[8:11], s46 offen offset:1024 sc1
    buffer_load_dwordx4 v[40:43], v0, s[8:11], s46 offen offset:2048 sc1
    buffer_load_dwordx4 v[44:47], v0, s[8:11], s46 offen offset:3072 sc1
    s_add_u32 s46, s46, 4096
    buffer_load_dwordx4 v[48:51], v0, s[8:11], s46 offen offset:0 sc1
    buffer_load_dwordx4 v[52:55], v0, s[8:11], s46 offen offset:1024 sc1
    s_barrier
    ds_read_b64_tr_b16 v[176:177], v220 offset:0
    ds_read_b64_tr_b16 v[178:179], v220 offset:1024
    ds_read_b64_tr_b16 v[180:181], v221 offset:0
    ds_read_b64_tr_b16 v[182:183], v221 offset:1024
    ds_read_b64_tr_b16 v[184:185], v220 offset:2048
    ds_read_b64_tr_b16 v[186:187], v220 offset:3072
    ds_read_b64_tr_b16 v[188:189], v221 offset:2048
    ds_read_b64_tr_b16 v[190:191], v221 offset:3072
    s_waitcnt vmcnt(9) lgkmcnt(4)
    v_mfma_f32_32x32x16_bf16 v[128:143], v[176:179], v[16:19], 0
    ds_read_b64_tr_b16 v[192:193], v220 offset:4096
    ds_read_b64_tr_b16 v[194:195], v220 offset:5120
    buffer_load_dwordx4 v[56:59], v0, s[8:11], s46 offen offset:2048 sc1
    v_mfma_f32_32x32x16_bf16 v[144:159], v[180:183], v[16:19], 0
    ds_read_b64_tr_b16 v[196:197], v221 offset:4096
    ds_read_b64_tr_b16 v[198:199], v221 offset:5120
    s_waitcnt vmcnt(9) lgkmcnt(4)
    v_mfma_f32_32x32x16_bf16 v[128:143], v[184:187], v[20:23], v[128:143]
    ds_read_b64_tr_b16 v[176:177], v220 offset:6144
    ds_read_b64_tr_b16 v[178:179], v220 offset:7168
    buffer_load_dwordx4 v[60:63], v0, s[8:11], s46 offen offset:3072 sc1
    v_mfma_f32_32x32x16_bf16 v[144:159], v[188:191], v[20:23], v[144:159]
    ds_read_b64_tr_b16 v[180:181], v221 offset:6144
    ds_read_b64_tr_b16 v[182:183], v221 offset:7168
    s_waitcnt vmcnt(9) lgkmcnt(4)
    v_mfma_f32_32x32x16_bf16 v[128:143], v[192:195], v[24:27], v[128:143]
    ds_read_b64_tr_b16 v[184:185], v220 offset:8192
    ds_read_b64_tr_b16 v[186:187], v220 offset:9216
    s_add_u32 s46, s46, 4096
    buffer_load_dwordx4 v[64:67], v0, s[8:11], s46 offen offset:0 sc1
    v_mfma_f32_32x32x16_bf16 v[144:159], v[196:199], v[24:27], v[144:159]
    ds_read_b64_tr_b16 v[188:189], v221 offset:8192
    ds_read_b64_tr_b16 v[190:191], v221 offset:9216
    s_waitcnt vmcnt(9) lgkmcnt(4)
    v_mfma_f32_32x32x16_bf16 v[128:143], v[176:179], v[28:31], v[128:143]
    ds_read_b64_tr_b16 v[192:193], v220 offset:10240
    ds_read_b64_tr_b16 v[194:195], v220 offset:11264
    buffer_load_dwordx4 v[68:71], v0, s[8:11], s46 offen offset:1024 sc1
    v_mfma_f32_32x32x16_bf16 v[144:159], v[180:183], v[28:31], v[144:159]
    ds_read_b64_tr_b16 v[196:197], v221 offset:10240
    ds_read_b64_tr_b16 v[198:199], v221 offset:11264
    s_waitcnt vmcnt(9) lgkmcnt(4)
    v_mfma_f32_32x32x16_bf16 v[128:143], v[184:187], v[32:35], v[128:143]
    ds_read_b64_tr_b16 v[176:177], v220 offset:12288
    ds_read_b64_tr_b16 v[178:179], v220 offset:13312
    buffer_load_dwordx4 v[72:75], v0, s[8:11], s46 offen offset:2048 sc1
    v_mfma_f32_32x32x16_bf16 v[144:159], v[188:191], v[32:35], v[144:159]
    ds_read_b64_tr_b16 v[180:181], v221 offset:12288
    ds_read_b64_tr_b16 v[182:183], v221 offset:13312
    s_waitcnt vmcnt(9) lgkmcnt(4)
    v_mfma_f32_32x32x16_bf16 v[128:143], v[192:195], v[36:39], v[128:143]
    ds_read_b64_tr_b16 v[184:185], v220 offset:14336
    ds_read_b64_tr_b16 v[186:187], v220 offset:15360
    buffer_load_dwordx4 v[76:79], v0, s[8:11], s46 offen offset:3072 sc1
    v_mfma_f32_32x32x16_bf16 v[144:159], v[196:199], v[36:39], v[144:159]
    ds_read_b64_tr_b16 v[188:189], v221 offset:14336
    ds_read_b64_tr_b16 v[190:191], v221 offset:15360
    s_waitcnt vmcnt(9) lgkmcnt(4)
    v_mfma_f32_32x32x16_bf16 v[128:143], v[176:179], v[40:43], v[128:143]
    ds_read_b64_tr_b16 v[192:193], v220 offset:16384
    ds_read_b64_tr_b16 v[194:195], v220 offset:17408
    s_add_u32 s46, s46, 4096
    buffer_load_dwordx4 v[80:83], v0, s[8:11], s46 offen offset:0 sc1
    v_mfma_f32_32x32x16_bf16 v[144:159], v[180:183], v[40:43], v[144:159]
    ds_read_b64_tr_b16 v[196:197], v221 offset:16384
    ds_read_b64_tr_b16 v[198:199], v221 offset:17408
    s_waitcnt vmcnt(9) lgkmcnt(4)
    v_mfma_f32_32x32x16_bf16 v[128:143], v[184:187], v[44:47], v[128:143]
    ds_read_b64_tr_b16 v[176:177], v220 offset:18432
    ds_read_b64_tr_b16 v[178:179], v220 offset:19456
    buffer_load_dwordx4 v[84:87], v0, s[8:11], s46 offen offset:1024 sc1
    v_mfma_f32_32x32x16_bf16 v[144:159], v[188:191], v[44:47], v[144:159]
    ds_read_b64_tr_b16 v[180:181], v221 offset:18432
    ds_read_b64_tr_b16 v[182:183], v221 offset:19456
    s_waitcnt vmcnt(9) lgkmcnt(4)
    v_mfma_f32_32x32x16_bf16 v[128:143], v[192:195], v[48:51], v[128:143]
    ds_read_b64_tr_b16 v[184:185], v220 offset:20480
    ds_read_b64_tr_b16 v[186:187], v220 offset:21504
    buffer_load_dwordx4 v[88:91], v0, s[8:11], s46 offen offset:2048 sc1
    v_mfma_f32_32x32x16_bf16 v[144:159], v[196:199], v[48:51], v[144:159]
    ds_read_b64_tr_b16 v[188:189], v221 offset:20480
    ds_read_b64_tr_b16 v[190:191], v221 offset:21504
    s_waitcnt vmcnt(9) lgkmcnt(4)
    v_mfma_f32_32x32x16_bf16 v[128:143], v[176:179], v[52:55], v[128:143]
    ds_read_b64_tr_b16 v[192:193], v220 offset:22528
    ds_read_b64_tr_b16 v[194:195], v220 offset:23552
    buffer_load_dwordx4 v[92:95], v0, s[8:11], s46 offen offset:3072 sc1
    v_mfma_f32_32x32x16_bf16 v[144:159], v[180:183], v[52:55], v[144:159]
    ds_read_b64_tr_b16 v[196:197], v221 offset:22528
    ds_read_b64_tr_b16 v[198:199], v221 offset:23552
    s_waitcnt vmcnt(9) lgkmcnt(4)
    v_mfma_f32_32x32x16_bf16 v[128:143], v[184:187], v[56:59], v[128:143]
    ds_read_b64_tr_b16 v[176:177], v220 offset:24576
    ds_read_b64_tr_b16 v[178:179], v220 offset:25600
    s_add_u32 s46, s46, 4096
    buffer_load_dwordx4 v[96:99], v0, s[8:11], s46 offen offset:0 sc1
    v_mfma_f32_32x32x16_bf16 v[144:159], v[188:191], v[56:59], v[144:159]
    ds_read_b64_tr_b16 v[180:181], v221 offset:24576
    ds_read_b64_tr_b16 v[182:183], v221 offset:25600
    s_waitcnt vmcnt(9) lgkmcnt(4)
    v_mfma_f32_32x32x16_bf16 v[128:143], v[192:195], v[60:63], v[128:143]
    ds_read_b64_tr_b16 v[184:185], v220 offset:26624
    ds_read_b64_tr_b16 v[186:187], v220 offset:27648
    buffer_load_dwordx4 v[100:103], v0, s[8:11], s46 offen offset:1024 sc1
    v_mfma_f32_32x32x16_bf16 v[144:159], v[196:199], v[60:63], v[144:159]
    ds_read_b64_tr_b16 v[188:189], v221 offset:26624
    ds_read_b64_tr_b16 v[190:191], v221 offset:27648
    s_waitcnt vmcnt(9) lgkmcnt(4)
    v_mfma_f32_32x32x16_bf16 v[128:143], v[176:179], v[64:67], v[128:143]
    ds_read_b64_tr_b16 v[192:193], v220 offset:28672
    ds_read_b64_tr_b16 v[194:195], v220 offset:29696
    buffer_load_dwordx4 v[104:107], v0, s[8:11], s46 offen offset:2048 sc1
    v_mfma_f32_32x32x16_bf16 v[144:159], v[180:183], v[64:67], v[144:159]
    ds_read_b64_tr_b16 v[196:197], v221 offset:28672
    ds_read_b64_tr_b16 v[198:199], v221 offset:29696
    s_waitcnt vmcnt(9) lgkmcnt(4)
    v_mfma_f32_32x32x16_bf16 v[128:143], v[184:187], v[68:71], v[128:143]
    ds_read_b64_tr_b16 v[176:177], v220 offset:30720
    ds_read_b64_tr_b16 v[178:179], v220 offset:31744
    buffer_load_dwordx4 v[108:111], v0, s[8:11], s46 offen offset:3072 sc1
    v_mfma_f32_32x32x16_bf16 v[144:159], v[188:191], v[68:71], v[144:159]
    ds_read_b64_tr_b16 v[180:181], v221 offset:30720
    ds_read_b64_tr_b16 v[182:183], v221 offset:31744
    s_waitcnt vmcnt(9) lgkmcnt(4)
    v_mfma_f32_32x32x16_bf16 v[128:143], v[192:195], v[72:75], v[128:143]
    ds_read_b64_tr_b16 v[184:185], v220 offset:32768
    ds_read_b64_tr_b16 v[186:187], v220 offset:33792
    s_add_u32 s46, s46, 4096
    buffer_load_dwordx4 v[112:115], v0, s[8:11], s46 offen offset:0 sc1
    v_mfma_f32_32x32x16_bf16 v[144:159], v[196:199], v[72:75], v[144:159]
    ds_read_b64_tr_b16 v[188:189], v221 offset:32768
    ds_read_b64_tr_b16 v[190:191], v221 offset:33792
    s_waitcnt vmcnt(9) lgkmcnt(4)
    v_mfma_f32_32x32x16_bf16 v[128:143], v[176:179], v[76:79], v[128:143]
    ds_read_b64_tr_b16 v[192:193], v220 offset:34816
    ds_read_b64_tr_b16 v[194:195], v220 offset:35840
    buffer_load_dwordx4 v[116:119], v0, s[8:11], s46 offen offset:1024 sc1
    v_mfma_f32_32x32x16_bf16 v[144:159], v[180:183], v[76:79], v[144:159]
    ds_read_b64_tr_b16 v[196:197], v221 offset:34816
    ds_read_b64_tr_b16 v[198:199], v221 offset:35840
    s_waitcnt vmcnt(9) lgkmcnt(4)
    v_mfma_f32_32x32x16_bf16 v[128:143], v[184:187], v[80:83], v[128:143]
    ds_read_b64_tr_b16 v[176:177], v220 offset:36864
    ds_read_b64_tr_b16 v[178:179], v220 offset:37888
    buffer_load_dwordx4 v[120:123], v0, s[8:11], s46 offen offset:2048 sc1
    v_mfma_f32_32x32x16_bf16 v[144:159], v[188:191], v[80:83], v[144:159]
    ds_read_b64_tr_b16 v[180:181], v221 offset:36864
    ds_read_b64_tr_b16 v[182:183], v221 offset:37888
    s_waitcnt vmcnt(9) lgkmcnt(4)
    v_mfma_f32_32x32x16_bf16 v[128:143], v[192:195], v[84:87], v[128:143]
    ds_read_b64_tr_b16 v[184:185], v220 offset:38912
    ds_read_b64_tr_b16 v[186:187], v220 offset:39936
    buffer_load_dwordx4 v[124:127], v0, s[8:11], s46 offen offset:3072 sc1
    v_mfma_f32_32x32x16_bf16 v[144:159], v[196:199], v[84:87], v[144:159]
    ds_read_b64_tr_b16 v[188:189], v221 offset:38912
    ds_read_b64_tr_b16 v[190:191], v221 offset:39936
    s_waitcnt vmcnt(9) lgkmcnt(4)
    v_mfma_f32_32x32x16_bf16 v[128:143], v[176:179], v[88:91], v[128:143]
    ds_read_b64_tr_b16 v[192:193], v220 offset:40960
    ds_read_b64_tr_b16 v[194:195], v220 offset:41984
    v_mfma_f32_32x32x16_bf16 v[144:159], v[180:183], v[88:91], v[144:159]
    ds_read_b64_tr_b16 v[196:197], v221 offset:40960
    ds_read_b64_tr_b16 v[198:199], v221 offset:41984
    s_waitcnt vmcnt(8) lgkmcnt(4)
    v_mfma_f32_32x32x16_bf16 v[128:143], v[184:187], v[92:95], v[128:143]
    ds_read_b64_tr_b16 v[176:177], v220 offset:43008
    ds_read_b64_tr_b16 v[178:179], v220 offset:44032
    v_mfma_f32_32x32x16_bf16 v[144:159], v[188:191], v[92:95], v[144:159]
    ds_read_b64_tr_b16 v[180:181], v221 offset:43008
    ds_read_b64_tr_b16 v[182:183], v221 offset:44032
    s_waitcnt vmcnt(7) lgkmcnt(4)
    v_mfma_f32_32x32x16_bf16 v[128:143], v[192:195], v[96:99], v[128:143]
    ds_read_b64_tr_b16 v[184:185], v220 offset:45056
    ds_read_b64_tr_b16 v[186:187], v220 offset:46080
    v_mfma_f32_32x32x16_bf16 v[144:159], v[196:199], v[96:99], v[144:159]
    ds_read_b64_tr_b16 v[188:189], v221 offset:45056
    ds_read_b64_tr_b16 v[190:191], v221 offset:46080
    s_waitcnt vmcnt(6) lgkmcnt(4)
    v_mfma_f32_32x32x16_bf16 v[128:143], v[176:179], v[100:103], v[128:143]
    ds_read_b64_tr_b16 v[192:193], v220 offset:47104
    ds_read_b64_tr_b16 v[194:195], v220 offset:48128
    v_mfma_f32_32x32x16_bf16 v[144:159], v[180:183], v[100:103], v[144:159]
    ds_read_b64_tr_b16 v[196:197], v221 offset:47104
    ds_read_b64_tr_b16 v[198:199], v221 offset:48128
    s_waitcnt vmcnt(5) lgkmcnt(4)
    v_mfma_f32_32x32x16_bf16 v[128:143], v[184:187], v[104:107], v[128:143]
    ds_read_b64_tr_b16 v[176:177], v220 offset:49152
    ds_read_b64_tr_b16 v[178:179], v220 offset:50176
    v_mfma_f32_32x32x16_bf16 v[144:159], v[188:191], v[104:107], v[144:159]
    ds_read_b64_tr_b16 v[180:181], v221 offset:49152
    ds_read_b64_tr_b16 v[182:183], v221 offset:50176
    s_waitcnt vmcnt(4) lgkmcnt(4)
    v_mfma_f32_32x32x16_bf16 v[128:143], v[192:195], v[108:111], v[128:143]
    ds_read_b64_tr_b16 v[184:185], v220 offset:51200
    ds_read_b64_tr_b16 v[186:187], v220 offset:52224
    v_mfma_f32_32x32x16_bf16 v[144:159], v[196:199], v[108:111], v[144:159]
    ds_read_b64_tr_b16 v[188:189], v221 offset:51200
    ds_read_b64_tr_b16 v[190:191], v221 offset:52224
    s_waitcnt vmcnt(3) lgkmcnt(4)
    v_mfma_f32_32x32x16_bf16 v[128:143], v[176:179], v[112:115], v[128:143]
    ds_read_b64_tr_b16 v[192:193], v220 offset:53248
    ds_read_b64_tr_b16 v[194:195], v220 offset:54272
    v_mfma_f32_32x32x16_bf16 v[144:159], v[180:183], v[112:115], v[144:159]
    ds_read_b64_tr_b16 v[196:197], v221 offset:53248
    ds_read_b64_tr_b16 v[198:199], v221 offset:54272
    s_waitcnt vmcnt(2) lgkmcnt(4)
    v_mfma_f32_32x32x16_bf16 v[128:143], v[184:187], v[116:119], v[128:143]
    ds_read_b64_tr_b16 v[176:177], v220 offset:55296
    ds_read_b64_tr_b16 v[178:179], v220 offset:56320
    v_mfma_f32_32x32x16_bf16 v[144:159], v[188:191], v[116:119], v[144:159]
    ds_read_b64_tr_b16 v[180:181], v221 offset:55296
    ds_read_b64_tr_b16 v[182:183], v221 offset:56320
    s_waitcnt vmcnt(1) lgkmcnt(4)
    v_mfma_f32_32x32x16_bf16 v[128:143], v[192:195], v[120:123], v[128:143]
    v_mfma_f32_32x32x16_bf16 v[144:159], v[196:199], v[120:123], v[144:159]
    s_waitcnt vmcnt(0) lgkmcnt(0)
    v_mfma_f32_32x32x16_bf16 v[128:143], v[176:179], v[124:127], v[128:143]
    v_mfma_f32_32x32x16_bf16 v[144:159], v[180:183], v[124:127], v[144:159]
    s_lshl_b32 s45, s3, 12
    s_add_u32 s45, s45, 145408
    v_add_u32 v2, s45, v0
    s_xor_b32 s45, s3, 2
    s_lshl_b32 s45, s45, 12
    s_add_u32 s45, s45, 145408
    v_add_u32 v3, s45, v0
    s_nop 7
    ds_write_b128 v2, v[144:147] offset:0
    ds_write_b128 v2, v[148:151] offset:1024
    ds_write_b128 v2, v[152:155] offset:2048
    ds_write_b128 v2, v[156:159] offset:3072
    s_waitcnt lgkmcnt(0)
    s_barrier
    ds_read_b128 v[160:163], v3 offset:0
    ds_read_b128 v[164:167], v3 offset:1024
    ds_read_b128 v[168:171], v3 offset:2048
    ds_read_b128 v[172:175], v3 offset:3072
    v_lshlrev_b32 v16, 16, v200
    v_and_b32 v17, 0xffff0000, v200
    v_lshlrev_b32 v18, 16, v201
    v_and_b32 v19, 0xffff0000, v201
    v_lshlrev_b32 v20, 16, v202
    v_and_b32 v21, 0xffff0000, v202
    v_lshlrev_b32 v22, 16, v203
    v_and_b32 v23, 0xffff0000, v203
    v_lshlrev_b32 v24, 16, v204
    v_and_b32 v25, 0xffff0000, v204
    v_lshlrev_b32 v26, 16, v205
    v_and_b32 v27, 0xffff0000, v205
    v_lshlrev_b32 v28, 16, v206
    v_and_b32 v29, 0xffff0000, v206
    v_lshlrev_b32 v30, 16, v207
    v_and_b32 v31, 0xffff0000, v207
    v_add_f32 v128, v128, v16
    v_add_f32 v129, v129, v17
    v_add_f32 v130, v130, v18
    v_add_f32 v131, v131, v19
    v_add_f32 v132, v132, v20
    v_add_f32 v133, v133, v21
    v_add_f32 v134, v134, v22
    v_add_f32 v135, v135, v23
    v_add_f32 v136, v136, v24
    v_add_f32 v137, v137, v25
    v_add_f32 v138, v138, v26
    v_add_f32 v139, v139, v27
    v_add_f32 v140, v140, v28
    v_add_f32 v141, v141, v29
    v_add_f32 v142, v142, v30
    v_add_f32 v143, v143, v31
    s_waitcnt lgkmcnt(0)
    s_barrier
    v_add_f32 v128, v128, v160
    v_add_f32 v129, v129, v161
    v_add_f32 v130, v130, v162
    v_add_f32 v131, v131, v163
    v_add_f32 v132, v132, v164
    v_add_f32 v133, v133, v165
    v_add_f32 v134, v134, v166
    v_add_f32 v135, v135, v167
    v_add_f32 v136, v136, v168
    v_add_f32 v137, v137, v169
    v_add_f32 v138, v138, v170
    v_add_f32 v139, v139, v171
    v_add_f32 v140, v140, v172
    v_add_f32 v141, v141, v173
    v_add_f32 v142, v142, v174
    v_add_f32 v143, v143, v175
    v_cvt_pk_bf16_f32 v160, v128, v129
    v_cvt_pk_bf16_f32 v161, v130, v131
    v_cvt_pk_bf16_f32 v162, v132, v133
    v_cvt_pk_bf16_f32 v163, v134, v135
    v_cvt_pk_bf16_f32 v164, v136, v137
    v_cvt_pk_bf16_f32 v165, v138, v139
    v_cvt_pk_bf16_f32 v166, v140, v141
    v_cvt_pk_bf16_f32 v167, v142, v143
    s_cmp_eq_u32 s19, 0
    s_cbranch_scc0 L_out_final_68
    s_mul_i32 s44, s19, 0
    s_add_u32 s44, s44, 5242880
    s_add_u32 s44, s44, s52
    s_cmp_eq_u32 s39, 1
    s_cbranch_scc0 L_wt_70
    buffer_store_dwordx4 v[160:163], v0, s[8:11], s44 offen offset:0
    buffer_store_dwordx4 v[164:167], v0, s[8:11], s44 offen offset:1024
    s_branch L_wtd_71
L_wt_70:
    buffer_store_dwordx4 v[160:163], v0, s[8:11], s44 offen offset:0 sc1
    buffer_store_dwordx4 v[164:167], v0, s[8:11], s44 offen offset:1024 sc1
L_wtd_71:
    v_pk_add_f32 v[4:5], v[128:129], v[130:131]
    v_pk_mul_f32 v[6:7], v[128:129], v[128:129]
    v_pk_fma_f32 v[6:7], v[130:131], v[130:131], v[6:7]
    v_pk_fma_f32 v[6:7], v[132:133], v[132:133], v[6:7]
    v_pk_add_f32 v[4:5], v[4:5], v[132:133]
    v_pk_fma_f32 v[6:7], v[134:135], v[134:135], v[6:7]
    v_pk_add_f32 v[4:5], v[4:5], v[134:135]
    v_pk_fma_f32 v[6:7], v[136:137], v[136:137], v[6:7]
    v_pk_add_f32 v[4:5], v[4:5], v[136:137]
    v_pk_fma_f32 v[6:7], v[138:139], v[138:139], v[6:7]
    v_pk_add_f32 v[4:5], v[4:5], v[138:139]
    v_pk_fma_f32 v[6:7], v[140:141], v[140:141], v[6:7]
    v_pk_add_f32 v[4:5], v[4:5], v[140:141]
    v_pk_fma_f32 v[6:7], v[142:143], v[142:143], v[6:7]
    v_pk_add_f32 v[4:5], v[4:5], v[142:143]
    v_add_f32 v4, v4, v5
    v_add_f32 v5, v6, v7
    v_mov_b32 v8, v4
    v_mov_b32 v9, v5
    s_nop 0
    v_permlane32_swap_b32 v4, v8
    v_permlane32_swap_b32 v5, v9
    s_nop 0
    v_add_f32 v4, v4, v8
    v_add_f32 v5, v5, v9
    s_mul_i32 s44, s19, 0
    s_add_u32 s44, s44, 39845888
    s_lshl_b32 s45, s53, 8
    s_add_u32 s44, s44, s45
    v_lshlrev_b32 v2, 3, v1
    s_mov_b32 exec_hi, 0
    s_cmp_eq_u32 s39, 1
    s_cbranch_scc0 L_wt_72
    buffer_store_dwordx2 v[4:5], v2, s[8:11], s44 offen
    s_branch L_wtd_73
L_wt_72:
    buffer_store_dwordx2 v[4:5], v2, s[8:11], s44 offen sc1
L_wtd_73:
    s_mov_b64 exec, -1
    s_mul_i32 s57, s19, 32768
    s_add_u32 s57, s57, 393216
    s_lshl_b32 s58, s16, 11
    s_add_u32 s57, s57, s58
    s_lshl_b32 s58, s17, 7
    s_add_u32 s57, s57, s58
    s_lshl_b32 s58, s3, 2
    s_add_u32 s57, s57, s58
    v_mov_b32 v6, 1
    v_mov_b32 v7, 0
    s_waitcnt vmcnt(0)
    s_mov_b64 exec, 1
    s_cmp_eq_u32 s39, 1
    s_cbranch_scc0 L_wt_74
    buffer_store_dword v6, v7, s[8:11], s57 offen
    s_branch L_wtd_75
L_wt_74:
    buffer_store_dword v6, v7, s[8:11], s57 offen sc1
L_wtd_75:
    s_mov_b64 exec, -1
    s_branch L_out_done_69
L_out_final_68:
    s_mov_b32 s12, s32
    s_mov_b32 s13, s33
    s_mov_b32 s14, 1835008
    s_mov_b32 s15, 0x20000
    v_and_b32 v2, 0x13, v1
    v_bfe_u32 v3, v1, 2, 1
    v_lshlrev_b32 v3, 3, v3
    v_or_b32 v2, v2, v3
    v_bfe_u32 v3, v1, 3, 1
    v_lshlrev_b32 v3, 2, v3
    v_or_b32 v2, v2, v3
    v_mul_u32_u24 v2, 896, v2
    v_lshrrev_b32 v3, 5, v1
    v_lshlrev_b32 v3, 4, v3
    v_add_u32 v2, v2, v3
    s_mul_i32 s44, s50, 28672
    s_lshl_b32 s45, s38, 7
    s_add_u32 s44, s44, s45
    s_lshl_b32 s45, s49, 6
    s_add_u32 s44, s44, s45
    v_permlane32_swap_b32 v160, v162
    v_permlane32_swap_b32 v161, v163
    v_permlane32_swap_b32 v164, v166
    v_permlane32_swap_b32 v165, v167
    s_nop 1
    buffer_store_dwordx4 v[160:163], v2, s[12:15], s44 offen offset:0
    buffer_store_dwordx4 v[164:167], v2, s[12:15], s44 offen offset:32
L_out_done_69:
    s_branch L_out_join_65
L_out_helper_64:
    s_waitcnt lgkmcnt(0)
    s_barrier
    s_barrier
    s_barrier
    s_cmp_eq_u32 s19, 0
    s_cbranch_scc0 L_out_nopf_76
    s_lshl_b32 s40, s3, 10
    v_add_u32 v2, s40, v0
    v_add_u32 v3, 0x10000, v2
    ds_write_b128 v2, v[172:175] offset:0
    ds_write_b128 v2, v[176:179] offset:4096
    ds_write_b128 v2, v[180:183] offset:8192
    ds_write_b128 v2, v[184:187] offset:12288
    ds_write_b128 v2, v[188:191] offset:16384
    ds_write_b128 v2, v[192:195] offset:20480
    ds_write_b128 v2, v[196:199] offset:24576
    ds_write_b128 v2, v[200:203] offset:28672
    ds_write_b128 v2, v[204:207] offset:32768
    ds_write_b128 v2, v[208:211] offset:36864
    ds_write_b128 v2, v[212:215] offset:40960
    ds_write_b128 v2, v[216:219] offset:45056
    ds_write_b128 v2, v[220:223] offset:49152
    ds_write_b128 v2, v[224:227] offset:53248
    ds_write_b128 v2, v[228:231] offset:57344
    ds_write_b128 v2, v[232:235] offset:61440
    ds_write_b128 v3, v[236:239] offset:0
    ds_write_b128 v3, v[240:243] offset:4096
    ds_write_b128 v3, v[244:247] offset:8192
    ds_write_b128 v3, v[248:251] offset:12288
    ds_write_b128 v3, v[252:255] offset:16384
L_out_nopf_76:
L_out_join_65:
L_layer_next_2:
    s_add_u32 s19, s19, 1
    s_cmp_lt_u32 s19, 2
    s_cbranch_scc0 L_main_end
    s_xor_b32 s2, s39, 1
    s_cmp_ge_u32 s18, 4
    s_cbranch_scc0 L_qkv_helper_77
    s_lshl_b32 s50, s16, 2
    s_add_u32 s50, s50, s3
    v_lshrrev_b32 v2, 5, v1
    v_lshlrev_b32 v2, 2, v2
    v_bfe_u32 v3, v1, 2, 2
    v_add_u32 v2, v2, v3
    v_mul_u32_u24 v218, 64, v2
    v_bfe_u32 v3, v1, 4, 1
    v_lshlrev_b32 v3, 5, v3
    v_add_u32 v218, v218, v3
    v_and_b32 v3, 3, v1
    v_lshlrev_b32 v3, 3, v3
    v_add_u32 v218, v218, v3
    v_add_u32 v219, 57344, v218
    v_lshrrev_b32 v220, 5, v1
    v_lshlrev_b32 v220, 4, v220
    v_add_u32 v220, 161792, v220
    v_and_b32 v2, 31, v1
    v_lshrrev_b32 v3, 5, v1
    v_lshlrev_b32 v3, 2, v3
    v_sub_u32 v2, v2, v3
    v_mov_b32 v240, 0
    v_mov_b32 v3, 0x3f80
    v_cmp_eq_u32 vcc, 0, v2
    s_nop 1
    v_cndmask_b32 v240, v240, v3, vcc
    v_mov_b32 v3, 0x3f800000
    v_cmp_eq_u32 vcc, 1, v2
    s_nop 1
    v_cndmask_b32 v240, v240, v3, vcc
    v_mov_b32 v241, 0
    v_mov_b32 v3, 0x3f80
    v_cmp_eq_u32 vcc, 2, v2
    s_nop 1
    v_cndmask_b32 v241, v241, v3, vcc
    v_mov_b32 v3, 0x3f800000
    v_cmp_eq_u32 vcc, 3, v2
    s_nop 1
    v_cndmask_b32 v241, v241, v3, vcc
    v_mov_b32 v242, 0
    v_mov_b32 v3, 0x3f80
    v_cmp_eq_u32 vcc, 8, v2
    s_nop 1
    v_cndmask_b32 v242, v242, v3, vcc
    v_mov_b32 v3, 0x3f800000
    v_cmp_eq_u32 vcc, 9, v2
    s_nop 1
    v_cndmask_b32 v242, v242, v3, vcc
    v_mov_b32 v243, 0
    v_mov_b32 v3, 0x3f80
    v_cmp_eq_u32 vcc, 10, v2
    s_nop 1
    v_cndmask_b32 v243, v243, v3, vcc
    v_mov_b32 v3, 0x3f800000
    v_cmp_eq_u32 vcc, 11, v2
    s_nop 1
    v_cndmask_b32 v243, v243, v3, vcc
    v_mov_b32 v244, 0
    v_mov_b32 v3, 0x3f80
    v_cmp_eq_u32 vcc, 16, v2
    s_nop 1
    v_cndmask_b32 v244, v244, v3, vcc
    v_mov_b32 v3, 0x3f800000
    v_cmp_eq_u32 vcc, 17, v2
    s_nop 1
    v_cndmask_b32 v244, v244, v3, vcc
    v_mov_b32 v245, 0
    v_mov_b32 v3, 0x3f80
    v_cmp_eq_u32 vcc, 18, v2
    s_nop 1
    v_cndmask_b32 v245, v245, v3, vcc
    v_mov_b32 v3, 0x3f800000
    v_cmp_eq_u32 vcc, 19, v2
    s_nop 1
    v_cndmask_b32 v245, v245, v3, vcc
    v_mov_b32 v246, 0
    v_mov_b32 v3, 0x3f80
    v_cmp_eq_u32 vcc, 24, v2
    s_nop 1
    v_cndmask_b32 v246, v246, v3, vcc
    v_mov_b32 v3, 0x3f800000
    v_cmp_eq_u32 vcc, 25, v2
    s_nop 1
    v_cndmask_b32 v246, v246, v3, vcc
    v_mov_b32 v247, 0
    v_mov_b32 v3, 0x3f80
    v_cmp_eq_u32 vcc, 26, v2
    s_nop 1
    v_cndmask_b32 v247, v247, v3, vcc
    v_mov_b32 v3, 0x3f800000
    v_cmp_eq_u32 vcc, 27, v2
    s_nop 1
    v_cndmask_b32 v247, v247, v3, vcc
    s_mul_i32 s46, s19, 524288
    s_add_u32 s46, s46, 39321600
    s_mul_i32 s47, s50, 3584
    s_add_u32 s46, s46, s47
    v_lshrrev_b32 v8, 5, v1
    v_mul_u32_u24 v8, 1792, v8
    v_and_b32 v9, 31, v1
    v_lshl_add_u32 v8, v9, 3, v8
    s_mul_i32 s40, s19, 4194304
    s_add_u32 s40, s40, 1048576
    s_mul_i32 s41, s50, 28672
    s_add_u32 s40, s40, s41
    s_barrier
    s_mul_i32 s42, s19, 32768
    s_add_u32 s42, s42, 360448
    s_lshl_b32 s43, s16, 11
    s_add_u32 s42, s42, s43
    s_lshr_b32 s43, s3, 1
    s_mul_i32 s43, s43, 896
    s_add_u32 s42, s42, s43
    s_and_b32 s43, s3, 1
    s_lshl_b32 s43, s43, 2
    s_add_u32 s42, s42, s43
    v_min_u32 v2, 13, v1
    v_lshrrev_b32 v3, 1, v2
    v_lshlrev_b32 v3, 7, v3
    v_and_b32 v2, 1, v2
    v_lshlrev_b32 v2, 3, v2
    v_add_u32 v2, v2, v3
    s_mov_b32 s59, s36
L_poll_79:
    buffer_load_dword v3, v2, s[8:11], s42 offen sc1
    s_waitcnt vmcnt(0)
    v_cmp_eq_u32 vcc, 0, v3
    s_cbranch_vccz L_polld_80
    s_sub_u32 s59, s59, 1
    s_cmp_lg_u32 s59, 0
    s_cbranch_scc1 L_poll_79
    s_mov_b32 s36, 1
L_polld_80:
    buffer_load_dwordx4 v[16:19], v0, s[8:11], s40 offen offset:0 sc1
    buffer_load_dwordx4 v[20:23], v0, s[8:11], s40 offen offset:1024 sc1
    buffer_load_dwordx4 v[24:27], v0, s[8:11], s40 offen offset:2048 sc1
    buffer_load_dwordx4 v[28:31], v0, s[8:11], s40 offen offset:3072 sc1
    s_add_u32 s40, s40, 4096
    buffer_load_dwordx4 v[32:35], v0, s[8:11], s40 offen offset:0 sc1
    buffer_load_dwordx4 v[36:39], v0, s[8:11], s40 offen offset:1024 sc1
    buffer_load_dwordx4 v[40:43], v0, s[8:11], s40 offen offset:2048 sc1
    buffer_load_dwordx4 v[44:47], v0, s[8:11], s40 offen offset:3072 sc1
    s_add_u32 s40, s40, 4096
    buffer_load_dwordx4 v[48:51], v0, s[8:11], s40 offen offset:0 sc1
    buffer_load_dwordx4 v[52:55], v0, s[8:11], s40 offen offset:1024 sc1
    buffer_load_dwordx2 v[226:227], v8, s[8:11], s46 offen offset:0 sc1
    buffer_load_dwordx2 v[228:229], v8, s[8:11], s46 offen offset:256 sc1
    buffer_load_dwordx2 v[230:231], v8, s[8:11], s46 offen offset:512 sc1
    buffer_load_dwordx2 v[232:233], v8, s[8:11], s46 offen offset:768 sc1
    buffer_load_dwordx2 v[234:235], v8, s[8:11], s46 offen offset:1024 sc1
    buffer_load_dwordx2 v[236:237], v8, s[8:11], s46 offen offset:1280 sc1
    buffer_load_dwordx2 v[238:239], v8, s[8:11], s46 offen offset:1536 sc1
    ds_read_b64_tr_b16 v[176:177], v218 offset:0
    ds_read_b64_tr_b16 v[178:179], v218 offset:512
    ds_read_b64_tr_b16 v[180:181], v218 offset:28672
    ds_read_b64_tr_b16 v[182:183], v218 offset:29184
    ds_read_b64_tr_b16 v[184:185], v219 offset:0
    ds_read_b64_tr_b16 v[186:187], v219 offset:512
    ds_read_b64_tr_b16 v[188:189], v218 offset:1024
    ds_read_b64_tr_b16 v[190:191], v218 offset:1536
    ds_read_b64_tr_b16 v[192:193], v218 offset:29696
    ds_read_b64_tr_b16 v[194:195], v218 offset:30208
    ds_read_b64_tr_b16 v[196:197], v219 offset:1024
    ds_read_b64_tr_b16 v[198:199], v219 offset:1536
    s_waitcnt vmcnt(16) lgkmcnt(6)
    v_mfma_f32_32x32x16_bf16 v[128:143], v[176:179], v[16:19], 0
    ds_read_b64_tr_b16 v[200:201], v218 offset:2048
    ds_read_b64_tr_b16 v[202:203], v218 offset:2560
    buffer_load_dwordx4 v[56:59], v0, s[8:11], s40 offen offset:2048 sc1
    v_mfma_f32_32x32x16_bf16 v[144:159], v[180:183], v[16:19], 0
    ds_read_b64_tr_b16 v[204:205], v218 offset:30720
    ds_read_b64_tr_b16 v[206:207], v218 offset:31232
    v_mfma_f32_32x32x16_bf16 v[160:175], v[184:187], v[16:19], 0
    ds_read_b64_tr_b16 v[208:209], v219 offset:2048
    ds_read_b64_tr_b16 v[210:211], v219 offset:2560
    s_waitcnt vmcnt(16) lgkmcnt(6)
    v_mfma_f32_32x32x16_bf16 v[128:143], v[188:191], v[20:23], v[128:143]
    ds_read_b64_tr_b16 v[176:177], v218 offset:3072
    ds_read_b64_tr_b16 v[178:179], v218 offset:3584
    buffer_load_dwordx4 v[60:63], v0, s[8:11], s40 offen offset:3072 sc1
    v_mfma_f32_32x32x16_bf16 v[144:159], v[192:195], v[20:23], v[144:159]
    ds_read_b64_tr_b16 v[180:181], v218 offset:31744
    ds_read_b64_tr_b16 v[182:183], v218 offset:32256
    v_mfma_f32_32x32x16_bf16 v[160:175], v[196:199], v[20:23], v[160:175]
    ds_read_b64_tr_b16 v[184:185], v219 offset:3072
    ds_read_b64_tr_b16 v[186:187], v219 offset:3584
    s_waitcnt vmcnt(16) lgkmcnt(6)
    v_mfma_f32_32x32x16_bf16 v[128:143], v[200:203], v[24:27], v[128:143]
    ds_read_b64_tr_b16 v[188:189], v218 offset:4096
    ds_read_b64_tr_b16 v[190:191], v218 offset:4608
    s_add_u32 s40, s40, 4096
    buffer_load_dwordx4 v[64:67], v0, s[8:11], s40 offen offset:0 sc1
    v_mfma_f32_32x32x16_bf16 v[144:159], v[204:207], v[24:27], v[144:159]
    ds_read_b64_tr_b16 v[192:193], v218 offset:32768
    ds_read_b64_tr_b16 v[194:195], v218 offset:33280
    v_mfma_f32_32x32x16_bf16 v[160:175], v[208:211], v[24:27], v[160:175]
    ds_read_b64_tr_b16 v[196:197], v219 offset:4096
    ds_read_b64_tr_b16 v[198:199], v219 offset:4608
    s_waitcnt vmcnt(16) lgkmcnt(6)
    v_mfma_f32_32x32x16_bf16 v[128:143], v[176:179], v[28:31], v[128:143]
    ds_read_b64_tr_b16 v[200:201], v218 offset:5120
    ds_read_b64_tr_b16 v[202:203], v218 offset:5632
    buffer_load_dwordx4 v[68:71], v0, s[8:11], s40 offen offset:1024 sc1
    v_mfma_f32_32x32x16_bf16 v[144:159], v[180:183], v[28:31], v[144:159]
    ds_read_b64_tr_b16 v[204:205], v218 offset:33792
    ds_read_b64_tr_b16 v[206:207], v218 offset:34304
    v_mfma_f32_32x32x16_bf16 v[160:175], v[184:187], v[28:31], v[160:175]
    ds_read_b64_tr_b16 v[208:209], v219 offset:5120
    ds_read_b64_tr_b16 v[210:211], v219 offset:5632
    s_waitcnt vmcnt(16) lgkmcnt(6)
    v_mfma_f32_32x32x16_bf16 v[128:143], v[188:191], v[32:35], v[128:143]
    ds_read_b64_tr_b16 v[176:177], v218 offset:6144
    ds_read_b64_tr_b16 v[178:179], v218 offset:6656
    buffer_load_dwordx4 v[72:75], v0, s[8:11], s40 offen offset:2048 sc1
    v_mfma_f32_32x32x16_bf16 v[144:159], v[192:195], v[32:35], v[144:159]
    ds_read_b64_tr_b16 v[180:181], v218 offset:34816
    ds_read_b64_tr_b16 v[182:183], v218 offset:35328
    v_mfma_f32_32x32x16_bf16 v[160:175], v[196:199], v[32:35], v[160:175]
    ds_read_b64_tr_b16 v[184:185], v219 offset:6144
    ds_read_b64_tr_b16 v[186:187], v219 offset:6656
    s_waitcnt vmcnt(16) lgkmcnt(6)
    v_mfma_f32_32x32x16_bf16 v[128:143], v[200:203], v[36:39], v[128:143]
    ds_read_b64_tr_b16 v[188:189], v218 offset:7168
    ds_read_b64_tr_b16 v[190:191], v218 offset:7680
    buffer_load_dwordx4 v[76:79], v0, s[8:11], s40 offen offset:3072 sc1
    v_mfma_f32_32x32x16_bf16 v[144:159], v[204:207], v[36:39], v[144:159]
    ds_read_b64_tr_b16 v[192:193], v218 offset:35840
    ds_read_b64_tr_b16 v[194:195], v218 offset:36352
    v_mfma_f32_32x32x16_bf16 v[160:175], v[208:211], v[36:39], v[160:175]
    ds_read_b64_tr_b16 v[196:197], v219 offset:7168
    ds_read_b64_tr_b16 v[198:199], v219 offset:7680
    s_waitcnt vmcnt(16) lgkmcnt(6)
    v_mfma_f32_32x32x16_bf16 v[128:143], v[176:179], v[40:43], v[128:143]
    ds_read_b64_tr_b16 v[200:201], v218 offset:8192
    ds_read_b64_tr_b16 v[202:203], v218 offset:8704
    s_add_u32 s40, s40, 4096
    buffer_load_dwordx4 v[80:83], v0, s[8:11], s40 offen offset:0 sc1
    v_mfma_f32_32x32x16_bf16 v[144:159], v[180:183], v[40:43], v[144:159]
    ds_read_b64_tr_b16 v[204:205], v218 offset:36864
    ds_read_b64_tr_b16 v[206:207], v218 offset:37376
    v_mfma_f32_32x32x16_bf16 v[160:175], v[184:187], v[40:43], v[160:175]
    ds_read_b64_tr_b16 v[208:209], v219 offset:8192
    ds_read_b64_tr_b16 v[210:211], v219 offset:8704
    s_waitcnt vmcnt(16) lgkmcnt(6)
    v_mfma_f32_32x32x16_bf16 v[128:143], v[188:191], v[44:47], v[128:143]
    ds_read_b64_tr_b16 v[176:177], v218 offset:9216
    ds_read_b64_tr_b16 v[178:179], v218 offset:9728
    buffer_load_dwordx4 v[84:87], v0, s[8:11], s40 offen offset:1024 sc1
    v_mfma_f32_32x32x16_bf16 v[144:159], v[192:195], v[44:47], v[144:159]
    ds_read_b64_tr_b16 v[180:181], v218 offset:37888
    ds_read_b64_tr_b16 v[182:183], v218 offset:38400
    v_mfma_f32_32x32x16_bf16 v[160:175], v[196:199], v[44:47], v[160:175]
    ds_read_b64_tr_b16 v[184:185], v219 offset:9216
    ds_read_b64_tr_b16 v[186:187], v219 offset:9728
    s_waitcnt vmcnt(16) lgkmcnt(6)
    v_mfma_f32_32x32x16_bf16 v[128:143], v[200:203], v[48:51], v[128:143]
    ds_read_b64_tr_b16 v[188:189], v218 offset:10240
    ds_read_b64_tr_b16 v[190:191], v218 offset:10752
    buffer_load_dwordx4 v[88:91], v0, s[8:11], s40 offen offset:2048 sc1
    v_mfma_f32_32x32x16_bf16 v[144:159], v[204:207], v[48:51], v[144:159]
    ds_read_b64_tr_b16 v[192:193], v218 offset:38912
    ds_read_b64_tr_b16 v[194:195], v218 offset:39424
    v_mfma_f32_32x32x16_bf16 v[160:175], v[208:211], v[48:51], v[160:175]
    ds_read_b64_tr_b16 v[196:197], v219 offset:10240
    ds_read_b64_tr_b16 v[198:199], v219 offset:10752
    s_waitcnt vmcnt(16) lgkmcnt(6)
    v_mfma_f32_32x32x16_bf16 v[128:143], v[176:179], v[52:55], v[128:143]
    ds_read_b64_tr_b16 v[200:201], v218 offset:11264
    ds_read_b64_tr_b16 v[202:203], v218 offset:11776
    buffer_load_dwordx4 v[92:95], v0, s[8:11], s40 offen offset:3072 sc1
    v_mfma_f32_32x32x16_bf16 v[144:159], v[180:183], v[52:55], v[144:159]
    ds_read_b64_tr_b16 v[204:205], v218 offset:39936
    ds_read_b64_tr_b16 v[206:207], v218 offset:40448
    v_mfma_f32_32x32x16_bf16 v[160:175], v[184:187], v[52:55], v[160:175]
    ds_read_b64_tr_b16 v[208:209], v219 offset:11264
    ds_read_b64_tr_b16 v[210:211], v219 offset:11776
    s_waitcnt vmcnt(9) lgkmcnt(6)
    v_mfma_f32_32x32x16_bf16 v[128:143], v[188:191], v[56:59], v[128:143]
    ds_read_b64_tr_b16 v[176:177], v218 offset:12288
    ds_read_b64_tr_b16 v[178:179], v218 offset:12800
    s_add_u32 s40, s40, 4096
    buffer_load_dwordx4 v[96:99], v0, s[8:11], s40 offen offset:0 sc1
    v_mfma_f32_32x32x16_bf16 v[144:159], v[192:195], v[56:59], v[144:159]
    ds_read_b64_tr_b16 v[180:181], v218 offset:40960
    ds_read_b64_tr_b16 v[182:183], v218 offset:41472
    v_mfma_f32_32x32x16_bf16 v[160:175], v[196:199], v[56:59], v[160:175]
    ds_read_b64_tr_b16 v[184:185], v219 offset:12288
    ds_read_b64_tr_b16 v[186:187], v219 offset:12800
    s_waitcnt vmcnt(9) lgkmcnt(6)
    v_mfma_f32_32x32x16_bf16 v[128:143], v[200:203], v[60:63], v[128:143]
    ds_read_b64_tr_b16 v[188:189], v218 offset:13312
    ds_read_b64_tr_b16 v[190:191], v218 offset:13824
    buffer_load_dwordx4 v[100:103], v0, s[8:11], s40 offen offset:1024 sc1
    v_mfma_f32_32x32x16_bf16 v[144:159], v[204:207], v[60:63], v[144:159]
    ds_read_b64_tr_b16 v[192:193], v218 offset:41984
    ds_read_b64_tr_b16 v[194:195], v218 offset:42496
    v_mfma_f32_32x32x16_bf16 v[160:175], v[208:211], v[60:63], v[160:175]
    ds_read_b64_tr_b16 v[196:197], v219 offset:13312
    ds_read_b64_tr_b16 v[198:199], v219 offset:13824
    v_add_f32 v226, v226, v228
    v_add_f32 v227, v227, v229
    v_add_f32 v226, v226, v230
    v_add_f32 v227, v227, v231
    v_add_f32 v226, v226, v232
    v_add_f32 v227, v227, v233
    v_add_f32 v226, v226, v234
    v_add_f32 v227, v227, v235
    v_add_f32 v226, v226, v236
    v_add_f32 v227, v227, v237
    v_add_f32 v226, v226, v238
    v_add_f32 v227, v227, v239
    v_mov_b32 v228, v226
    v_mov_b32 v229, v227
    s_nop 0
    v_permlane32_swap_b32 v226, v228
    v_permlane32_swap_b32 v227, v229
    s_nop 0
    v_add_f32 v226, v226, v228
    v_add_f32 v227, v227, v229
    v_mul_f32 v226, 0x3b124925, v226
    v_mul_f32 v227, 0x3b124925, v227
    v_fma_f32 v227, -v226, v226, v227
    v_max_f32 v227, 0, v227
    v_add_f32 v227, 0x3727c5ac, v227
    v_rsq_f32 v212, v227
    s_nop 0
    v_mul_f32 v214, v226, v212
    s_waitcnt vmcnt(9) lgkmcnt(6)
    v_mfma_f32_32x32x16_bf16 v[128:143], v[176:179], v[64:67], v[128:143]
    ds_read_b64_tr_b16 v[200:201], v218 offset:14336
    ds_read_b64_tr_b16 v[202:203], v218 offset:14848
    buffer_load_dwordx4 v[104:107], v0, s[8:11], s40 offen offset:2048 sc1
    v_mfma_f32_32x32x16_bf16 v[144:159], v[180:183], v[64:67], v[144:159]
    ds_read_b64_tr_b16 v[204:205], v218 offset:43008
    ds_read_b64_tr_b16 v[206:207], v218 offset:43520
    v_mfma_f32_32x32x16_bf16 v[160:175], v[184:187], v[64:67], v[160:175]
    ds_read_b64_tr_b16 v[208:209], v219 offset:14336
    ds_read_b64_tr_b16 v[210:211], v219 offset:14848
    s_waitcnt vmcnt(9) lgkmcnt(6)
    v_mfma_f32_32x32x16_bf16 v[128:143], v[188:191], v[68:71], v[128:143]
    ds_read_b64_tr_b16 v[176:177], v218 offset:15360
    ds_read_b64_tr_b16 v[178:179], v218 offset:15872
    buffer_load_dwordx4 v[108:111], v0, s[8:11], s40 offen offset:3072 sc1
    v_mfma_f32_32x32x16_bf16 v[144:159], v[192:195], v[68:71], v[144:159]
    ds_read_b64_tr_b16 v[180:181], v218 offset:44032
    ds_read_b64_tr_b16 v[182:183], v218 offset:44544
    v_mfma_f32_32x32x16_bf16 v[160:175], v[196:199], v[68:71], v[160:175]
    ds_read_b64_tr_b16 v[184:185], v219 offset:15360
    ds_read_b64_tr_b16 v[186:187], v219 offset:15872
    s_waitcnt vmcnt(9) lgkmcnt(6)
    v_mfma_f32_32x32x16_bf16 v[128:143], v[200:203], v[72:75], v[128:143]
    ds_read_b64_tr_b16 v[188:189], v218 offset:16384
    ds_read_b64_tr_b16 v[190:191], v218 offset:16896
    s_add_u32 s40, s40, 4096
    buffer_load_dwordx4 v[112:115], v0, s[8:11], s40 offen offset:0 sc1
    v_mfma_f32_32x32x16_bf16 v[144:159], v[204:207], v[72:75], v[144:159]
    ds_read_b64_tr_b16 v[192:193], v218 offset:45056
    ds_read_b64_tr_b16 v[194:195], v218 offset:45568
    v_mfma_f32_32x32x16_bf16 v[160:175], v[208:211], v[72:75], v[160:175]
    ds_read_b64_tr_b16 v[196:197], v219 offset:16384
    ds_read_b64_tr_b16 v[198:199], v219 offset:16896
    s_waitcnt vmcnt(9) lgkmcnt(6)
    v_mfma_f32_32x32x16_bf16 v[128:143], v[176:179], v[76:79], v[128:143]
    ds_read_b64_tr_b16 v[200:201], v218 offset:17408
    ds_read_b64_tr_b16 v[202:203], v218 offset:17920
    buffer_load_dwordx4 v[116:119], v0, s[8:11], s40 offen offset:1024 sc1
    v_mfma_f32_32x32x16_bf16 v[144:159], v[180:183], v[76:79], v[144:159]
    ds_read_b64_tr_b16 v[204:205], v218 offset:46080
    ds_read_b64_tr_b16 v[206:207], v218 offset:46592
    v_mfma_f32_32x32x16_bf16 v[160:175], v[184:187], v[76:79], v[160:175]
    ds_read_b64_tr_b16 v[208:209], v219 offset:17408
    ds_read_b64_tr_b16 v[210:211], v219 offset:17920
    s_waitcnt vmcnt(9) lgkmcnt(6)
    v_mfma_f32_32x32x16_bf16 v[128:143], v[188:191], v[80:83], v[128:143]
    ds_read_b64_tr_b16 v[176:177], v218 offset:18432
    ds_read_b64_tr_b16 v[178:179], v218 offset:18944
    buffer_load_dwordx4 v[120:123], v0, s[8:11], s40 offen offset:2048 sc1
    v_mfma_f32_32x32x16_bf16 v[144:159], v[192:195], v[80:83], v[144:159]
    ds_read_b64_tr_b16 v[180:181], v218 offset:47104
    ds_read_b64_tr_b16 v[182:183], v218 offset:47616
    v_mfma_f32_32x32x16_bf16 v[160:175], v[196:199], v[80:83], v[160:175]
    ds_read_b64_tr_b16 v[184:185], v219 offset:18432
    ds_read_b64_tr_b16 v[186:187], v219 offset:18944
    s_waitcnt vmcnt(9) lgkmcnt(6)
    v_mfma_f32_32x32x16_bf16 v[128:143], v[200:203], v[84:87], v[128:143]
    ds_read_b64_tr_b16 v[188:189], v218 offset:19456
    ds_read_b64_tr_b16 v[190:191], v218 offset:19968
    buffer_load_dwordx4 v[124:127], v0, s[8:11], s40 offen offset:3072 sc1
    v_mfma_f32_32x32x16_bf16 v[144:159], v[204:207], v[84:87], v[144:159]
    ds_read_b64_tr_b16 v[192:193], v218 offset:48128
    ds_read_b64_tr_b16 v[194:195], v218 offset:48640
    v_mfma_f32_32x32x16_bf16 v[160:175], v[208:211], v[84:87], v[160:175]
    ds_read_b64_tr_b16 v[196:197], v219 offset:19456
    ds_read_b64_tr_b16 v[198:199], v219 offset:19968
    s_waitcnt vmcnt(9) lgkmcnt(6)
    v_mfma_f32_32x32x16_bf16 v[128:143], v[176:179], v[88:91], v[128:143]
    ds_read_b64_tr_b16 v[200:201], v218 offset:20480
    ds_read_b64_tr_b16 v[202:203], v218 offset:20992
    v_mfma_f32_32x32x16_bf16 v[144:159], v[180:183], v[88:91], v[144:159]
    ds_read_b64_tr_b16 v[204:205], v218 offset:49152
    ds_read_b64_tr_b16 v[206:207], v218 offset:49664
    v_mfma_f32_32x32x16_bf16 v[160:175], v[184:187], v[88:91], v[160:175]
    ds_read_b64_tr_b16 v[208:209], v219 offset:20480
    ds_read_b64_tr_b16 v[210:211], v219 offset:20992
    s_waitcnt vmcnt(8) lgkmcnt(6)
    v_mfma_f32_32x32x16_bf16 v[128:143], v[188:191], v[92:95], v[128:143]
    ds_read_b64_tr_b16 v[176:177], v218 offset:21504
    ds_read_b64_tr_b16 v[178:179], v218 offset:22016
    v_mfma_f32_32x32x16_bf16 v[144:159], v[192:195], v[92:95], v[144:159]
    ds_read_b64_tr_b16 v[180:181], v218 offset:50176
    ds_read_b64_tr_b16 v[182:183], v218 offset:50688
    v_mfma_f32_32x32x16_bf16 v[160:175], v[196:199], v[92:95], v[160:175]
    ds_read_b64_tr_b16 v[184:185], v219 offset:21504
    ds_read_b64_tr_b16 v[186:187], v219 offset:22016
    s_waitcnt vmcnt(7) lgkmcnt(6)
    v_mfma_f32_32x32x16_bf16 v[128:143], v[200:203], v[96:99], v[128:143]
    ds_read_b64_tr_b16 v[188:189], v218 offset:22528
    ds_read_b64_tr_b16 v[190:191], v218 offset:23040
    v_mfma_f32_32x32x16_bf16 v[144:159], v[204:207], v[96:99], v[144:159]
    ds_read_b64_tr_b16 v[192:193], v218 offset:51200
    ds_read_b64_tr_b16 v[194:195], v218 offset:51712
    v_mfma_f32_32x32x16_bf16 v[160:175], v[208:211], v[96:99], v[160:175]
    ds_read_b64_tr_b16 v[196:197], v219 offset:22528
    ds_read_b64_tr_b16 v[198:199], v219 offset:23040
    s_waitcnt vmcnt(6) lgkmcnt(6)
    v_mfma_f32_32x32x16_bf16 v[128:143], v[176:179], v[100:103], v[128:143]
    ds_read_b64_tr_b16 v[200:201], v218 offset:23552
    ds_read_b64_tr_b16 v[202:203], v218 offset:24064
    v_mfma_f32_32x32x16_bf16 v[144:159], v[180:183], v[100:103], v[144:159]
    ds_read_b64_tr_b16 v[204:205], v218 offset:52224
    ds_read_b64_tr_b16 v[206:207], v218 offset:52736
    v_mfma_f32_32x32x16_bf16 v[160:175], v[184:187], v[100:103], v[160:175]
    ds_read_b64_tr_b16 v[208:209], v219 offset:23552
    ds_read_b64_tr_b16 v[210:211], v219 offset:24064
    s_waitcnt vmcnt(5) lgkmcnt(6)
    v_mfma_f32_32x32x16_bf16 v[128:143], v[188:191], v[104:107], v[128:143]
    ds_read_b64_tr_b16 v[176:177], v218 offset:24576
    ds_read_b64_tr_b16 v[178:179], v218 offset:25088
    v_mfma_f32_32x32x16_bf16 v[144:159], v[192:195], v[104:107], v[144:159]
    ds_read_b64_tr_b16 v[180:181], v218 offset:53248
    ds_read_b64_tr_b16 v[182:183], v218 offset:53760
    v_mfma_f32_32x32x16_bf16 v[160:175], v[196:199], v[104:107], v[160:175]
    ds_read_b64_tr_b16 v[184:185], v219 offset:24576
    ds_read_b64_tr_b16 v[186:187], v219 offset:25088
    s_waitcnt vmcnt(4) lgkmcnt(6)
    v_mfma_f32_32x32x16_bf16 v[128:143], v[200:203], v[108:111], v[128:143]
    ds_read_b64_tr_b16 v[188:189], v218 offset:25600
    ds_read_b64_tr_b16 v[190:191], v218 offset:26112
    v_mfma_f32_32x32x16_bf16 v[144:159], v[204:207], v[108:111], v[144:159]
    ds_read_b64_tr_b16 v[192:193], v218 offset:54272
    ds_read_b64_tr_b16 v[194:195], v218 offset:54784
    v_mfma_f32_32x32x16_bf16 v[160:175], v[208:211], v[108:111], v[160:175]
    ds_read_b64_tr_b16 v[196:197], v219 offset:25600
    ds_read_b64_tr_b16 v[198:199], v219 offset:26112
    s_waitcnt vmcnt(3) lgkmcnt(6)
    v_mfma_f32_32x32x16_bf16 v[128:143], v[176:179], v[112:115], v[128:143]
    ds_read_b64_tr_b16 v[200:201], v218 offset:26624
    ds_read_b64_tr_b16 v[202:203], v218 offset:27136
    v_mfma_f32_32x32x16_bf16 v[144:159], v[180:183], v[112:115], v[144:159]
    ds_read_b64_tr_b16 v[204:205], v218 offset:55296
    ds_read_b64_tr_b16 v[206:207], v218 offset:55808
    v_mfma_f32_32x32x16_bf16 v[160:175], v[184:187], v[112:115], v[160:175]
    ds_read_b64_tr_b16 v[208:209], v219 offset:26624
    ds_read_b64_tr_b16 v[210:211], v219 offset:27136
    s_waitcnt vmcnt(2) lgkmcnt(6)
    v_mfma_f32_32x32x16_bf16 v[128:143], v[188:191], v[116:119], v[128:143]
    ds_read_b64_tr_b16 v[176:177], v218 offset:27648
    ds_read_b64_tr_b16 v[178:179], v218 offset:28160
    v_mfma_f32_32x32x16_bf16 v[144:159], v[192:195], v[116:119], v[144:159]
    ds_read_b64_tr_b16 v[180:181], v218 offset:56320
    ds_read_b64_tr_b16 v[182:183], v218 offset:56832
    v_mfma_f32_32x32x16_bf16 v[160:175], v[196:199], v[116:119], v[160:175]
    ds_read_b64_tr_b16 v[184:185], v219 offset:27648
    ds_read_b64_tr_b16 v[186:187], v219 offset:28160
    s_waitcnt vmcnt(1) lgkmcnt(6)
    v_mfma_f32_32x32x16_bf16 v[128:143], v[200:203], v[120:123], v[128:143]
    v_mfma_f32_32x32x16_bf16 v[144:159], v[204:207], v[120:123], v[144:159]
    v_mfma_f32_32x32x16_bf16 v[160:175], v[208:211], v[120:123], v[160:175]
    s_waitcnt vmcnt(0) lgkmcnt(0)
    v_mfma_f32_32x32x16_bf16 v[128:143], v[176:179], v[124:127], v[128:143]
    v_mfma_f32_32x32x16_bf16 v[144:159], v[180:183], v[124:127], v[144:159]
    v_mfma_f32_32x32x16_bf16 v[160:175], v[184:187], v[124:127], v[160:175]
    s_barrier
    ds_read_b128 v[16:19], v220 offset:256
    ds_read_b128 v[20:23], v220 offset:288
    ds_read_b128 v[24:27], v220 offset:320
    ds_read_b128 v[28:31], v220 offset:352
    ds_read_b128 v[32:35], v220 offset:128
    ds_read_b128 v[36:39], v220 offset:160
    ds_read_b128 v[40:43], v220 offset:192
    ds_read_b128 v[44:47], v220 offset:224
    ds_read_b128 v[48:51], v220 offset:0
    ds_read_b128 v[52:55], v220 offset:32
    ds_read_b128 v[56:59], v220 offset:64
    ds_read_b128 v[60:63], v220 offset:96
    s_lshl_b32 s40, s17, 6
    s_add_u32 s40, s40, s50
    s_lshl_b32 s40, s40, 11
    s_mul_i32 s41, s19, 2097152
    s_add_u32 s41, s41, 9437184
    s_add_u32 s41, s41, s40
    s_mul_i32 s42, s19, 2097152
    s_add_u32 s42, s42, 13631488
    s_add_u32 s42, s42, s40
    s_waitcnt lgkmcnt(8)
    v_pk_mul_f32 v[16:17], v[16:17], v[214:215] op_sel_hi:[1,0]
    v_pk_mul_f32 v[18:19], v[18:19], v[214:215] op_sel_hi:[1,0]
    v_pk_mul_f32 v[20:21], v[20:21], v[214:215] op_sel_hi:[1,0]
    v_pk_mul_f32 v[22:23], v[22:23], v[214:215] op_sel_hi:[1,0]
    v_pk_mul_f32 v[24:25], v[24:25], v[214:215] op_sel_hi:[1,0]
    v_pk_mul_f32 v[26:27], v[26:27], v[214:215] op_sel_hi:[1,0]
    v_pk_mul_f32 v[28:29], v[28:29], v[214:215] op_sel_hi:[1,0]
    v_pk_mul_f32 v[30:31], v[30:31], v[214:215] op_sel_hi:[1,0]
    v_pk_fma_f32 v[160:161], v[160:161], v[212:213], v[16:17] op_sel_hi:[1,0,1] neg_lo:[0,0,1] neg_hi:[0,0,1]
    v_pk_fma_f32 v[162:163], v[162:163], v[212:213], v[18:19] op_sel_hi:[1,0,1] neg_lo:[0,0,1] neg_hi:[0,0,1]
    v_pk_fma_f32 v[164:165], v[164:165], v[212:213], v[20:21] op_sel_hi:[1,0,1] neg_lo:[0,0,1] neg_hi:[0,0,1]
    v_pk_fma_f32 v[166:167], v[166:167], v[212:213], v[22:23] op_sel_hi:[1,0,1] neg_lo:[0,0,1] neg_hi:[0,0,1]
    v_pk_fma_f32 v[168:169], v[168:169], v[212:213], v[24:25] op_sel_hi:[1,0,1] neg_lo:[0,0,1] neg_hi:[0,0,1]
    v_pk_fma_f32 v[170:171], v[170:171], v[212:213], v[26:27] op_sel_hi:[1,0,1] neg_lo:[0,0,1] neg_hi:[0,0,1]
    v_pk_fma_f32 v[172:173], v[172:173], v[212:213], v[28:29] op_sel_hi:[1,0,1] neg_lo:[0,0,1] neg_hi:[0,0,1]
    v_pk_fma_f32 v[174:175], v[174:175], v[212:213], v[30:31] op_sel_hi:[1,0,1] neg_lo:[0,0,1] neg_hi:[0,0,1]
    s_mov_b32 exec_lo, 0
    v_mov_b32 v172, 1.0
    v_mov_b32 v173, 0
    v_mov_b32 v174, 0
    v_mov_b32 v175, 0
    s_mov_b64 exec, -1
    v_cvt_pk_bf16_f32 v184, v160, v161
    v_cvt_pk_bf16_f32 v185, v162, v163
    v_cvt_pk_bf16_f32 v186, v164, v165
    v_cvt_pk_bf16_f32 v187, v166, v167
    v_cvt_pk_bf16_f32 v188, v168, v169
    v_cvt_pk_bf16_f32 v189, v170, v171
    v_cvt_pk_bf16_f32 v190, v172, v173
    v_cvt_pk_bf16_f32 v191, v174, v175
    s_nop 1
    v_mfma_f32_32x32x16_bf16 v[160:175], v[184:187], v[240:243], 0
    v_mfma_f32_32x32x16_bf16 v[160:175], v[188:191], v[244:247], v[160:175]
    s_waitcnt lgkmcnt(0)
    v_pk_mul_f32 v[32:33], v[32:33], v[214:215] op_sel_hi:[1,0]
    v_pk_mul_f32 v[34:35], v[34:35], v[214:215] op_sel_hi:[1,0]
    v_pk_mul_f32 v[36:37], v[36:37], v[214:215] op_sel_hi:[1,0]
    v_pk_mul_f32 v[38:39], v[38:39], v[214:215] op_sel_hi:[1,0]
    v_pk_mul_f32 v[40:41], v[40:41], v[214:215] op_sel_hi:[1,0]
    v_pk_mul_f32 v[42:43], v[42:43], v[214:215] op_sel_hi:[1,0]
    v_pk_mul_f32 v[44:45], v[44:45], v[214:215] op_sel_hi:[1,0]
    v_pk_mul_f32 v[46:47], v[46:47], v[214:215] op_sel_hi:[1,0]
    v_pk_fma_f32 v[144:145], v[144:145], v[212:213], v[32:33] op_sel_hi:[1,0,1] neg_lo:[0,0,1] neg_hi:[0,0,1]
    v_pk_fma_f32 v[146:147], v[146:147], v[212:213], v[34:35] op_sel_hi:[1,0,1] neg_lo:[0,0,1] neg_hi:[0,0,1]
    v_pk_fma_f32 v[148:149], v[148:149], v[212:213], v[36:37] op_sel_hi:[1,0,1] neg_lo:[0,0,1] neg_hi:[0,0,1]
    v_pk_fma_f32 v[150:151], v[150:151], v[212:213], v[38:39] op_sel_hi:[1,0,1] neg_lo:[0,0,1] neg_hi:[0,0,1]
    v_pk_fma_f32 v[152:153], v[152:153], v[212:213], v[40:41] op_sel_hi:[1,0,1] neg_lo:[0,0,1] neg_hi:[0,0,1]
    v_pk_fma_f32 v[154:155], v[154:155], v[212:213], v[42:43] op_sel_hi:[1,0,1] neg_lo:[0,0,1] neg_hi:[0,0,1]
    v_pk_fma_f32 v[156:157], v[156:157], v[212:213], v[44:45] op_sel_hi:[1,0,1] neg_lo:[0,0,1] neg_hi:[0,0,1]
    v_pk_fma_f32 v[158:159], v[158:159], v[212:213], v[46:47] op_sel_hi:[1,0,1] neg_lo:[0,0,1] neg_hi:[0,0,1]
    s_mov_b32 exec_lo, 0
    v_mov_b32 v156, 0
    v_mov_b32 v157, 0
    v_mov_b32 v158, 0
    v_mov_b32 v159, 0
    s_mov_b64 exec, -1
    v_cvt_pk_bf16_f32 v192, v144, v145
    v_cvt_pk_bf16_f32 v193, v146, v147
    v_cvt_pk_bf16_f32 v194, v148, v149
    v_cvt_pk_bf16_f32 v195, v150, v151
    v_cvt_pk_bf16_f32 v196, v152, v153
    v_cvt_pk_bf16_f32 v197, v154, v155
    v_cvt_pk_bf16_f32 v198, v156, v157
    v_cvt_pk_bf16_f32 v199, v158, v159
    buffer_store_dwordx4 v[192:195], v0, s[8:11], s41 offen offset:0 sc1
    buffer_store_dwordx4 v[196:199], v0, s[8:11], s41 offen offset:1024 sc1
    v_cvt_pk_bf16_f32 v184, v160, v161
    v_cvt_pk_bf16_f32 v185, v162, v163
    v_cvt_pk_bf16_f32 v186, v164, v165
    v_cvt_pk_bf16_f32 v187, v166, v167
    v_cvt_pk_bf16_f32 v188, v168, v169
    v_cvt_pk_bf16_f32 v189, v170, v171
    v_cvt_pk_bf16_f32 v190, v172, v173
    v_cvt_pk_bf16_f32 v191, v174, v175
    buffer_store_dwordx4 v[184:187], v0, s[8:11], s42 offen offset:0 sc1
    buffer_store_dwordx4 v[188:191], v0, s[8:11], s42 offen offset:1024 sc1
    v_mul_f32 v214, 0x3e8b97f6, v214
    v_mul_f32 v212, 0x3e8b97f6, v212
    v_pk_mul_f32 v[48:49], v[48:49], v[214:215] op_sel_hi:[1,0]
    v_pk_mul_f32 v[50:51], v[50:51], v[214:215] op_sel_hi:[1,0]
    v_pk_mul_f32 v[52:53], v[52:53], v[214:215] op_sel_hi:[1,0]
    v_pk_mul_f32 v[54:55], v[54:55], v[214:215] op_sel_hi:[1,0]
    v_pk_mul_f32 v[56:57], v[56:57], v[214:215] op_sel_hi:[1,0]
    v_pk_mul_f32 v[58:59], v[58:59], v[214:215] op_sel_hi:[1,0]
    v_pk_mul_f32 v[60:61], v[60:61], v[214:215] op_sel_hi:[1,0]
    v_pk_mul_f32 v[62:63], v[62:63], v[214:215] op_sel_hi:[1,0]
    v_pk_fma_f32 v[128:129], v[128:129], v[212:213], v[48:49] op_sel_hi:[1,0,1] neg_lo:[0,0,1] neg_hi:[0,0,1]
    v_pk_fma_f32 v[130:131], v[130:131], v[212:213], v[50:51] op_sel_hi:[1,0,1] neg_lo:[0,0,1] neg_hi:[0,0,1]
    v_pk_fma_f32 v[132:133], v[132:133], v[212:213], v[52:53] op_sel_hi:[1,0,1] neg_lo:[0,0,1] neg_hi:[0,0,1]
    v_pk_fma_f32 v[134:135], v[134:135], v[212:213], v[54:55] op_sel_hi:[1,0,1] neg_lo:[0,0,1] neg_hi:[0,0,1]
    v_pk_fma_f32 v[136:137], v[136:137], v[212:213], v[56:57] op_sel_hi:[1,0,1] neg_lo:[0,0,1] neg_hi:[0,0,1]
    v_pk_fma_f32 v[138:139], v[138:139], v[212:213], v[58:59] op_sel_hi:[1,0,1] neg_lo:[0,0,1] neg_hi:[0,0,1]
    v_pk_fma_f32 v[140:141], v[140:141], v[212:213], v[60:61] op_sel_hi:[1,0,1] neg_lo:[0,0,1] neg_hi:[0,0,1]
    v_pk_fma_f32 v[142:143], v[142:143], v[212:213], v[62:63] op_sel_hi:[1,0,1] neg_lo:[0,0,1] neg_hi:[0,0,1]
    s_mov_b32 exec_lo, 0
    v_mov_b32 v140, 0
    v_mov_b32 v141, 0
    v_mov_b32 v142, 0
    v_mov_b32 v143, 0
    s_mov_b64 exec, -1
    v_cvt_pk_bf16_f32 v144, v128, v129
    v_cvt_pk_bf16_f32 v145, v130, v131
    v_cvt_pk_bf16_f32 v146, v132, v133
    v_cvt_pk_bf16_f32 v147, v134, v135
    v_cvt_pk_bf16_f32 v148, v136, v137
    v_cvt_pk_bf16_f32 v149, v138, v139
    v_cvt_pk_bf16_f32 v150, v140, v141
    v_cvt_pk_bf16_f32 v151, v142, v143
    s_lshl_b32 s41, s3, 11
    s_add_u32 s41, s41, 145408
    v_add_u32 v2, s41, v0
    ds_write_b128 v2, v[144:147]
    ds_write_b128 v2, v[148:151] offset:1024
    s_mul_i32 s57, s19, 32768
    s_add_u32 s57, s57, 0
    s_lshl_b32 s58, s16, 11
    s_add_u32 s57, s57, s58
    s_lshl_b32 s58, s17, 7
    s_add_u32 s57, s57, s58
    s_lshl_b32 s58, s19, 2
    s_add_u32 s58, s58, 162880
    v_mov_b32 v4, 1
    v_mov_b32 v5, s58
    s_waitcnt vmcnt(0)
    s_mov_b64 exec, 1
    ds_add_rtn_u32 v6, v5, v4
    v_mov_b32 v7, 0
    s_waitcnt lgkmcnt(0)
    v_readfirstlane_b32 s58, v6
    s_nop 0
    s_cmp_eq_u32 s58, 3
    s_cbranch_scc0 L_nosig_81
    buffer_store_dword v4, v7, s[8:11], s57 offen sc1
L_nosig_81:
    s_mov_b64 exec, -1
    s_waitcnt lgkmcnt(0)
    s_branch L_qkv_join_78
L_qkv_helper_77:
    s_waitcnt vmcnt(0) lgkmcnt(0)
    s_barrier
    s_barrier
L_qkv_join_78:
    s_branch L_att_1
L_att_fallback_18:
    s_waitcnt lgkmcnt(0)
    s_barrier
    s_lshl_b32 s45, s17, 6
    s_lshl_b32 s44, s49, 5
    s_add_u32 s45, s45, s44
    s_lshl_b32 s45, s45, 11
    s_mul_i32 s40, s19, 2097152
    s_add_u32 s40, s40, 9437184
    s_add_u32 s40, s40, s45
    s_mul_i32 s41, s19, 2097152
    s_add_u32 s41, s41, 13631488
    s_add_u32 s41, s41, s45
    v_mov_b32 v56, 0xff800000
    s_mov_b32 s42, 0
L_fb_max_82:
    s_add_u32 s43, s40, s42
    buffer_load_dwordx4 v[80:83], v0, s[8:11], s43 offen sc1
    buffer_load_dwordx4 v[84:87], v0, s[8:11], s43 offen offset:1024 sc1
    s_waitcnt vmcnt(0)
    v_mfma_f32_32x32x16_bf16 v[40:55], v[80:83], v[16:19], 0
    v_mfma_f32_32x32x16_bf16 v[40:55], v[84:87], v[20:23], v[40:55]
    s_nop 11
    v_max3_f32 v56, v40, v41, v56
    v_max3_f32 v56, v42, v43, v56
    v_max3_f32 v56, v44, v45, v56
    v_max3_f32 v56, v46, v47, v56
    v_max3_f32 v56, v48, v49, v56
    v_max3_f32 v56, v50, v51, v56
    v_max3_f32 v56, v52, v53, v56
    v_max3_f32 v56, v54, v55, v56
    s_add_u32 s42, s42, 2048
    s_cmp_lt_u32 s42, 65536
    s_cbranch_scc1 L_fb_max_82
    v_mov_b32 v57, v56
    s_nop 1
    v_permlane32_swap_b32 v56, v57
    s_nop 1
    v_max_f32 v56, v56, v57
    s_lshl_b32 s45, s18, 8
    s_add_u32 s45, s45, 145408
    v_lshlrev_b32 v6, 2, v1
    v_add_u32 v7, s45, v6
    ds_write_b32 v7, v56
    s_waitcnt lgkmcnt(0)
    s_barrier
    v_xor_b32 v7, 1024, v7
    ds_read_b32 v57, v7
    s_waitcnt lgkmcnt(0)
    v_max_f32 v56, v56, v57
    s_barrier
    v_mov_b32 v24, 0
    v_mov_b32 v25, 0
    v_mov_b32 v26, 0
    v_mov_b32 v27, 0
    v_mov_b32 v28, 0
    v_mov_b32 v29, 0
    v_mov_b32 v30, 0
    v_mov_b32 v31, 0
    v_mov_b32 v32, 0
    v_mov_b32 v33, 0
    v_mov_b32 v34, 0
    v_mov_b32 v35, 0
    v_mov_b32 v36, 0
    v_mov_b32 v37, 0
    v_mov_b32 v38, 0
    v_mov_b32 v39, 0
    s_mov_b32 s42, 0
L_fb_sum_83:
    s_add_u32 s43, s40, s42
    buffer_load_dwordx4 v[80:83], v0, s[8:11], s43 offen sc1
    buffer_load_dwordx4 v[84:87], v0, s[8:11], s43 offen offset:1024 sc1
    s_add_u32 s43, s41, s42
    buffer_load_dwordx4 v[96:99], v0, s[8:11], s43 offen sc1
    buffer_load_dwordx4 v[100:103], v0, s[8:11], s43 offen offset:1024 sc1
    s_waitcnt vmcnt(0)
    v_mfma_f32_32x32x16_bf16 v[40:55], v[80:83], v[16:19], 0
    v_mfma_f32_32x32x16_bf16 v[40:55], v[84:87], v[20:23], v[40:55]
    s_nop 11
    v_sub_f32 v40, v40, v56
    v_sub_f32 v41, v41, v56
    v_sub_f32 v42, v42, v56
    v_sub_f32 v43, v43, v56
    v_sub_f32 v44, v44, v56
    v_sub_f32 v45, v45, v56
    v_sub_f32 v46, v46, v56
    v_sub_f32 v47, v47, v56
    v_sub_f32 v48, v48, v56
    v_sub_f32 v49, v49, v56
    v_sub_f32 v50, v50, v56
    v_sub_f32 v51, v51, v56
    v_sub_f32 v52, v52, v56
    v_sub_f32 v53, v53, v56
    v_sub_f32 v54, v54, v56
    v_sub_f32 v55, v55, v56
    v_exp_f32 v40, v40
    v_exp_f32 v41, v41
    v_exp_f32 v42, v42
    v_exp_f32 v43, v43
    v_exp_f32 v44, v44
    v_exp_f32 v45, v45
    v_exp_f32 v46, v46
    v_exp_f32 v47, v47
    v_exp_f32 v48, v48
    v_exp_f32 v49, v49
    v_exp_f32 v50, v50
    v_exp_f32 v51, v51
    v_exp_f32 v52, v52
    v_exp_f32 v53, v53
    v_exp_f32 v54, v54
    v_exp_f32 v55, v55
    s_nop 0
    v_cvt_pk_bf16_f32 v72, v40, v41
    v_cvt_pk_bf16_f32 v73, v42, v43
    v_cvt_pk_bf16_f32 v74, v44, v45
    v_cvt_pk_bf16_f32 v75, v46, v47
    v_cvt_pk_bf16_f32 v76, v48, v49
    v_cvt_pk_bf16_f32 v77, v50, v51
    v_cvt_pk_bf16_f32 v78, v52, v53
    v_cvt_pk_bf16_f32 v79, v54, v55
    s_nop 1
    v_mfma_f32_32x32x16_bf16 v[24:39], v[96:99], v[72:75], v[24:39]
    v_mfma_f32_32x32x16_bf16 v[24:39], v[100:103], v[76:79], v[24:39]
    s_add_u32 s42, s42, 2048
    s_cmp_lt_u32 s42, 65536
    s_cbranch_scc1 L_fb_sum_83
    s_nop 11
    v_mov_b32 v41, 0
    s_lshl_b32 s45, s18, 2
    s_add_u32 s45, s45, 162816
    v_mov_b32 v42, s45
    ds_write_b32 v42, v41
    s_branch L_att_back_19
L_main_end:
    s_endpgm
.section .rodata,"a"
.p2align 6
.amdhsa_kernel interleave_layers__mha_block__mixer_gmlp__prompt_kernel
  .amdhsa_next_free_vgpr 256
  .amdhsa_next_free_sgpr 102
  .amdhsa_accum_offset 256
  .amdhsa_group_segment_fixed_size 0
  .amdhsa_kernarg_size 88
  .amdhsa_user_sgpr_count 2
  .amdhsa_user_sgpr_kernarg_segment_ptr 1
  .amdhsa_system_sgpr_workgroup_id_x 1
.end_amdhsa_kernel
```
